```python
import torch

def _softmax(x, axis=-1):
    return torch.softmax(x, dim=axis)
def _gelu(x):
    return torch.nn.functional.gelu(x, approximate="tanh")
def _silu(x):
    return torch.nn.functional.silu(x)
def _sigmoid(x):
    return torch.sigmoid(x)
def _layernorm(x, axis=-1, eps=1e-5):
    m = x.mean(dim=axis, keepdim=True)
    v = x.var(dim=axis, keepdim=True, unbiased=False)
    return (x - m) / torch.sqrt(v + eps)
def _scatter_add(tgt, idx, src, axis=0):
    return tgt.clone().index_add_(axis, idx, src)
def _segment_sum(src, seg, n):
    out = torch.zeros((n,) + src.shape[1:], dtype=src.dtype)
    return out.index_add_(0, seg, src)
def _pad(x, pw):
    flat = tuple(v for pair in reversed(pw) for v in pair)
    return torch.nn.functional.pad(x, flat)

kernel_name = 'interleave_layers__grouped_kv_mqa__glu_gated_geglu__prompt'

def setup_inputs():

    _w = (lambda a: (lambda t: t.to(torch.bfloat16) if t.is_floating_point() else t)(torch.as_tensor(a)))
    def _A_setup():
        B, S, D, H = 1, 2048, 512, 32
        Dh = D // H
        return {
            "x": _w((lambda *s: torch.randn(*s, dtype=torch.bfloat16) * 0.05)(B, S, D)),
            "wq": _w((lambda *s: torch.randn(*s, dtype=torch.bfloat16) * 0.05)(D, H * Dh)),
            "wk": _w((lambda *s: torch.randn(*s, dtype=torch.bfloat16) * 0.05)(D, Dh)),
            "wv": _w((lambda *s: torch.randn(*s, dtype=torch.bfloat16) * 0.05)(D, Dh)),
            "wo": _w((lambda *s: torch.randn(*s, dtype=torch.bfloat16) * 0.05)(H * Dh, D)),
        }
    _A_in = _A_setup()

    def _B_setup():
        B, S, Dm, Df = 1, 2048, 512, 1376
        return {
            "x": _w((lambda *s: torch.randn(*s, dtype=torch.bfloat16) * 0.05)(B, S, Dm)),
            "w_gate": _w((lambda *s: torch.randn(*s, dtype=torch.bfloat16) * 0.8)(Dm, Df) * (Dm ** -0.5)),
            "w_up": _w((lambda *s: torch.randn(*s, dtype=torch.bfloat16) * 0.8)(Dm, Df) * (Dm ** -0.5)),
            "w_down": _w((lambda *s: torch.randn(*s, dtype=torch.bfloat16) * 0.8)(Df, Dm) * (Df ** -0.5)),
        }
    _B_in = _B_setup()

    return {
        "A_x": _A_in["x"],
        "A_wq": _A_in["wq"],
        "A_wk": _A_in["wk"],
        "A_wv": _A_in["wv"],
        "A_wo": _A_in["wo"],
        "B_x": _B_in["x"],
        "B_w_gate": _B_in["w_gate"],
        "B_w_up": _B_in["w_up"],
        "B_w_down": _B_in["w_down"],
    }

def reference(A_x, A_wq, A_wk, A_wv, A_wo, B_x, B_w_gate, B_w_up, B_w_down):
    def _A_ref(x, wq, wk, wv, wo):
        B, S, D = x.shape
        H = 32
        Dh = D // H
        q = (lambda x, *d: x.permute(*d))((x @ wq).reshape(B, S, H, Dh), 0, 2, 1, 3)
        k = x @ wk
        v = x @ wv
        scores = torch.einsum("bhqd,bkd->bhqk", q, k) * (Dh ** -0.5)
        p = _softmax(scores, axis=-1)
        o = torch.einsum("bhqk,bkd->bhqd", p, v)
        return (lambda x, *d: x.permute(*d))(o, 0, 2, 1, 3).reshape(B, S, H * Dh) @ wo

    def _B_ref(x, w_gate, w_up, w_down):
        g = torch.einsum("bsd,df->bsf", x, w_gate)
        u = torch.einsum("bsd,df->bsf", x, w_up)
        h = _gelu(g) * u
        return torch.einsum("bsf,fd->bsd", h, w_down)

    x = A_x
    x = x + _A_ref(_layernorm(x, axis=-1), A_wq, A_wk, A_wv, A_wo)
    x = x + _B_ref(_layernorm(x, axis=-1), B_w_gate, B_w_up, B_w_down)
    x = x + _A_ref(_layernorm(x, axis=-1), A_wq, A_wk, A_wv, A_wo)
    x = x + _B_ref(_layernorm(x, axis=-1), B_w_gate, B_w_up, B_w_down)
    return x
```

```asm
; @launch grid=(256,1,1) block=(256,1,1) lds=163840
.amdgcn_target "amdgcn-amd-amdhsa--gfx950"
.text
.globl interleave_layers__grouped_kv_mqa__glu_gated_geglu__prompt_kernel
.p2align 8
.type interleave_layers__grouped_kv_mqa__glu_gated_geglu__prompt_kernel,@function
interleave_layers__grouped_kv_mqa__glu_gated_geglu__prompt_kernel:
code_begin:
    s_cmp_ge_u32 s2, 256
    s_cbranch_scc1 k_exit
    s_load_dwordx16 s[72:87], s[0:1], 0
    s_load_dwordx8 s[88:95], s[0:1], 64
    s_mov_b32 s3, 0
    s_and_b32 s4, s2, 7
    s_lshr_b32 s5, s2, 3
    v_lshrrev_b32 v2, 6, v0
    v_and_b32 v1, 63, v0
    v_readfirstlane_b32 s6, v2
    s_mov_b32 s7, 16252928
    v_lshlrev_b32 v121, 7, v1
    s_getpc_b64 s[96:97]
pc_1:
    s_sub_u32 s96, s96, pc_1-code_begin
    s_subb_u32 s97, s97, 0
    s_mov_b32 s98, code_end-code_begin
    s_mov_b32 s99, 0x00020000
    s_lshr_b32 s48, s2, 3
    s_lshl_b32 s48, s48, 2
    s_add_u32 s48, s48, s6
    s_lshl_b32 s48, s48, 13
    buffer_load_dword v122, v121, s[96:99], s48 offen
    s_lshr_b32 s52, s5, 3
    s_lshl_b32 s48, s4, 2
    s_add_u32 s48, s48, s52
    s_and_b32 s49, s5, 7
    s_add_u32 s50, s48, s49
    s_and_b32 s50, s50, 3
    v_lshrrev_b32 v125, 4, v1
    v_lshrrev_b32 v123, 5, v1
    v_lshlrev_b32 v123, 3, v123
    v_bfe_u32 v124, v1, 3, 2
    v_add_u32 v123, v123, v124
    v_lshlrev_b32 v126, 10, v123
    v_lshrrev_b32 v123, 1, v1
    v_xor_b32 v123, v123, v125
    v_and_b32 v123, 3, v123
    v_lshl_add_u32 v126, v123, 5, v126
    v_and_b32 v125, 1, v1
    v_lshl_add_u32 v126, v125, 4, v126
    s_lshl_b32 s52, s49, 7
    s_lshl_b32 s53, s6, 15
    s_add_u32 s52, s52, s53
    v_add_u32 v126, s52, v126
    s_lshl_b32 s58, s6, 12
    v_lshlrev_b32 v124, 3, v124
    v_lshrrev_b32 v123, 5, v1
    v_lshl_add_u32 v124, v123, 2, v124
    v_bfe_u32 v123, v1, 1, 2
    v_add_u32 v124, v124, v123
    v_lshlrev_b32 v127, 5, v124
    v_lshl_add_u32 v127, v125, 4, v127
    s_lshl_b32 s52, s6, 10
    v_add_u32 v127, s52, v127
    s_add_u32 s57, s52, 135168
    v_lshrrev_b32 v5, 4, v1
    s_lshl_b32 s59, s6, 14
    v_lshrrev_b32 v4, 2, v1
    v_sub_u32 v6, 0, v5
    v_xor_b32 v6, v6, v1
    v_and_b32 v6, 3, v6
    s_lshl_b32 s51, s48, 6
    s_lshl_b32 s52, s6, 4
    s_add_u32 s51, s51, s52
    v_add_u32 v4, s51, v4
    v_lshlrev_b32 v3, 10, v4
    v_lshl_add_u32 v3, v6, 4, v3
    v_and_b32 v4, 15, v1
    v_lshrrev_b32 v8, 2, v4
    v_sub_u32 v8, 0, v8
    v_xor_b32 v8, v8, v5
    v_and_b32 v8, 3, v8
    v_lshlrev_b32 v11, 6, v4
    v_lshl_add_u32 v11, v8, 4, v11
    v_add_u32 v11, s59, v11
    v_add_u32 v6, s51, v4
    v_lshrrev_b32 v8, 5, v1
    v_lshlrev_b32 v8, 10, v8
    v_bfe_u32 v9, v1, 2, 3
    v_lshl_add_u32 v8, v9, 7, v8
    v_and_b32 v9, 3, v1
    v_lshl_add_u32 v8, v9, 3, v8
    v_add_u32 v8, 69632, v8
    v_bfe_u32 v9, v1, 3, 2
    s_add_u32 s52, s6, 0
    s_and_b32 s52, s52, 3
    v_xor_b32 v12, s52, v9
    v_lshl_add_u32 v12, v12, 5, v8
    s_add_u32 s52, s6, 1
    s_and_b32 s52, s52, 3
    v_xor_b32 v13, s52, v9
    v_lshl_add_u32 v13, v13, 5, v8
    s_add_u32 s52, s6, 2
    s_and_b32 s52, s52, 3
    v_xor_b32 v14, s52, v9
    v_lshl_add_u32 v14, v14, 5, v8
    s_add_u32 s52, s6, 3
    s_and_b32 s52, s52, 3
    v_xor_b32 v15, s52, v9
    v_lshl_add_u32 v15, v15, 5, v8
    v_lshlrev_b32 v50, 3, v1
    v_add_u32 v50, 135168, v50
    v_mov_b32 v44, 0x3f803f80
    v_mov_b32 v45, 0x3f803f80
    v_mov_b32 v46, 0x3f803f80
    v_mov_b32 v47, 0x3f803f80
    v_mov_b32 v48, 0
    v_mov_b32 v49, 0
    s_add_u32 s65, s49, 2
    s_and_b32 s65, s65, 3
    v_lshrrev_b32 v51, 2, v1
    v_lshlrev_b32 v51, 10, v51
    v_and_b32 v9, 3, v1
    v_lshl_add_u32 v51, v9, 4, v51
    s_lshr_b32 s61, s2, 4
    s_and_b32 s62, s2, 15
    s_lshl_b32 s63, s61, 15
    s_lshl_b32 s64, s62, 6
    s_add_u32 s63, s63, s64
    v_lshrrev_b32 v52, 5, v1
    v_lshlrev_b32 v52, 10, v52
    v_bfe_u32 v53, v1, 4, 1
    v_lshl_add_u32 v52, v53, 8, v52
    v_bfe_u32 v53, v1, 2, 1
    v_lshl_add_u32 v52, v53, 6, v52
    v_bfe_u32 v53, v1, 3, 1
    v_lshl_add_u32 v52, v53, 9, v52
    v_lshl_add_u32 v52, v9, 3, v52
    v_add_u32 v52, 151552, v52
    v_lshlrev_b32 v53, 4, v1
    s_lshr_b32 s52, s62, 2
    s_lshl_b32 s52, s52, 3
    s_lshr_b32 s53, s61, 1
    s_add_u32 s52, s52, s53
    s_lshl_b32 s52, s52, 3
    s_and_b32 s53, s62, 3
    s_lshl_b32 s53, s53, 1
    s_add_u32 s52, s52, s53
    s_lshl_b32 s52, s52, 1
    s_and_b32 s53, s61, 1
    s_add_u32 s52, s52, s53
    s_lshl_b32 s52, s52, 10
    s_add_u32 s64, s52, 15728640
    s_waitcnt lgkmcnt(0)
    s_mov_b32 s8, s72
    s_mov_b32 s9, s73
    s_mov_b32 s10, 0x200000
    s_mov_b32 s11, 0x00020000
    s_mov_b32 s24, s74
    s_mov_b32 s25, s75
    s_mov_b32 s26, 0x80000
    s_mov_b32 s27, 0x00020000
    s_cmp_lt_u32 s49, 4
    s_cselect_b32 s28, s76, s78
    s_cselect_b32 s29, s77, s79
    s_mov_b32 s30, 0x4000
    s_mov_b32 s31, 0x00020000
    s_mov_b32 s16, s94
    s_mov_b32 s17, s95
    s_mov_b32 s18, 0x2200000
    s_mov_b32 s19, 0x00020000
    s_or_b32 s66, s2, s6
    s_cmp_lg_u32 s66, 0
    s_cbranch_scc1 noinit_2
    v_lshlrev_b32 v16, 8, v1
    v_mov_b32 v17, 0
    s_add_u32 s66, s7, 0
    buffer_store_dword v17, v16, s[16:19], s66 offen sc1
    s_add_u32 s66, s7, 16384
    buffer_store_dword v17, v16, s[16:19], s66 offen sc1
    s_add_u32 s66, s7, 32768
    buffer_store_dword v17, v16, s[16:19], s66 offen sc1
    s_add_u32 s66, s7, 65536
    buffer_store_dword v17, v16, s[16:19], s66 offen sc1
    s_add_u32 s66, s7, 81920
    buffer_store_dword v17, v16, s[16:19], s66 offen sc1
    s_add_u32 s66, s7, 98304
    buffer_store_dword v17, v16, s[16:19], s66 offen sc1
noinit_2:
    s_add_u32 s52, s50, 0
    s_and_b32 s52, s52, 3
    s_lshl_b32 s54, s52, 8
    s_add_u32 m0, s59, 0
    s_add_u32 s55, s54, 0
    buffer_load_dwordx4 v3, s[8:11], s55 offen lds
    s_add_u32 m0, s59, 1024
    s_add_u32 s55, s54, 64
    buffer_load_dwordx4 v3, s[8:11], s55 offen lds
    s_add_u32 m0, s59, 2048
    s_add_u32 s55, s54, 128
    buffer_load_dwordx4 v3, s[8:11], s55 offen lds
    s_add_u32 m0, s59, 3072
    s_add_u32 s55, s54, 192
    buffer_load_dwordx4 v3, s[8:11], s55 offen lds
    s_add_u32 s52, s50, 0
    s_and_b32 s52, s52, 3
    s_lshl_b32 s53, s52, 17
    s_add_u32 m0, s58, 69632
    s_add_u32 s55, s53, 0
    buffer_load_dwordx4 v126, s[24:27], s55 offen lds
    s_add_u32 m0, s58, 70656
    s_add_u32 s55, s53, 16384
    buffer_load_dwordx4 v126, s[24:27], s55 offen lds
    s_add_u32 m0, s58, 71680
    s_add_u32 s55, s53, 4096
    buffer_load_dwordx4 v126, s[24:27], s55 offen lds
    s_add_u32 m0, s58, 72704
    s_add_u32 s55, s53, 20480
    buffer_load_dwordx4 v126, s[24:27], s55 offen lds
    s_add_u32 m0, s57, 0
    s_lshl_b32 s55, s52, 12
    buffer_load_dwordx4 v127, s[28:31], s55 offen lds
    s_add_u32 s52, s50, 1
    s_and_b32 s52, s52, 3
    s_lshl_b32 s54, s52, 8
    s_add_u32 m0, s59, 4096
    s_add_u32 s55, s54, 0
    buffer_load_dwordx4 v3, s[8:11], s55 offen lds
    s_add_u32 m0, s59, 5120
    s_add_u32 s55, s54, 64
    buffer_load_dwordx4 v3, s[8:11], s55 offen lds
    s_add_u32 m0, s59, 6144
    s_add_u32 s55, s54, 128
    buffer_load_dwordx4 v3, s[8:11], s55 offen lds
    s_add_u32 m0, s59, 7168
    s_add_u32 s55, s54, 192
    buffer_load_dwordx4 v3, s[8:11], s55 offen lds
    s_add_u32 s52, s50, 1
    s_and_b32 s52, s52, 3
    s_lshl_b32 s53, s52, 17
    s_add_u32 m0, s58, 86016
    s_add_u32 s55, s53, 0
    buffer_load_dwordx4 v126, s[24:27], s55 offen lds
    s_mov_b32 s44, s80
    s_mov_b32 s45, s81
    s_mov_b32 s46, 0x80000
    s_mov_b32 s47, 0x00020000
    s_mov_b32 s32, s84
    s_mov_b32 s33, s85
    s_mov_b32 s34, 0x158000
    s_mov_b32 s35, 0x00020000
    s_mov_b32 s36, s86
    s_mov_b32 s37, s87
    s_mov_b32 s38, 0x158000
    s_mov_b32 s39, 0x00020000
    s_mov_b32 s40, s88
    s_mov_b32 s41, s89
    s_mov_b32 s42, 0x158000
    s_mov_b32 s43, 0x00020000
    s_mov_b32 s12, s94
    s_mov_b32 s13, s95
    s_mov_b32 s14, 0xd00000
    s_mov_b32 s15, 0x00020000
    s_add_u32 s20, s94, 0xd00000
    s_addc_u32 s21, s95, 0
    s_mov_b32 s22, 0x200000
    s_mov_b32 s23, 0x00020000
    s_mov_b32 s96, s92
    s_mov_b32 s97, s93
    s_mov_b32 s98, 0x100
    s_mov_b32 s99, 0x00020000
    s_branch qkv_first
layer_top:
    s_mov_b32 s26, 0
    s_mov_b32 s30, 0
    v_lshrrev_b32 v5, 4, v1
    s_lshl_b32 s59, s6, 14
    v_lshrrev_b32 v4, 2, v1
    v_sub_u32 v6, 0, v5
    v_xor_b32 v6, v6, v1
    v_and_b32 v6, 3, v6
    s_lshl_b32 s51, s48, 6
    s_lshl_b32 s52, s6, 4
    s_add_u32 s51, s51, s52
    v_add_u32 v4, s51, v4
    v_lshlrev_b32 v3, 10, v4
    v_lshl_add_u32 v3, v6, 4, v3
    v_and_b32 v4, 15, v1
    v_lshrrev_b32 v8, 2, v4
    v_sub_u32 v8, 0, v8
    v_xor_b32 v8, v8, v5
    v_and_b32 v8, 3, v8
    v_lshlrev_b32 v11, 6, v4
    v_lshl_add_u32 v11, v8, 4, v11
    v_add_u32 v11, s59, v11
    v_add_u32 v6, s51, v4
    v_lshrrev_b32 v8, 5, v1
    v_lshlrev_b32 v8, 10, v8
    v_bfe_u32 v9, v1, 2, 3
    v_lshl_add_u32 v8, v9, 7, v8
    v_and_b32 v9, 3, v1
    v_lshl_add_u32 v8, v9, 3, v8
    v_add_u32 v8, 69632, v8
    v_bfe_u32 v9, v1, 3, 2
    s_add_u32 s52, s6, 0
    s_and_b32 s52, s52, 3
    v_xor_b32 v12, s52, v9
    v_lshl_add_u32 v12, v12, 5, v8
    s_add_u32 s52, s6, 1
    s_and_b32 s52, s52, 3
    v_xor_b32 v13, s52, v9
    v_lshl_add_u32 v13, v13, 5, v8
    s_add_u32 s52, s6, 2
    s_and_b32 s52, s52, 3
    v_xor_b32 v14, s52, v9
    v_lshl_add_u32 v14, v14, 5, v8
    s_add_u32 s52, s6, 3
    s_and_b32 s52, s52, 3
    v_xor_b32 v15, s52, v9
    v_lshl_add_u32 v15, v15, 5, v8
    v_lshlrev_b32 v50, 3, v1
    v_add_u32 v50, 135168, v50
    v_mov_b32 v44, 0x3f803f80
    v_mov_b32 v45, 0x3f803f80
    v_mov_b32 v46, 0x3f803f80
    v_mov_b32 v47, 0x3f803f80
    v_mov_b32 v48, 0
    v_mov_b32 v49, 0
    v_mov_b32 v54, v50
    v_lshlrev_b32 v8, 4, v5
    s_lshl_b32 s52, s6, 6
    v_add_u32 v9, s52, v8
    v_add_u32 v9, 158208, v9
    v_add_u32 v8, 158208, v8
    ds_read_b128 v[32:35], v9
    ds_read_b128 v[68:71], v9 offset:64
    ds_read_b128 v[72:75], v9 offset:128
    ds_read_b128 v[76:79], v9 offset:192
    ds_read_b128 v[40:43], v8 offset:512
    v_lshrrev_b32 v8, 5, v6
    v_lshlrev_b32 v8, 11, v8
    v_lshl_add_u32 v8, v5, 9, v8
    v_and_b32 v9, 31, v6
    v_lshl_add_u32 v55, v9, 3, v8
    s_cmp_lg_u32 s6, 0
    s_cbranch_scc1 w0_3
    s_lshl_b32 s52, s48, 8
    s_add_u32 s52, s52, s7
    s_add_u32 s52, s52, 24576
    v_lshlrev_b32 v16, 8, v1
    s_mov_b32 s53, 200000
    s_mov_b64 exec, 1
poll_4:
    v_mov_b32 v17, 0
    buffer_atomic_add v17, v16, s[16:19], s52 offen sc0 sc1
    s_sub_u32 s53, s53, 1
    s_cmp_eq_u32 s53, 0
    s_cbranch_scc1 pollout_5
    s_waitcnt vmcnt(0)
    v_cmp_gt_u32 vcc, 16, v17
    s_cbranch_vccz pollout_5
    s_sleep 1
    s_branch poll_4
pollout_5:
    s_mov_b64 exec, -1
w0_3:
    s_waitcnt vmcnt(0) lgkmcnt(0)
    s_barrier
    s_add_u32 s52, s50, 0
    s_and_b32 s52, s52, 3
    s_lshl_b32 s54, s52, 8
    s_add_u32 m0, s59, 0
    s_add_u32 s55, s54, 0
    buffer_load_dwordx4 v3, s[8:11], s55 offen lds
    s_add_u32 m0, s59, 1024
    s_add_u32 s55, s54, 64
    buffer_load_dwordx4 v3, s[8:11], s55 offen lds
    s_add_u32 m0, s59, 2048
    s_add_u32 s55, s54, 128
    buffer_load_dwordx4 v3, s[8:11], s55 offen lds
    s_add_u32 m0, s59, 3072
    s_add_u32 s55, s54, 192
    buffer_load_dwordx4 v3, s[8:11], s55 offen lds
    s_mov_b32 s56, 16384000
    buffer_load_dwordx2 v[48:49], v55, s[16:19], s56 offen
    buffer_load_dwordx2 v[52:53], v55, s[16:19], s56 offen offset:256
    s_add_u32 s52, s50, 1
    s_and_b32 s52, s52, 3
    s_lshl_b32 s54, s52, 8
    s_add_u32 m0, s59, 4096
    s_add_u32 s55, s54, 0
    buffer_load_dwordx4 v3, s[8:11], s55 offen lds
    s_add_u32 m0, s59, 5120
    s_add_u32 s55, s54, 64
    buffer_load_dwordx4 v3, s[8:11], s55 offen lds
    s_add_u32 m0, s59, 6144
    s_add_u32 s55, s54, 128
    buffer_load_dwordx4 v3, s[8:11], s55 offen lds
    ds_read_b64_tr_b16 v[132:133], v12 offset:0
    ds_read_b64_tr_b16 v[134:135], v12 offset:2048
    ds_read_b64_tr_b16 v[136:137], v13 offset:0
    ds_read_b64_tr_b16 v[138:139], v13 offset:2048
    ds_read_b64_tr_b16 v[140:141], v14 offset:0
    ds_read_b64_tr_b16 v[142:143], v14 offset:2048
    ds_read_b64_tr_b16 v[144:145], v15 offset:0
    ds_read_b64_tr_b16 v[146:147], v15 offset:2048
    ds_read_b64_tr_b16 v[148:149], v54 offset:0
    ds_read_b64_tr_b16 v[150:151], v54 offset:512
    ds_read_b64_tr_b16 v[156:157], v12 offset:4096
    ds_read_b64_tr_b16 v[158:159], v12 offset:6144
    ds_read_b64_tr_b16 v[160:161], v13 offset:4096
    ds_read_b64_tr_b16 v[162:163], v13 offset:6144
    ds_read_b64_tr_b16 v[164:165], v14 offset:4096
    ds_read_b64_tr_b16 v[166:167], v14 offset:6144
    ds_read_b64_tr_b16 v[168:169], v15 offset:4096
    ds_read_b64_tr_b16 v[170:171], v15 offset:6144
    ds_read_b64_tr_b16 v[172:173], v54 offset:1024
    ds_read_b64_tr_b16 v[174:175], v54 offset:1536
    s_waitcnt vmcnt(8)
    ds_read_b128 v[128:131], v11 offset:0
    s_waitcnt vmcnt(7)
    ds_read_b128 v[152:155], v11 offset:1024
    s_waitcnt lgkmcnt(1)
    v_mfma_f32_16x16x32_bf16 v[16:19], v[132:135], v[128:131], 0
    ds_read_b64_tr_b16 v[180:181], v12 offset:8192
    ds_read_b64_tr_b16 v[182:183], v12 offset:10240
    s_add_u32 m0, s59, 7168
    s_add_u32 s55, s54, 192
    buffer_load_dwordx4 v3, s[8:11], s55 offen lds
    v_mfma_f32_16x16x32_bf16 v[20:23], v[136:139], v[128:131], 0
    ds_read_b64_tr_b16 v[184:185], v13 offset:8192
    ds_read_b64_tr_b16 v[186:187], v13 offset:10240
    v_mfma_f32_16x16x32_bf16 v[24:27], v[140:143], v[128:131], 0
    ds_read_b64_tr_b16 v[188:189], v14 offset:8192
    ds_read_b64_tr_b16 v[190:191], v14 offset:10240
    s_add_u32 s52, s50, 2
    s_and_b32 s52, s52, 3
    s_lshl_b32 s54, s52, 8
    s_add_u32 m0, s59, 8192
    s_add_u32 s55, s54, 0
    buffer_load_dwordx4 v3, s[8:11], s55 offen lds
    v_mfma_f32_16x16x32_bf16 v[28:31], v[144:147], v[128:131], 0
    ds_read_b64_tr_b16 v[192:193], v15 offset:8192
    ds_read_b64_tr_b16 v[194:195], v15 offset:10240
    v_mfma_f32_16x16x32_bf16 v[36:39], v[148:151], v[128:131], 0
    ds_read_b64_tr_b16 v[196:197], v54 offset:2048
    ds_read_b64_tr_b16 v[198:199], v54 offset:2560
    s_waitcnt vmcnt(8)
    ds_read_b128 v[176:179], v11 offset:2048
    s_waitcnt lgkmcnt(11)
    v_mfma_f32_16x16x32_bf16 v[16:19], v[156:159], v[152:155], v[16:19]
    ds_read_b64_tr_b16 v[204:205], v12 offset:12288
    ds_read_b64_tr_b16 v[206:207], v12 offset:14336
    s_add_u32 m0, s59, 9216
    s_add_u32 s55, s54, 64
    buffer_load_dwordx4 v3, s[8:11], s55 offen lds
    v_mfma_f32_16x16x32_bf16 v[20:23], v[160:163], v[152:155], v[20:23]
    ds_read_b64_tr_b16 v[208:209], v13 offset:12288
    ds_read_b64_tr_b16 v[210:211], v13 offset:14336
    v_mfma_f32_16x16x32_bf16 v[24:27], v[164:167], v[152:155], v[24:27]
    ds_read_b64_tr_b16 v[212:213], v14 offset:12288
    ds_read_b64_tr_b16 v[214:215], v14 offset:14336
    s_add_u32 m0, s59, 10240
    s_add_u32 s55, s54, 128
    buffer_load_dwordx4 v3, s[8:11], s55 offen lds
    v_mfma_f32_16x16x32_bf16 v[28:31], v[168:171], v[152:155], v[28:31]
    ds_read_b64_tr_b16 v[216:217], v15 offset:12288
    ds_read_b64_tr_b16 v[218:219], v15 offset:14336
    v_mfma_f32_16x16x32_bf16 v[36:39], v[172:175], v[152:155], v[36:39]
    ds_read_b64_tr_b16 v[220:221], v54 offset:3072
    ds_read_b64_tr_b16 v[222:223], v54 offset:3584
    s_waitcnt vmcnt(9)
    ds_read_b128 v[200:203], v11 offset:3072
    s_waitcnt lgkmcnt(11)
    v_mfma_f32_16x16x32_bf16 v[16:19], v[180:183], v[176:179], v[16:19]
    ds_read_b64_tr_b16 v[132:133], v12 offset:16384
    ds_read_b64_tr_b16 v[134:135], v12 offset:18432
    s_add_u32 m0, s59, 11264
    s_add_u32 s55, s54, 192
    buffer_load_dwordx4 v3, s[8:11], s55 offen lds
    v_mfma_f32_16x16x32_bf16 v[20:23], v[184:187], v[176:179], v[20:23]
    ds_read_b64_tr_b16 v[136:137], v13 offset:16384
    ds_read_b64_tr_b16 v[138:139], v13 offset:18432
    v_mfma_f32_16x16x32_bf16 v[24:27], v[188:191], v[176:179], v[24:27]
    ds_read_b64_tr_b16 v[140:141], v14 offset:16384
    ds_read_b64_tr_b16 v[142:143], v14 offset:18432
    s_add_u32 s52, s50, 3
    s_and_b32 s52, s52, 3
    s_lshl_b32 s54, s52, 8
    s_add_u32 m0, s59, 12288
    s_add_u32 s55, s54, 0
    buffer_load_dwordx4 v3, s[8:11], s55 offen lds
    v_mfma_f32_16x16x32_bf16 v[28:31], v[192:195], v[176:179], v[28:31]
    ds_read_b64_tr_b16 v[144:145], v15 offset:16384
    ds_read_b64_tr_b16 v[146:147], v15 offset:18432
    v_mfma_f32_16x16x32_bf16 v[36:39], v[196:199], v[176:179], v[36:39]
    ds_read_b64_tr_b16 v[148:149], v54 offset:4096
    ds_read_b64_tr_b16 v[150:151], v54 offset:4608
    s_waitcnt vmcnt(8)
    ds_read_b128 v[128:131], v11 offset:4096
    s_waitcnt lgkmcnt(11)
    v_mfma_f32_16x16x32_bf16 v[16:19], v[204:207], v[200:203], v[16:19]
    ds_read_b64_tr_b16 v[156:157], v12 offset:20480
    ds_read_b64_tr_b16 v[158:159], v12 offset:22528
    s_add_u32 m0, s59, 13312
    s_add_u32 s55, s54, 64
    buffer_load_dwordx4 v3, s[8:11], s55 offen lds
    v_mfma_f32_16x16x32_bf16 v[20:23], v[208:211], v[200:203], v[20:23]
    ds_read_b64_tr_b16 v[160:161], v13 offset:20480
    ds_read_b64_tr_b16 v[162:163], v13 offset:22528
    v_mfma_f32_16x16x32_bf16 v[24:27], v[212:215], v[200:203], v[24:27]
    ds_read_b64_tr_b16 v[164:165], v14 offset:20480
    ds_read_b64_tr_b16 v[166:167], v14 offset:22528
    s_add_u32 m0, s59, 14336
    s_add_u32 s55, s54, 128
    buffer_load_dwordx4 v3, s[8:11], s55 offen lds
    v_mfma_f32_16x16x32_bf16 v[28:31], v[216:219], v[200:203], v[28:31]
    ds_read_b64_tr_b16 v[168:169], v15 offset:20480
    ds_read_b64_tr_b16 v[170:171], v15 offset:22528
    v_mfma_f32_16x16x32_bf16 v[36:39], v[220:223], v[200:203], v[36:39]
    ds_read_b64_tr_b16 v[172:173], v54 offset:5120
    ds_read_b64_tr_b16 v[174:175], v54 offset:5632
    s_waitcnt vmcnt(9)
    ds_read_b128 v[152:155], v11 offset:5120
    s_waitcnt lgkmcnt(11)
    v_mfma_f32_16x16x32_bf16 v[16:19], v[132:135], v[128:131], v[16:19]
    ds_read_b64_tr_b16 v[180:181], v12 offset:24576
    ds_read_b64_tr_b16 v[182:183], v12 offset:26624
    s_add_u32 m0, s59, 15360
    s_add_u32 s55, s54, 192
    buffer_load_dwordx4 v3, s[8:11], s55 offen lds
    v_mfma_f32_16x16x32_bf16 v[20:23], v[136:139], v[128:131], v[20:23]
    ds_read_b64_tr_b16 v[184:185], v13 offset:24576
    ds_read_b64_tr_b16 v[186:187], v13 offset:26624
    v_mfma_f32_16x16x32_bf16 v[24:27], v[140:143], v[128:131], v[24:27]
    ds_read_b64_tr_b16 v[188:189], v14 offset:24576
    ds_read_b64_tr_b16 v[190:191], v14 offset:26624
    v_mfma_f32_16x16x32_bf16 v[28:31], v[144:147], v[128:131], v[28:31]
    ds_read_b64_tr_b16 v[192:193], v15 offset:24576
    ds_read_b64_tr_b16 v[194:195], v15 offset:26624
    v_mfma_f32_16x16x32_bf16 v[36:39], v[148:151], v[128:131], v[36:39]
    ds_read_b64_tr_b16 v[196:197], v54 offset:6144
    ds_read_b64_tr_b16 v[198:199], v54 offset:6656
    s_waitcnt vmcnt(9)
    ds_read_b128 v[176:179], v11 offset:6144
    s_waitcnt lgkmcnt(11)
    v_mfma_f32_16x16x32_bf16 v[16:19], v[156:159], v[152:155], v[16:19]
    ds_read_b64_tr_b16 v[204:205], v12 offset:28672
    ds_read_b64_tr_b16 v[206:207], v12 offset:30720
    v_mfma_f32_16x16x32_bf16 v[20:23], v[160:163], v[152:155], v[20:23]
    ds_read_b64_tr_b16 v[208:209], v13 offset:28672
    ds_read_b64_tr_b16 v[210:211], v13 offset:30720
    v_mfma_f32_16x16x32_bf16 v[24:27], v[164:167], v[152:155], v[24:27]
    ds_read_b64_tr_b16 v[212:213], v14 offset:28672
    ds_read_b64_tr_b16 v[214:215], v14 offset:30720
    v_mfma_f32_16x16x32_bf16 v[28:31], v[168:171], v[152:155], v[28:31]
    ds_read_b64_tr_b16 v[216:217], v15 offset:28672
    ds_read_b64_tr_b16 v[218:219], v15 offset:30720
    v_mfma_f32_16x16x32_bf16 v[36:39], v[172:175], v[152:155], v[36:39]
    ds_read_b64_tr_b16 v[220:221], v54 offset:7168
    ds_read_b64_tr_b16 v[222:223], v54 offset:7680
    s_waitcnt vmcnt(8)
    ds_read_b128 v[200:203], v11 offset:7168
    s_waitcnt lgkmcnt(11)
    v_mfma_f32_16x16x32_bf16 v[16:19], v[180:183], v[176:179], v[16:19]
    ds_read_b64_tr_b16 v[132:133], v12 offset:32768
    ds_read_b64_tr_b16 v[134:135], v12 offset:34816
    v_mfma_f32_16x16x32_bf16 v[20:23], v[184:187], v[176:179], v[20:23]
    ds_read_b64_tr_b16 v[136:137], v13 offset:32768
    ds_read_b64_tr_b16 v[138:139], v13 offset:34816
    v_mfma_f32_16x16x32_bf16 v[24:27], v[188:191], v[176:179], v[24:27]
    ds_read_b64_tr_b16 v[140:141], v14 offset:32768
    ds_read_b64_tr_b16 v[142:143], v14 offset:34816
    v_mfma_f32_16x16x32_bf16 v[28:31], v[192:195], v[176:179], v[28:31]
    ds_read_b64_tr_b16 v[144:145], v15 offset:32768
    ds_read_b64_tr_b16 v[146:147], v15 offset:34816
    v_mfma_f32_16x16x32_bf16 v[36:39], v[196:199], v[176:179], v[36:39]
    ds_read_b64_tr_b16 v[148:149], v54 offset:8192
    ds_read_b64_tr_b16 v[150:151], v54 offset:8704
    s_waitcnt vmcnt(7)
    ds_read_b128 v[128:131], v11 offset:8192
    v_add_f32 v48, v48, v52
    v_add_f32 v49, v49, v53
    v_mov_b32 v50, v48
    v_mov_b32 v51, v49
    s_nop 1
    v_permlane32_swap_b32 v48, v50
    v_permlane32_swap_b32 v49, v51
    s_nop 1
    v_add_f32 v48, v48, v50
    v_add_f32 v49, v49, v51
    v_mov_b32 v50, v48
    v_mov_b32 v51, v49
    s_nop 1
    v_permlane16_swap_b32 v48, v50
    v_permlane16_swap_b32 v49, v51
    s_nop 1
    v_add_f32 v48, v48, v50
    v_add_f32 v49, v49, v51
    v_mul_f32 v48, 0x3b000000, v48
    v_mul_f32 v49, 0x3b000000, v49
    v_fma_f32 v49, -v48, v48, v49
    v_max_f32 v49, 0, v49
    v_add_f32 v49, 0x3727c5ac, v49
    v_rsq_f32 v49, v49
    s_waitcnt lgkmcnt(11)
    v_mfma_f32_16x16x32_bf16 v[16:19], v[204:207], v[200:203], v[16:19]
    ds_read_b64_tr_b16 v[156:157], v12 offset:36864
    ds_read_b64_tr_b16 v[158:159], v12 offset:38912
    v_mfma_f32_16x16x32_bf16 v[20:23], v[208:211], v[200:203], v[20:23]
    ds_read_b64_tr_b16 v[160:161], v13 offset:36864
    ds_read_b64_tr_b16 v[162:163], v13 offset:38912
    v_mfma_f32_16x16x32_bf16 v[24:27], v[212:215], v[200:203], v[24:27]
    ds_read_b64_tr_b16 v[164:165], v14 offset:36864
    ds_read_b64_tr_b16 v[166:167], v14 offset:38912
    v_mfma_f32_16x16x32_bf16 v[28:31], v[216:219], v[200:203], v[28:31]
    ds_read_b64_tr_b16 v[168:169], v15 offset:36864
    ds_read_b64_tr_b16 v[170:171], v15 offset:38912
    v_mfma_f32_16x16x32_bf16 v[36:39], v[220:223], v[200:203], v[36:39]
    ds_read_b64_tr_b16 v[172:173], v54 offset:9216
    ds_read_b64_tr_b16 v[174:175], v54 offset:9728
    s_waitcnt vmcnt(6)
    ds_read_b128 v[152:155], v11 offset:9216
    s_waitcnt lgkmcnt(11)
    v_mfma_f32_16x16x32_bf16 v[16:19], v[132:135], v[128:131], v[16:19]
    ds_read_b64_tr_b16 v[180:181], v12 offset:40960
    ds_read_b64_tr_b16 v[182:183], v12 offset:43008
    v_mfma_f32_16x16x32_bf16 v[20:23], v[136:139], v[128:131], v[20:23]
    ds_read_b64_tr_b16 v[184:185], v13 offset:40960
    ds_read_b64_tr_b16 v[186:187], v13 offset:43008
    v_mfma_f32_16x16x32_bf16 v[24:27], v[140:143], v[128:131], v[24:27]
    ds_read_b64_tr_b16 v[188:189], v14 offset:40960
    ds_read_b64_tr_b16 v[190:191], v14 offset:43008
    v_mfma_f32_16x16x32_bf16 v[28:31], v[144:147], v[128:131], v[28:31]
    ds_read_b64_tr_b16 v[192:193], v15 offset:40960
    ds_read_b64_tr_b16 v[194:195], v15 offset:43008
    v_mfma_f32_16x16x32_bf16 v[36:39], v[148:151], v[128:131], v[36:39]
    ds_read_b64_tr_b16 v[196:197], v54 offset:10240
    ds_read_b64_tr_b16 v[198:199], v54 offset:10752
    s_waitcnt vmcnt(5)
    ds_read_b128 v[176:179], v11 offset:10240
    s_waitcnt lgkmcnt(11)
    v_mfma_f32_16x16x32_bf16 v[16:19], v[156:159], v[152:155], v[16:19]
    ds_read_b64_tr_b16 v[204:205], v12 offset:45056
    ds_read_b64_tr_b16 v[206:207], v12 offset:47104
    v_mfma_f32_16x16x32_bf16 v[20:23], v[160:163], v[152:155], v[20:23]
    ds_read_b64_tr_b16 v[208:209], v13 offset:45056
    ds_read_b64_tr_b16 v[210:211], v13 offset:47104
    v_mfma_f32_16x16x32_bf16 v[24:27], v[164:167], v[152:155], v[24:27]
    ds_read_b64_tr_b16 v[212:213], v14 offset:45056
    ds_read_b64_tr_b16 v[214:215], v14 offset:47104
    v_mfma_f32_16x16x32_bf16 v[28:31], v[168:171], v[152:155], v[28:31]
    ds_read_b64_tr_b16 v[216:217], v15 offset:45056
    ds_read_b64_tr_b16 v[218:219], v15 offset:47104
    v_mfma_f32_16x16x32_bf16 v[36:39], v[172:175], v[152:155], v[36:39]
    ds_read_b64_tr_b16 v[220:221], v54 offset:11264
    ds_read_b64_tr_b16 v[222:223], v54 offset:11776
    s_waitcnt vmcnt(4)
    ds_read_b128 v[200:203], v11 offset:11264
    s_waitcnt lgkmcnt(11)
    v_mfma_f32_16x16x32_bf16 v[16:19], v[180:183], v[176:179], v[16:19]
    ds_read_b64_tr_b16 v[132:133], v12 offset:49152
    ds_read_b64_tr_b16 v[134:135], v12 offset:51200
    v_mfma_f32_16x16x32_bf16 v[20:23], v[184:187], v[176:179], v[20:23]
    ds_read_b64_tr_b16 v[136:137], v13 offset:49152
    ds_read_b64_tr_b16 v[138:139], v13 offset:51200
    v_mfma_f32_16x16x32_bf16 v[24:27], v[188:191], v[176:179], v[24:27]
    ds_read_b64_tr_b16 v[140:141], v14 offset:49152
    ds_read_b64_tr_b16 v[142:143], v14 offset:51200
    v_mfma_f32_16x16x32_bf16 v[28:31], v[192:195], v[176:179], v[28:31]
    ds_read_b64_tr_b16 v[144:145], v15 offset:49152
    ds_read_b64_tr_b16 v[146:147], v15 offset:51200
    v_mfma_f32_16x16x32_bf16 v[36:39], v[196:199], v[176:179], v[36:39]
    ds_read_b64_tr_b16 v[148:149], v54 offset:12288
    ds_read_b64_tr_b16 v[150:151], v54 offset:12800
    s_waitcnt vmcnt(3)
    ds_read_b128 v[128:131], v11 offset:12288
    s_waitcnt lgkmcnt(11)
    v_mfma_f32_16x16x32_bf16 v[16:19], v[204:207], v[200:203], v[16:19]
    ds_read_b64_tr_b16 v[156:157], v12 offset:53248
    ds_read_b64_tr_b16 v[158:159], v12 offset:55296
    v_mfma_f32_16x16x32_bf16 v[20:23], v[208:211], v[200:203], v[20:23]
    ds_read_b64_tr_b16 v[160:161], v13 offset:53248
    ds_read_b64_tr_b16 v[162:163], v13 offset:55296
    v_mfma_f32_16x16x32_bf16 v[24:27], v[212:215], v[200:203], v[24:27]
    ds_read_b64_tr_b16 v[164:165], v14 offset:53248
    ds_read_b64_tr_b16 v[166:167], v14 offset:55296
    v_mfma_f32_16x16x32_bf16 v[28:31], v[216:219], v[200:203], v[28:31]
    ds_read_b64_tr_b16 v[168:169], v15 offset:53248
    ds_read_b64_tr_b16 v[170:171], v15 offset:55296
    v_mfma_f32_16x16x32_bf16 v[36:39], v[220:223], v[200:203], v[36:39]
    ds_read_b64_tr_b16 v[172:173], v54 offset:13312
    ds_read_b64_tr_b16 v[174:175], v54 offset:13824
    s_waitcnt vmcnt(2)
    ds_read_b128 v[152:155], v11 offset:13312
    s_waitcnt lgkmcnt(11)
    v_mfma_f32_16x16x32_bf16 v[16:19], v[132:135], v[128:131], v[16:19]
    ds_read_b64_tr_b16 v[180:181], v12 offset:57344
    ds_read_b64_tr_b16 v[182:183], v12 offset:59392
    v_mfma_f32_16x16x32_bf16 v[20:23], v[136:139], v[128:131], v[20:23]
    ds_read_b64_tr_b16 v[184:185], v13 offset:57344
    ds_read_b64_tr_b16 v[186:187], v13 offset:59392
    v_mfma_f32_16x16x32_bf16 v[24:27], v[140:143], v[128:131], v[24:27]
    ds_read_b64_tr_b16 v[188:189], v14 offset:57344
    ds_read_b64_tr_b16 v[190:191], v14 offset:59392
    v_mfma_f32_16x16x32_bf16 v[28:31], v[144:147], v[128:131], v[28:31]
    ds_read_b64_tr_b16 v[192:193], v15 offset:57344
    ds_read_b64_tr_b16 v[194:195], v15 offset:59392
    v_mfma_f32_16x16x32_bf16 v[36:39], v[148:151], v[128:131], v[36:39]
    ds_read_b64_tr_b16 v[196:197], v54 offset:14336
    ds_read_b64_tr_b16 v[198:199], v54 offset:14848
    s_waitcnt vmcnt(1)
    ds_read_b128 v[176:179], v11 offset:14336
    s_waitcnt lgkmcnt(11)
    v_mfma_f32_16x16x32_bf16 v[16:19], v[156:159], v[152:155], v[16:19]
    ds_read_b64_tr_b16 v[204:205], v12 offset:61440
    ds_read_b64_tr_b16 v[206:207], v12 offset:63488
    v_mfma_f32_16x16x32_bf16 v[20:23], v[160:163], v[152:155], v[20:23]
    ds_read_b64_tr_b16 v[208:209], v13 offset:61440
    ds_read_b64_tr_b16 v[210:211], v13 offset:63488
    v_mfma_f32_16x16x32_bf16 v[24:27], v[164:167], v[152:155], v[24:27]
    ds_read_b64_tr_b16 v[212:213], v14 offset:61440
    ds_read_b64_tr_b16 v[214:215], v14 offset:63488
    v_mfma_f32_16x16x32_bf16 v[28:31], v[168:171], v[152:155], v[28:31]
    ds_read_b64_tr_b16 v[216:217], v15 offset:61440
    ds_read_b64_tr_b16 v[218:219], v15 offset:63488
    v_mfma_f32_16x16x32_bf16 v[36:39], v[172:175], v[152:155], v[36:39]
    ds_read_b64_tr_b16 v[220:221], v54 offset:15360
    ds_read_b64_tr_b16 v[222:223], v54 offset:15872
    s_waitcnt vmcnt(0)
    ds_read_b128 v[200:203], v11 offset:15360
    s_waitcnt lgkmcnt(11)
    v_mfma_f32_16x16x32_bf16 v[16:19], v[180:183], v[176:179], v[16:19]
    v_mfma_f32_16x16x32_bf16 v[20:23], v[184:187], v[176:179], v[20:23]
    v_mfma_f32_16x16x32_bf16 v[24:27], v[188:191], v[176:179], v[24:27]
    v_mfma_f32_16x16x32_bf16 v[28:31], v[192:195], v[176:179], v[28:31]
    v_mfma_f32_16x16x32_bf16 v[36:39], v[196:199], v[176:179], v[36:39]
    s_waitcnt lgkmcnt(0)
    v_mfma_f32_16x16x32_bf16 v[16:19], v[204:207], v[200:203], v[16:19]
    v_mfma_f32_16x16x32_bf16 v[20:23], v[208:211], v[200:203], v[20:23]
    v_mfma_f32_16x16x32_bf16 v[24:27], v[212:215], v[200:203], v[24:27]
    v_mfma_f32_16x16x32_bf16 v[28:31], v[216:219], v[200:203], v[28:31]
    v_mfma_f32_16x16x32_bf16 v[36:39], v[220:223], v[200:203], v[36:39]
    s_nop 7
    s_branch qkv_epi
qkv_first:
    s_cmp_lg_u32 s65, s6
    s_cbranch_scc1 qkv_nwo_6
    s_mov_b32 m0, 151552
    s_add_u32 s55, s63, 16384
    buffer_load_dwordx4 v51, s[44:47], s63 offen lds
    s_mov_b32 m0, 152576
    s_nop 0
    buffer_load_dwordx4 v51, s[44:47], s55 offen lds
qkv_nwo_6:
    s_waitcnt vmcnt(5)
    s_barrier
    s_or_b32 s66, s2, s6
    s_cmp_lg_u32 s66, 0
    s_cbranch_scc1 noflag_7
    v_mov_b32 v16, 1
    s_mov_b64 exec, 1
    buffer_store_dword v16, off, s[96:99], 0 sc1
    s_mov_b64 exec, -1
noflag_7:
    ds_read_b128 v[128:131], v11 offset:0
    ds_read_b64_tr_b16 v[132:133], v12 offset:0
    ds_read_b64_tr_b16 v[134:135], v12 offset:2048
    ds_read_b64_tr_b16 v[136:137], v13 offset:0
    ds_read_b64_tr_b16 v[138:139], v13 offset:2048
    ds_read_b64_tr_b16 v[140:141], v14 offset:0
    ds_read_b64_tr_b16 v[142:143], v14 offset:2048
    ds_read_b64_tr_b16 v[144:145], v15 offset:0
    ds_read_b64_tr_b16 v[146:147], v15 offset:2048
    ds_read_b64_tr_b16 v[148:149], v50 offset:0
    ds_read_b64_tr_b16 v[150:151], v50 offset:512
    ds_read_b128 v[152:155], v11 offset:1024
    ds_read_b64_tr_b16 v[156:157], v12 offset:4096
    ds_read_b64_tr_b16 v[158:159], v12 offset:6144
    ds_read_b64_tr_b16 v[160:161], v13 offset:4096
    ds_read_b64_tr_b16 v[162:163], v13 offset:6144
    ds_read_b64_tr_b16 v[164:165], v14 offset:4096
    ds_read_b64_tr_b16 v[166:167], v14 offset:6144
    ds_read_b64_tr_b16 v[168:169], v15 offset:4096
    ds_read_b64_tr_b16 v[170:171], v15 offset:6144
    ds_read_b64_tr_b16 v[172:173], v50 offset:1024
    ds_read_b64_tr_b16 v[174:175], v50 offset:1536
    s_waitcnt lgkmcnt(11)
    v_mfma_f32_16x16x32_bf16 v[16:19], v[132:135], v[128:131], 0
    s_add_u32 m0, s58, 87040
    s_add_u32 s55, s53, 16384
    buffer_load_dwordx4 v126, s[24:27], s55 offen lds
    v_mfma_f32_16x16x32_bf16 v[20:23], v[136:139], v[128:131], 0
    ds_read_b128 v[176:179], v11 offset:2048
    ds_read_b64_tr_b16 v[180:181], v12 offset:8192
    ds_read_b64_tr_b16 v[182:183], v12 offset:10240
    v_mfma_f32_16x16x32_bf16 v[24:27], v[140:143], v[128:131], 0
    s_add_u32 m0, s58, 88064
    s_add_u32 s55, s53, 4096
    buffer_load_dwordx4 v126, s[24:27], s55 offen lds
    v_mfma_f32_16x16x32_bf16 v[28:31], v[144:147], v[128:131], 0
    ds_read_b64_tr_b16 v[184:185], v13 offset:8192
    ds_read_b64_tr_b16 v[186:187], v13 offset:10240
    ds_read_b64_tr_b16 v[188:189], v14 offset:8192
    v_mfma_f32_16x16x32_bf16 v[32:35], v[132:135], v[44:47], 0
    s_add_u32 m0, s58, 89088
    s_add_u32 s55, s53, 20480
    buffer_load_dwordx4 v126, s[24:27], s55 offen lds
    v_mfma_f32_16x16x32_bf16 v[36:39], v[148:151], v[128:131], 0
    ds_read_b64_tr_b16 v[190:191], v14 offset:10240
    ds_read_b64_tr_b16 v[192:193], v15 offset:8192
    ds_read_b64_tr_b16 v[194:195], v15 offset:10240
    v_mfma_f32_16x16x32_bf16 v[40:43], v[148:151], v[44:47], 0
    s_add_u32 m0, s57, 4096
    s_lshl_b32 s55, s52, 12
    buffer_load_dwordx4 v127, s[28:31], s55 offen lds
    v_mfma_f32_16x16x32_bf16 v[56:59], v[44:47], v[128:131], 0
    ds_read_b64_tr_b16 v[196:197], v50 offset:2048
    ds_read_b64_tr_b16 v[198:199], v50 offset:2560
    v_mfma_f32_16x16x32_bf16 v[60:63], v[128:131], v[128:131], 0
    s_add_u32 s52, s50, 2
    s_and_b32 s52, s52, 3
    s_lshl_b32 s54, s52, 8
    s_add_u32 m0, s59, 8192
    s_add_u32 s55, s54, 0
    buffer_load_dwordx4 v3, s[8:11], s55 offen lds
    s_waitcnt lgkmcnt(11)
    v_mfma_f32_16x16x32_bf16 v[16:19], v[156:159], v[152:155], v[16:19]
    s_add_u32 m0, s59, 9216
    s_add_u32 s55, s54, 64
    buffer_load_dwordx4 v3, s[8:11], s55 offen lds
    v_mfma_f32_16x16x32_bf16 v[20:23], v[160:163], v[152:155], v[20:23]
    ds_read_b128 v[200:203], v11 offset:3072
    ds_read_b64_tr_b16 v[204:205], v12 offset:12288
    ds_read_b64_tr_b16 v[206:207], v12 offset:14336
    v_mfma_f32_16x16x32_bf16 v[24:27], v[164:167], v[152:155], v[24:27]
    s_add_u32 m0, s59, 10240
    s_add_u32 s55, s54, 128
    buffer_load_dwordx4 v3, s[8:11], s55 offen lds
    v_mfma_f32_16x16x32_bf16 v[28:31], v[168:171], v[152:155], v[28:31]
    ds_read_b64_tr_b16 v[208:209], v13 offset:12288
    ds_read_b64_tr_b16 v[210:211], v13 offset:14336
    ds_read_b64_tr_b16 v[212:213], v14 offset:12288
    v_mfma_f32_16x16x32_bf16 v[32:35], v[156:159], v[44:47], v[32:35]
    s_add_u32 m0, s59, 11264
    s_add_u32 s55, s54, 192
    buffer_load_dwordx4 v3, s[8:11], s55 offen lds
    v_mfma_f32_16x16x32_bf16 v[36:39], v[172:175], v[152:155], v[36:39]
    ds_read_b64_tr_b16 v[214:215], v14 offset:14336
    ds_read_b64_tr_b16 v[216:217], v15 offset:12288
    ds_read_b64_tr_b16 v[218:219], v15 offset:14336
    v_mfma_f32_16x16x32_bf16 v[40:43], v[172:175], v[44:47], v[40:43]
    s_add_u32 s52, s50, 2
    s_and_b32 s52, s52, 3
    s_lshl_b32 s53, s52, 17
    s_add_u32 m0, s58, 102400
    s_add_u32 s55, s53, 0
    buffer_load_dwordx4 v126, s[24:27], s55 offen lds
    v_mfma_f32_16x16x32_bf16 v[56:59], v[44:47], v[152:155], v[56:59]
    ds_read_b64_tr_b16 v[220:221], v50 offset:3072
    ds_read_b64_tr_b16 v[222:223], v50 offset:3584
    v_mfma_f32_16x16x32_bf16 v[60:63], v[152:155], v[152:155], v[60:63]
    s_add_u32 m0, s58, 103424
    s_add_u32 s55, s53, 16384
    buffer_load_dwordx4 v126, s[24:27], s55 offen lds
    s_waitcnt vmcnt(6)
    s_barrier
    s_waitcnt lgkmcnt(11)
    v_mfma_f32_16x16x32_bf16 v[16:19], v[180:183], v[176:179], v[16:19]
    s_add_u32 m0, s58, 104448
    s_add_u32 s55, s53, 4096
    buffer_load_dwordx4 v126, s[24:27], s55 offen lds
    v_mfma_f32_16x16x32_bf16 v[20:23], v[184:187], v[176:179], v[20:23]
    ds_read_b128 v[128:131], v11 offset:4096
    ds_read_b64_tr_b16 v[132:133], v12 offset:16384
    ds_read_b64_tr_b16 v[134:135], v12 offset:18432
    v_mfma_f32_16x16x32_bf16 v[24:27], v[188:191], v[176:179], v[24:27]
    s_add_u32 m0, s58, 105472
    s_add_u32 s55, s53, 20480
    buffer_load_dwordx4 v126, s[24:27], s55 offen lds
    v_mfma_f32_16x16x32_bf16 v[28:31], v[192:195], v[176:179], v[28:31]
    ds_read_b64_tr_b16 v[136:137], v13 offset:16384
    ds_read_b64_tr_b16 v[138:139], v13 offset:18432
    ds_read_b64_tr_b16 v[140:141], v14 offset:16384
    v_mfma_f32_16x16x32_bf16 v[32:35], v[180:183], v[44:47], v[32:35]
    s_add_u32 m0, s57, 8192
    s_lshl_b32 s55, s52, 12
    buffer_load_dwordx4 v127, s[28:31], s55 offen lds
    v_mfma_f32_16x16x32_bf16 v[36:39], v[196:199], v[176:179], v[36:39]
    ds_read_b64_tr_b16 v[142:143], v14 offset:18432
    ds_read_b64_tr_b16 v[144:145], v15 offset:16384
    ds_read_b64_tr_b16 v[146:147], v15 offset:18432
    v_mfma_f32_16x16x32_bf16 v[40:43], v[196:199], v[44:47], v[40:43]
    s_add_u32 s52, s50, 3
    s_and_b32 s52, s52, 3
    s_lshl_b32 s54, s52, 8
    s_add_u32 m0, s59, 12288
    s_add_u32 s55, s54, 0
    buffer_load_dwordx4 v3, s[8:11], s55 offen lds
    v_mfma_f32_16x16x32_bf16 v[56:59], v[44:47], v[176:179], v[56:59]
    ds_read_b64_tr_b16 v[148:149], v50 offset:4096
    ds_read_b64_tr_b16 v[150:151], v50 offset:4608
    v_mfma_f32_16x16x32_bf16 v[60:63], v[176:179], v[176:179], v[60:63]
    s_add_u32 m0, s59, 13312
    s_add_u32 s55, s54, 64
    buffer_load_dwordx4 v3, s[8:11], s55 offen lds
    s_waitcnt lgkmcnt(11)
    v_mfma_f32_16x16x32_bf16 v[16:19], v[204:207], v[200:203], v[16:19]
    s_add_u32 m0, s59, 14336
    s_add_u32 s55, s54, 128
    buffer_load_dwordx4 v3, s[8:11], s55 offen lds
    v_mfma_f32_16x16x32_bf16 v[20:23], v[208:211], v[200:203], v[20:23]
    ds_read_b128 v[152:155], v11 offset:5120
    ds_read_b64_tr_b16 v[156:157], v12 offset:20480
    ds_read_b64_tr_b16 v[158:159], v12 offset:22528
    v_mfma_f32_16x16x32_bf16 v[24:27], v[212:215], v[200:203], v[24:27]
    s_add_u32 m0, s59, 15360
    s_add_u32 s55, s54, 192
    buffer_load_dwordx4 v3, s[8:11], s55 offen lds
    v_mfma_f32_16x16x32_bf16 v[28:31], v[216:219], v[200:203], v[28:31]
    ds_read_b64_tr_b16 v[160:161], v13 offset:20480
    ds_read_b64_tr_b16 v[162:163], v13 offset:22528
    ds_read_b64_tr_b16 v[164:165], v14 offset:20480
    v_mfma_f32_16x16x32_bf16 v[32:35], v[204:207], v[44:47], v[32:35]
    s_add_u32 s52, s50, 3
    s_and_b32 s52, s52, 3
    s_lshl_b32 s53, s52, 17
    s_add_u32 m0, s58, 118784
    s_add_u32 s55, s53, 0
    buffer_load_dwordx4 v126, s[24:27], s55 offen lds
    v_mfma_f32_16x16x32_bf16 v[36:39], v[220:223], v[200:203], v[36:39]
    ds_read_b64_tr_b16 v[166:167], v14 offset:22528
    ds_read_b64_tr_b16 v[168:169], v15 offset:20480
    ds_read_b64_tr_b16 v[170:171], v15 offset:22528
    v_mfma_f32_16x16x32_bf16 v[40:43], v[220:223], v[44:47], v[40:43]
    s_add_u32 m0, s58, 119808
    s_add_u32 s55, s53, 16384
    buffer_load_dwordx4 v126, s[24:27], s55 offen lds
    v_mfma_f32_16x16x32_bf16 v[56:59], v[44:47], v[200:203], v[56:59]
    ds_read_b64_tr_b16 v[172:173], v50 offset:5120
    ds_read_b64_tr_b16 v[174:175], v50 offset:5632
    v_mfma_f32_16x16x32_bf16 v[60:63], v[200:203], v[200:203], v[60:63]
    s_add_u32 m0, s58, 120832
    s_add_u32 s55, s53, 4096
    buffer_load_dwordx4 v126, s[24:27], s55 offen lds
    s_waitcnt lgkmcnt(11)
    v_mfma_f32_16x16x32_bf16 v[16:19], v[132:135], v[128:131], v[16:19]
    s_add_u32 m0, s58, 121856
    s_add_u32 s55, s53, 20480
    buffer_load_dwordx4 v126, s[24:27], s55 offen lds
    v_mfma_f32_16x16x32_bf16 v[20:23], v[136:139], v[128:131], v[20:23]
    ds_read_b128 v[176:179], v11 offset:6144
    ds_read_b64_tr_b16 v[180:181], v12 offset:24576
    ds_read_b64_tr_b16 v[182:183], v12 offset:26624
    v_mfma_f32_16x16x32_bf16 v[24:27], v[140:143], v[128:131], v[24:27]
    s_add_u32 m0, s57, 12288
    s_lshl_b32 s55, s52, 12
    buffer_load_dwordx4 v127, s[28:31], s55 offen lds
    v_mfma_f32_16x16x32_bf16 v[28:31], v[144:147], v[128:131], v[28:31]
    ds_read_b64_tr_b16 v[184:185], v13 offset:24576
    v_mfma_f32_16x16x32_bf16 v[32:35], v[132:135], v[44:47], v[32:35]
    ds_read_b64_tr_b16 v[186:187], v13 offset:26624
    v_mfma_f32_16x16x32_bf16 v[36:39], v[148:151], v[128:131], v[36:39]
    ds_read_b64_tr_b16 v[188:189], v14 offset:24576
    v_mfma_f32_16x16x32_bf16 v[40:43], v[148:151], v[44:47], v[40:43]
    ds_read_b64_tr_b16 v[190:191], v14 offset:26624
    v_mfma_f32_16x16x32_bf16 v[56:59], v[44:47], v[128:131], v[56:59]
    ds_read_b64_tr_b16 v[192:193], v15 offset:24576
    v_mfma_f32_16x16x32_bf16 v[60:63], v[128:131], v[128:131], v[60:63]
    ds_read_b64_tr_b16 v[194:195], v15 offset:26624
    ds_read_b64_tr_b16 v[196:197], v50 offset:6144
    ds_read_b64_tr_b16 v[198:199], v50 offset:6656
    s_waitcnt lgkmcnt(11)
    v_mfma_f32_16x16x32_bf16 v[16:19], v[156:159], v[152:155], v[16:19]
    ds_read_b128 v[200:203], v11 offset:7168
    ds_read_b64_tr_b16 v[204:205], v12 offset:28672
    v_mfma_f32_16x16x32_bf16 v[20:23], v[160:163], v[152:155], v[20:23]
    ds_read_b64_tr_b16 v[206:207], v12 offset:30720
    ds_read_b64_tr_b16 v[208:209], v13 offset:28672
    v_mfma_f32_16x16x32_bf16 v[24:27], v[164:167], v[152:155], v[24:27]
    ds_read_b64_tr_b16 v[210:211], v13 offset:30720
    v_mfma_f32_16x16x32_bf16 v[28:31], v[168:171], v[152:155], v[28:31]
    ds_read_b64_tr_b16 v[212:213], v14 offset:28672
    v_mfma_f32_16x16x32_bf16 v[32:35], v[156:159], v[44:47], v[32:35]
    ds_read_b64_tr_b16 v[214:215], v14 offset:30720
    v_mfma_f32_16x16x32_bf16 v[36:39], v[172:175], v[152:155], v[36:39]
    ds_read_b64_tr_b16 v[216:217], v15 offset:28672
    v_mfma_f32_16x16x32_bf16 v[40:43], v[172:175], v[44:47], v[40:43]
    ds_read_b64_tr_b16 v[218:219], v15 offset:30720
    v_mfma_f32_16x16x32_bf16 v[56:59], v[44:47], v[152:155], v[56:59]
    ds_read_b64_tr_b16 v[220:221], v50 offset:7168
    v_mfma_f32_16x16x32_bf16 v[60:63], v[152:155], v[152:155], v[60:63]
    ds_read_b64_tr_b16 v[222:223], v50 offset:7680
    s_waitcnt vmcnt(9)
    s_barrier
    s_waitcnt lgkmcnt(11)
    v_mfma_f32_16x16x32_bf16 v[16:19], v[180:183], v[176:179], v[16:19]
    ds_read_b128 v[128:131], v11 offset:8192
    ds_read_b64_tr_b16 v[132:133], v12 offset:32768
    v_mfma_f32_16x16x32_bf16 v[20:23], v[184:187], v[176:179], v[20:23]
    ds_read_b64_tr_b16 v[134:135], v12 offset:34816
    ds_read_b64_tr_b16 v[136:137], v13 offset:32768
    v_mfma_f32_16x16x32_bf16 v[24:27], v[188:191], v[176:179], v[24:27]
    ds_read_b64_tr_b16 v[138:139], v13 offset:34816
    v_mfma_f32_16x16x32_bf16 v[28:31], v[192:195], v[176:179], v[28:31]
    ds_read_b64_tr_b16 v[140:141], v14 offset:32768
    v_mfma_f32_16x16x32_bf16 v[32:35], v[180:183], v[44:47], v[32:35]
    ds_read_b64_tr_b16 v[142:143], v14 offset:34816
    v_mfma_f32_16x16x32_bf16 v[36:39], v[196:199], v[176:179], v[36:39]
    ds_read_b64_tr_b16 v[144:145], v15 offset:32768
    v_mfma_f32_16x16x32_bf16 v[40:43], v[196:199], v[44:47], v[40:43]
    ds_read_b64_tr_b16 v[146:147], v15 offset:34816
    v_mfma_f32_16x16x32_bf16 v[56:59], v[44:47], v[176:179], v[56:59]
    ds_read_b64_tr_b16 v[148:149], v50 offset:8192
    v_mfma_f32_16x16x32_bf16 v[60:63], v[176:179], v[176:179], v[60:63]
    ds_read_b64_tr_b16 v[150:151], v50 offset:8704
    s_waitcnt lgkmcnt(11)
    v_mfma_f32_16x16x32_bf16 v[16:19], v[204:207], v[200:203], v[16:19]
    ds_read_b128 v[152:155], v11 offset:9216
    ds_read_b64_tr_b16 v[156:157], v12 offset:36864
    v_mfma_f32_16x16x32_bf16 v[20:23], v[208:211], v[200:203], v[20:23]
    ds_read_b64_tr_b16 v[158:159], v12 offset:38912
    ds_read_b64_tr_b16 v[160:161], v13 offset:36864
    v_mfma_f32_16x16x32_bf16 v[24:27], v[212:215], v[200:203], v[24:27]
    ds_read_b64_tr_b16 v[162:163], v13 offset:38912
    v_mfma_f32_16x16x32_bf16 v[28:31], v[216:219], v[200:203], v[28:31]
    ds_read_b64_tr_b16 v[164:165], v14 offset:36864
    v_mfma_f32_16x16x32_bf16 v[32:35], v[204:207], v[44:47], v[32:35]
    ds_read_b64_tr_b16 v[166:167], v14 offset:38912
    v_mfma_f32_16x16x32_bf16 v[36:39], v[220:223], v[200:203], v[36:39]
    ds_read_b64_tr_b16 v[168:169], v15 offset:36864
    v_mfma_f32_16x16x32_bf16 v[40:43], v[220:223], v[44:47], v[40:43]
    ds_read_b64_tr_b16 v[170:171], v15 offset:38912
    v_mfma_f32_16x16x32_bf16 v[56:59], v[44:47], v[200:203], v[56:59]
    ds_read_b64_tr_b16 v[172:173], v50 offset:9216
    v_mfma_f32_16x16x32_bf16 v[60:63], v[200:203], v[200:203], v[60:63]
    ds_read_b64_tr_b16 v[174:175], v50 offset:9728
    s_waitcnt lgkmcnt(11)
    v_mfma_f32_16x16x32_bf16 v[16:19], v[132:135], v[128:131], v[16:19]
    ds_read_b128 v[176:179], v11 offset:10240
    ds_read_b64_tr_b16 v[180:181], v12 offset:40960
    v_mfma_f32_16x16x32_bf16 v[20:23], v[136:139], v[128:131], v[20:23]
    ds_read_b64_tr_b16 v[182:183], v12 offset:43008
    ds_read_b64_tr_b16 v[184:185], v13 offset:40960
    v_mfma_f32_16x16x32_bf16 v[24:27], v[140:143], v[128:131], v[24:27]
    ds_read_b64_tr_b16 v[186:187], v13 offset:43008
    v_mfma_f32_16x16x32_bf16 v[28:31], v[144:147], v[128:131], v[28:31]
    ds_read_b64_tr_b16 v[188:189], v14 offset:40960
    v_mfma_f32_16x16x32_bf16 v[32:35], v[132:135], v[44:47], v[32:35]
    ds_read_b64_tr_b16 v[190:191], v14 offset:43008
    v_mfma_f32_16x16x32_bf16 v[36:39], v[148:151], v[128:131], v[36:39]
    ds_read_b64_tr_b16 v[192:193], v15 offset:40960
    v_mfma_f32_16x16x32_bf16 v[40:43], v[148:151], v[44:47], v[40:43]
    ds_read_b64_tr_b16 v[194:195], v15 offset:43008
    v_mfma_f32_16x16x32_bf16 v[56:59], v[44:47], v[128:131], v[56:59]
    ds_read_b64_tr_b16 v[196:197], v50 offset:10240
    v_mfma_f32_16x16x32_bf16 v[60:63], v[128:131], v[128:131], v[60:63]
    ds_read_b64_tr_b16 v[198:199], v50 offset:10752
    s_waitcnt lgkmcnt(11)
    v_mfma_f32_16x16x32_bf16 v[16:19], v[156:159], v[152:155], v[16:19]
    ds_read_b128 v[200:203], v11 offset:11264
    ds_read_b64_tr_b16 v[204:205], v12 offset:45056
    v_mfma_f32_16x16x32_bf16 v[20:23], v[160:163], v[152:155], v[20:23]
    ds_read_b64_tr_b16 v[206:207], v12 offset:47104
    ds_read_b64_tr_b16 v[208:209], v13 offset:45056
    v_mfma_f32_16x16x32_bf16 v[24:27], v[164:167], v[152:155], v[24:27]
    ds_read_b64_tr_b16 v[210:211], v13 offset:47104
    v_mfma_f32_16x16x32_bf16 v[28:31], v[168:171], v[152:155], v[28:31]
    ds_read_b64_tr_b16 v[212:213], v14 offset:45056
    v_mfma_f32_16x16x32_bf16 v[32:35], v[156:159], v[44:47], v[32:35]
    ds_read_b64_tr_b16 v[214:215], v14 offset:47104
    v_mfma_f32_16x16x32_bf16 v[36:39], v[172:175], v[152:155], v[36:39]
    ds_read_b64_tr_b16 v[216:217], v15 offset:45056
    v_mfma_f32_16x16x32_bf16 v[40:43], v[172:175], v[44:47], v[40:43]
    ds_read_b64_tr_b16 v[218:219], v15 offset:47104
    v_mfma_f32_16x16x32_bf16 v[56:59], v[44:47], v[152:155], v[56:59]
    ds_read_b64_tr_b16 v[220:221], v50 offset:11264
    v_mfma_f32_16x16x32_bf16 v[60:63], v[152:155], v[152:155], v[60:63]
    ds_read_b64_tr_b16 v[222:223], v50 offset:11776
    s_waitcnt vmcnt(0)
    s_barrier
    s_waitcnt lgkmcnt(11)
    v_mfma_f32_16x16x32_bf16 v[16:19], v[180:183], v[176:179], v[16:19]
    ds_read_b128 v[128:131], v11 offset:12288
    ds_read_b64_tr_b16 v[132:133], v12 offset:49152
    v_mfma_f32_16x16x32_bf16 v[20:23], v[184:187], v[176:179], v[20:23]
    ds_read_b64_tr_b16 v[134:135], v12 offset:51200
    ds_read_b64_tr_b16 v[136:137], v13 offset:49152
    v_mfma_f32_16x16x32_bf16 v[24:27], v[188:191], v[176:179], v[24:27]
    ds_read_b64_tr_b16 v[138:139], v13 offset:51200
    v_mfma_f32_16x16x32_bf16 v[28:31], v[192:195], v[176:179], v[28:31]
    ds_read_b64_tr_b16 v[140:141], v14 offset:49152
    v_mfma_f32_16x16x32_bf16 v[32:35], v[180:183], v[44:47], v[32:35]
    ds_read_b64_tr_b16 v[142:143], v14 offset:51200
    v_mfma_f32_16x16x32_bf16 v[36:39], v[196:199], v[176:179], v[36:39]
    ds_read_b64_tr_b16 v[144:145], v15 offset:49152
    v_mfma_f32_16x16x32_bf16 v[40:43], v[196:199], v[44:47], v[40:43]
    ds_read_b64_tr_b16 v[146:147], v15 offset:51200
    v_mfma_f32_16x16x32_bf16 v[56:59], v[44:47], v[176:179], v[56:59]
    ds_read_b64_tr_b16 v[148:149], v50 offset:12288
    v_mfma_f32_16x16x32_bf16 v[60:63], v[176:179], v[176:179], v[60:63]
    ds_read_b64_tr_b16 v[150:151], v50 offset:12800
    s_cmp_lg_u32 s65, s6
    s_cbranch_scc1 qkv_pdone_8
    ds_read_b64_tr_b16 v[112:113], v52
    ds_read_b64_tr_b16 v[114:115], v52 offset:128
    ds_read_b64_tr_b16 v[116:117], v52 offset:32
    ds_read_b64_tr_b16 v[118:119], v52 offset:160
    s_waitcnt lgkmcnt(0)
    buffer_store_dwordx4 v[112:115], v53, s[16:19], s64 offen sc1
    buffer_store_dwordx4 v[116:119], v53, s[16:19], s64 offen offset:2048 sc1
qkv_pdone_8:
    s_waitcnt lgkmcnt(11)
    v_mfma_f32_16x16x32_bf16 v[16:19], v[204:207], v[200:203], v[16:19]
    ds_read_b128 v[152:155], v11 offset:13312
    ds_read_b64_tr_b16 v[156:157], v12 offset:53248
    v_mfma_f32_16x16x32_bf16 v[20:23], v[208:211], v[200:203], v[20:23]
    ds_read_b64_tr_b16 v[158:159], v12 offset:55296
    ds_read_b64_tr_b16 v[160:161], v13 offset:53248
    v_mfma_f32_16x16x32_bf16 v[24:27], v[212:215], v[200:203], v[24:27]
    ds_read_b64_tr_b16 v[162:163], v13 offset:55296
    v_mfma_f32_16x16x32_bf16 v[28:31], v[216:219], v[200:203], v[28:31]
    ds_read_b64_tr_b16 v[164:165], v14 offset:53248
    v_mfma_f32_16x16x32_bf16 v[32:35], v[204:207], v[44:47], v[32:35]
    ds_read_b64_tr_b16 v[166:167], v14 offset:55296
    v_mfma_f32_16x16x32_bf16 v[36:39], v[220:223], v[200:203], v[36:39]
    ds_read_b64_tr_b16 v[168:169], v15 offset:53248
    v_mfma_f32_16x16x32_bf16 v[40:43], v[220:223], v[44:47], v[40:43]
    ds_read_b64_tr_b16 v[170:171], v15 offset:55296
    v_mfma_f32_16x16x32_bf16 v[56:59], v[44:47], v[200:203], v[56:59]
    ds_read_b64_tr_b16 v[172:173], v50 offset:13312
    v_mfma_f32_16x16x32_bf16 v[60:63], v[200:203], v[200:203], v[60:63]
    ds_read_b64_tr_b16 v[174:175], v50 offset:13824
    s_cmp_lg_u32 s6, 0
    s_cbranch_scc1 w0_9
    buffer_load_dword v124, off, s[96:99], 0 sc1
w0_9:
    s_waitcnt lgkmcnt(11)
    v_mfma_f32_16x16x32_bf16 v[16:19], v[132:135], v[128:131], v[16:19]
    ds_read_b128 v[176:179], v11 offset:14336
    ds_read_b64_tr_b16 v[180:181], v12 offset:57344
    v_mfma_f32_16x16x32_bf16 v[20:23], v[136:139], v[128:131], v[20:23]
    ds_read_b64_tr_b16 v[182:183], v12 offset:59392
    ds_read_b64_tr_b16 v[184:185], v13 offset:57344
    v_mfma_f32_16x16x32_bf16 v[24:27], v[140:143], v[128:131], v[24:27]
    ds_read_b64_tr_b16 v[186:187], v13 offset:59392
    v_mfma_f32_16x16x32_bf16 v[28:31], v[144:147], v[128:131], v[28:31]
    ds_read_b64_tr_b16 v[188:189], v14 offset:57344
    v_mfma_f32_16x16x32_bf16 v[32:35], v[132:135], v[44:47], v[32:35]
    ds_read_b64_tr_b16 v[190:191], v14 offset:59392
    v_mfma_f32_16x16x32_bf16 v[36:39], v[148:151], v[128:131], v[36:39]
    ds_read_b64_tr_b16 v[192:193], v15 offset:57344
    v_mfma_f32_16x16x32_bf16 v[40:43], v[148:151], v[44:47], v[40:43]
    ds_read_b64_tr_b16 v[194:195], v15 offset:59392
    v_mfma_f32_16x16x32_bf16 v[56:59], v[44:47], v[128:131], v[56:59]
    ds_read_b64_tr_b16 v[196:197], v50 offset:14336
    v_mfma_f32_16x16x32_bf16 v[60:63], v[128:131], v[128:131], v[60:63]
    ds_read_b64_tr_b16 v[198:199], v50 offset:14848
    s_waitcnt lgkmcnt(11)
    v_mfma_f32_16x16x32_bf16 v[16:19], v[156:159], v[152:155], v[16:19]
    ds_read_b128 v[200:203], v11 offset:15360
    ds_read_b64_tr_b16 v[204:205], v12 offset:61440
    v_mfma_f32_16x16x32_bf16 v[20:23], v[160:163], v[152:155], v[20:23]
    ds_read_b64_tr_b16 v[206:207], v12 offset:63488
    ds_read_b64_tr_b16 v[208:209], v13 offset:61440
    v_mfma_f32_16x16x32_bf16 v[24:27], v[164:167], v[152:155], v[24:27]
    ds_read_b64_tr_b16 v[210:211], v13 offset:63488
    v_mfma_f32_16x16x32_bf16 v[28:31], v[168:171], v[152:155], v[28:31]
    ds_read_b64_tr_b16 v[212:213], v14 offset:61440
    v_mfma_f32_16x16x32_bf16 v[32:35], v[156:159], v[44:47], v[32:35]
    ds_read_b64_tr_b16 v[214:215], v14 offset:63488
    v_mfma_f32_16x16x32_bf16 v[36:39], v[172:175], v[152:155], v[36:39]
    ds_read_b64_tr_b16 v[216:217], v15 offset:61440
    v_mfma_f32_16x16x32_bf16 v[40:43], v[172:175], v[44:47], v[40:43]
    ds_read_b64_tr_b16 v[218:219], v15 offset:63488
    v_mfma_f32_16x16x32_bf16 v[56:59], v[44:47], v[152:155], v[56:59]
    ds_read_b64_tr_b16 v[220:221], v50 offset:15360
    v_mfma_f32_16x16x32_bf16 v[60:63], v[152:155], v[152:155], v[60:63]
    ds_read_b64_tr_b16 v[222:223], v50 offset:15872
    s_waitcnt lgkmcnt(11)
    v_mfma_f32_16x16x32_bf16 v[16:19], v[180:183], v[176:179], v[16:19]
    v_mfma_f32_16x16x32_bf16 v[20:23], v[184:187], v[176:179], v[20:23]
    v_mfma_f32_16x16x32_bf16 v[24:27], v[188:191], v[176:179], v[24:27]
    v_mfma_f32_16x16x32_bf16 v[28:31], v[192:195], v[176:179], v[28:31]
    v_mfma_f32_16x16x32_bf16 v[32:35], v[180:183], v[44:47], v[32:35]
    v_mfma_f32_16x16x32_bf16 v[36:39], v[196:199], v[176:179], v[36:39]
    v_mfma_f32_16x16x32_bf16 v[40:43], v[196:199], v[44:47], v[40:43]
    v_mfma_f32_16x16x32_bf16 v[56:59], v[44:47], v[176:179], v[56:59]
    v_mfma_f32_16x16x32_bf16 v[60:63], v[176:179], v[176:179], v[60:63]
    s_waitcnt lgkmcnt(0)
    v_mfma_f32_16x16x32_bf16 v[16:19], v[204:207], v[200:203], v[16:19]
    v_mfma_f32_16x16x32_bf16 v[20:23], v[208:211], v[200:203], v[20:23]
    v_mfma_f32_16x16x32_bf16 v[24:27], v[212:215], v[200:203], v[24:27]
    v_mfma_f32_16x16x32_bf16 v[28:31], v[216:219], v[200:203], v[28:31]
    v_mfma_f32_16x16x32_bf16 v[32:35], v[204:207], v[44:47], v[32:35]
    v_mfma_f32_16x16x32_bf16 v[36:39], v[220:223], v[200:203], v[36:39]
    v_mfma_f32_16x16x32_bf16 v[40:43], v[220:223], v[44:47], v[40:43]
    v_mfma_f32_16x16x32_bf16 v[56:59], v[44:47], v[200:203], v[56:59]
    v_mfma_f32_16x16x32_bf16 v[60:63], v[200:203], v[200:203], v[60:63]
    s_nop 3
    v_lshlrev_b32 v8, 4, v5
    s_lshl_b32 s52, s6, 6
    v_add_u32 v9, s52, v8
    v_add_u32 v9, 158208, v9
    v_add_u32 v8, 158208, v8
    s_nop 1
    ds_write_b128 v9, v[32:35]
    ds_write_b128 v9, v[32:35] offset:256
    ds_write_b128 v8, v[40:43] offset:512
    v_and_b32 v50, 3, v1
    v_cmp_eq_u32 vcc, 1, v50
    v_mul_f32 v48, 0.25, v56
    v_lshrrev_b32 v51, 2, v4
    v_cndmask_b32 v49, v60, v61, vcc
    v_cmp_eq_u32 vcc, 2, v50
    s_nop 1
    v_cndmask_b32 v49, v49, v62, vcc
    v_cmp_eq_u32 vcc, 3, v50
    s_nop 1
    v_cndmask_b32 v49, v49, v63, vcc
    v_cmp_eq_u32 vcc, v51, v5
    s_nop 1
    v_cndmask_b32 v49, 0, v49, vcc
    v_mov_b32 v50, v48
    v_mov_b32 v51, v49
    s_nop 1
    v_permlane32_swap_b32 v48, v50
    v_permlane32_swap_b32 v49, v51
    s_nop 1
    v_add_f32 v48, v48, v50
    v_add_f32 v49, v49, v51
    v_mov_b32 v50, v48
    v_mov_b32 v51, v49
    s_nop 1
    v_permlane16_swap_b32 v48, v50
    v_permlane16_swap_b32 v49, v51
    s_nop 1
    v_add_f32 v48, v48, v50
    v_add_f32 v49, v49, v51
    v_mul_f32 v48, 0x3b000000, v48
    v_mul_f32 v49, 0x3b000000, v49
    v_fma_f32 v49, -v48, v48, v49
    v_max_f32 v49, 0, v49
    v_add_f32 v49, 0x3727c5ac, v49
    v_rsq_f32 v49, v49
    s_waitcnt lgkmcnt(0)
    s_barrier
    ds_read_b128 v[68:71], v9 offset:64
    ds_read_b128 v[72:75], v9 offset:128
    ds_read_b128 v[76:79], v9 offset:192
qkv_epi:
    v_mul_f32 v50, 0x3eb8aa3b, v49
    v_fma_f32 v36, -v48, v40, v36
    v_fma_f32 v37, -v48, v41, v37
    v_fma_f32 v38, -v48, v42, v38
    v_fma_f32 v39, -v48, v43, v39
    v_mul_f32 v36, v49, v36
    v_mul_f32 v37, v49, v37
    v_mul_f32 v38, v49, v38
    v_mul_f32 v39, v49, v39
    v_cvt_pk_bf16_f32 v36, v36, v37
    v_cvt_pk_bf16_f32 v37, v38, v39
    v_lshrrev_b32 v8, 3, v6
    v_lshlrev_b32 v8, 13, v8
    v_and_b32 v9, 7, v6
    v_lshl_add_u32 v8, v9, 4, v8
    v_lshrrev_b32 v9, 1, v5
    v_lshl_add_u32 v8, v9, 7, v8
    v_and_b32 v9, 1, v5
    v_add_u32 v9, s6, v9
    v_and_b32 v12, 3, v9
    v_lshl_add_u32 v12, v12, 8, v8
    v_add_u32 v9, 2, v9
    v_and_b32 v13, 3, v9
    v_lshl_add_u32 v13, v13, 8, v8
    s_lshl_b32 s52, s49, 10
    v_fma_f32 v16, -v48, v32, v16
    v_fma_f32 v17, -v48, v33, v17
    v_fma_f32 v18, -v48, v34, v18
    v_fma_f32 v19, -v48, v35, v19
    v_mul_f32 v16, v50, v16
    v_mul_f32 v17, v50, v17
    v_mul_f32 v18, v50, v18
    v_mul_f32 v19, v50, v19
    v_cvt_pk_bf16_f32 v80, v16, v17
    v_cvt_pk_bf16_f32 v81, v18, v19
    s_waitcnt lgkmcnt(0)
    v_fma_f32 v20, -v48, v68, v20
    v_fma_f32 v21, -v48, v69, v21
    v_fma_f32 v22, -v48, v70, v22
    v_fma_f32 v23, -v48, v71, v23
    v_mul_f32 v20, v50, v20
    v_mul_f32 v21, v50, v21
    v_mul_f32 v22, v50, v22
    v_mul_f32 v23, v50, v23
    v_cvt_pk_bf16_f32 v82, v20, v21
    v_cvt_pk_bf16_f32 v83, v22, v23
    s_nop 1
    v_permlane16_swap_b32 v80, v82
    v_permlane16_swap_b32 v81, v83
    buffer_store_dwordx4 v[80:83], v12, s[12:15], s52 offen offset:0 sc1
    v_fma_f32 v24, -v48, v72, v24
    v_fma_f32 v25, -v48, v73, v25
    v_fma_f32 v26, -v48, v74, v26
    v_fma_f32 v27, -v48, v75, v27
    v_mul_f32 v24, v50, v24
    v_mul_f32 v25, v50, v25
    v_mul_f32 v26, v50, v26
    v_mul_f32 v27, v50, v27
    v_cvt_pk_bf16_f32 v84, v24, v25
    v_cvt_pk_bf16_f32 v85, v26, v27
    v_fma_f32 v28, -v48, v76, v28
    v_fma_f32 v29, -v48, v77, v29
    v_fma_f32 v30, -v48, v78, v30
    v_fma_f32 v31, -v48, v79, v31
    v_mul_f32 v28, v50, v28
    v_mul_f32 v29, v50, v29
    v_mul_f32 v30, v50, v30
    v_mul_f32 v31, v50, v31
    v_cvt_pk_bf16_f32 v86, v28, v29
    v_cvt_pk_bf16_f32 v87, v30, v31
    s_nop 1
    v_permlane16_swap_b32 v84, v86
    v_permlane16_swap_b32 v85, v87
    buffer_store_dwordx4 v[84:87], v13, s[12:15], s52 offen offset:0 sc1
    s_and_b32 s52, s49, 3
    s_cmp_lg_u32 s52, s6
    s_cbranch_scc1 qkv_kvdone_10
    s_lshr_b32 s53, s51, 5
    s_lshl_b32 s53, s53, 11
    s_add_u32 s53, s53, 2097152
    s_and_b32 s54, s51, 16
    v_and_b32 v9, 31, v1
    v_lshlrev_b32 v9, 4, v9
    v_add_u32 v12, 153600, v9
    s_cmp_lt_u32 s49, 4
    s_cbranch_scc0 qkv_v_11
    v_lshrrev_b32 v8, 1, v5
    v_lshlrev_b32 v8, 8, v8
    v_lshl_add_u32 v8, v4, 4, v8
    v_and_b32 v13, 1, v5
    v_lshl_add_u32 v8, v13, 3, v8
    v_add_u32 v8, 153600, v8
    ds_write_b64 v8, v[36:37]
    v_bfe_u32 v8, v1, 4, 1
    v_lshl_add_u32 v9, v8, 8, v9
    s_lshl_b32 s54, s54, 4
    s_branch qkv_kvst_12
qkv_v_11:
    v_lshrrev_b32 v8, 3, v4
    v_lshlrev_b32 v8, 8, v8
    v_lshl_add_u32 v8, v5, 6, v8
    v_and_b32 v13, 7, v4
    v_lshl_add_u32 v8, v13, 1, v8
    v_add_u32 v8, 153600, v8
    ds_write_b16 v8, v36
    ds_write_b16_d16_hi v8, v36 offset:16
    ds_write_b16 v8, v37 offset:32
    ds_write_b16_d16_hi v8, v37 offset:48
    s_lshl_b32 s54, s54, 5
    s_add_u32 s54, s54, 1024
qkv_kvst_12:
    s_add_u32 s53, s53, s54
    s_waitcnt lgkmcnt(0)
    ds_read_b128 v[36:39], v12
    s_waitcnt lgkmcnt(0)
    s_mov_b32 exec_hi, 0
    buffer_store_dwordx4 v[36:39], v9, s[12:15], s53 offen sc1
    s_mov_b64 exec, -1
qkv_kvdone_10:
    s_waitcnt vmcnt(0)
    s_barrier
    s_cmp_lg_u32 s6, 0
    s_cbranch_scc1 w0_13
    s_cmp_lg_u32 s3, 0
    s_cbranch_scc1 initok_14
    v_readfirstlane_b32 s64, v124
    s_cmp_lg_u32 s64, 0
    s_cbranch_scc1 initok_14
    v_lshlrev_b32 v2, 8, v1
    s_mov_b32 s65, 200000
    s_mov_b64 exec, 1
poll_15:
    buffer_load_dword v3, v2, s[96:99], s64 offen sc1
    s_sub_u32 s65, s65, 1
    s_cmp_eq_u32 s65, 0
    s_cbranch_scc1 pollout_16
    s_waitcnt vmcnt(0)
    v_cmp_gt_u32 vcc, 1, v3
    s_cbranch_vccz pollout_16
    s_sleep 1
    s_branch poll_15
pollout_16:
    s_mov_b64 exec, -1
initok_14:
    s_lshr_b32 s64, s48, 1
    s_lshl_b32 s65, s64, 8
    s_add_u32 s65, s65, s7
    v_mov_b32 v110, 1
    s_mov_b64 exec, 1
    buffer_atomic_add v110, off, s[16:19], s65 sc0 sc1
    s_mov_b64 exec, -1
w0_13:
    s_lshl_b32 s58, s4, 5
    s_add_u32 s58, s58, s5
    s_lshl_b32 s48, s58, 3
    s_lshl_b32 s49, s6, 8
    v_lshlrev_b32 v108, 4, v1
    v_and_b32 v3, 7, v1
    v_lshlrev_b32 v3, 4, v3
    v_bfe_u32 v4, v1, 3, 2
    v_lshl_add_u32 v3, v4, 8, v3
    v_lshrrev_b32 v4, 5, v1
    v_lshl_add_u32 v3, v4, 7, v3
    s_lshl_b32 s58, s58, 13
    s_lshl_b32 s55, s6, 11
    s_add_u32 s58, s58, s55
    v_add_u32 v3, s58, v3
    s_lshr_b32 s50, s48, 7
    s_lshl_b32 s50, s50, 13
    s_add_u32 s50, s50, s55
    s_add_u32 s50, s50, 2097152
    s_mul_i32 s51, s6, 2080
    v_mov_b32 v104, 0xdddddddd
    v_mov_b32 v105, v108
    v_and_b32 v2, 15, v1
    v_lshlrev_b32 v106, 4, v2
    v_lshrrev_b32 v2, 5, v1
    v_lshl_add_u32 v106, v2, 8, v106
    v_add_u32 v106, 1024, v106
    v_add_u32 v107, 512, v106
    v_and_b32 v2, 27, v1
    v_cmp_eq_u32 vcc, 16, v2
    v_mov_b32 v2, 2064
    v_mov_b32 v4, 2048
    v_and_b32 v5, 16, v1
    v_cndmask_b32 v2, v2, v4, vcc
    v_cmp_eq_u32 vcc, 0, v5
    v_mov_b32 v40, 0x3f803f80
    v_mov_b32 v41, 0x3f803f80
    v_cndmask_b32 v106, v2, v106, vcc
    v_cndmask_b32 v107, v2, v107, vcc
    v_mov_b32 v42, 0
    v_lshrrev_b32 v4, 2, v0
    v_mul_u32_u24 v4, 2080, v4
    v_and_b32 v5, 3, v0
    v_lshl_add_u32 v4, v5, 3, v4
    v_cmp_gt_u32 vcc, 2, v5
    s_nop 1
    v_cndmask_b32 v40, v42, v40, vcc
    v_cndmask_b32 v41, v42, v41, vcc
    ds_write_b64 v4, v[40:41] offset:2048
    v_lshrrev_b32 v4, 5, v0
    v_add_u32 v4, s48, v4
    v_and_b32 v5, 31, v0
    v_lshlrev_b32 v7, 10, v4
    v_lshl_add_u32 v7, v5, 4, v7
    v_lshlrev_b32 v109, 7, v1
    s_lshl_b32 s53, s6, 17
    s_add_u32 s53, s53, 15728640
    s_mul_i32 s56, s5, 98304
    s_add_u32 s56, s56, s55
    s_add_u32 s56, s56, 30408704
    s_cmp_lt_u32 s5, 29
    s_cselect_b32 s56, s56, 2130706432
    v_cmp_gt_u32 vcc, 16, v1
    v_mov_b32 v2, 2130706432
    s_nop 0
    v_cndmask_b32 v121, v2, v109, vcc
    v_lshlrev_b32 v120, 8, v0
    v_cmp_gt_u32 vcc, 16, v0
    v_mov_b32 v111, 0
    v_mov_b32 v122, 0
    v_cndmask_b32 v120, v2, v120, vcc
    v_mov_b32 v72, 0
    v_mov_b32 v73, 0
    v_mov_b32 v74, 0
    v_mov_b32 v75, 0
    v_mov_b32 v76, 0
    v_mov_b32 v77, 0
    v_mov_b32 v78, 0
    v_mov_b32 v79, 0
    v_mov_b32 v80, 0
    v_mov_b32 v81, 0
    v_mov_b32 v82, 0
    v_mov_b32 v83, 0
    v_mov_b32 v84, 0
    v_mov_b32 v85, 0
    v_mov_b32 v86, 0
    v_mov_b32 v87, 0
    v_mov_b32 v88, 0
    v_mov_b32 v89, 0
    v_mov_b32 v90, 0
    v_mov_b32 v91, 0
    v_mov_b32 v92, 0
    v_mov_b32 v93, 0
    v_mov_b32 v94, 0
    v_mov_b32 v95, 0
    v_mov_b32 v96, 0
    v_mov_b32 v97, 0
    v_mov_b32 v98, 0
    v_mov_b32 v99, 0
    v_mov_b32 v100, 0
    v_mov_b32 v101, 0
    v_mov_b32 v102, 0
    v_mov_b32 v103, 0
    v_lshrrev_b32 v167, 2, v1
    v_mul_u32_u24 v166, 2752, v167
    v_lshlrev_b32 v167, 10, v167
    v_and_b32 v160, 3, v1
    v_lshl_add_u32 v166, v160, 4, v166
    v_lshl_add_u32 v167, v160, 4, v167
    s_lshl_b32 s58, s2, 2
    s_add_u32 s58, s58, s6
    s_cmp_eq_u32 s3, 0
    s_cselect_b32 s58, s58, 4096
    s_add_u32 s59, s58, 0
    s_and_b32 s60, s59, 31
    s_mul_i32 s57, s60, 44032
    s_lshl_b32 s62, s60, 10
    s_lshr_b32 s60, s59, 5
    s_lshl_b32 s63, s60, 16
    s_add_u32 s62, s62, s63
    s_add_u32 s62, s62, 30408704
    s_add_u32 s63, s62, 32768
    s_lshl_b32 s60, s60, 6
    s_add_u32 s57, s57, s60
    s_cmp_lt_u32 s59, 1376
    s_cselect_b32 s57, s57, 2130706432
    s_cselect_b32 s62, s62, 2130706432
    s_cselect_b32 s63, s63, 2130706432
    s_add_u32 s59, s58, 1024
    s_and_b32 s60, s59, 31
    s_mul_i32 s68, s60, 44032
    s_lshl_b32 s64, s60, 10
    s_lshr_b32 s60, s59, 5
    s_lshl_b32 s65, s60, 16
    s_add_u32 s64, s64, s65
    s_add_u32 s64, s64, 30408704
    s_add_u32 s65, s64, 32768
    s_lshl_b32 s60, s60, 6
    s_add_u32 s68, s68, s60
    s_cmp_lt_u32 s59, 1376
    s_cselect_b32 s68, s68, 2130706432
    s_cselect_b32 s64, s64, 2130706432
    s_cselect_b32 s65, s65, 2130706432
    s_sub_u32 s59, s58, 336
    s_lshr_b32 s60, s59, 3
    s_lshl_b32 s69, s60, 14
    s_lshl_b32 s66, s60, 11
    s_and_b32 s60, s59, 7
    s_mul_i32 s67, s60, 176128
    s_add_u32 s66, s66, s67
    s_add_u32 s66, s66, 33554432
    s_add_u32 s67, s66, 1024
    s_lshl_b32 s60, s60, 7
    s_add_u32 s69, s69, s60
    s_cmp_lt_u32 s59, 688
    s_cselect_b32 s69, s69, 2130706432
    s_cselect_b32 s66, s66, 2130706432
    s_cselect_b32 s67, s67, 2130706432
    v_add_u32 v162, 64, v167
    s_lshl_b32 s59, s6, 11
    s_add_u32 s59, s59, 133120
    v_bfe_u32 v164, v1, 2, 2
    v_lshlrev_b32 v163, 3, v160
    v_lshl_add_u32 v163, v164, 6, v163
    v_add_u32 v163, s59, v163
    v_lshrrev_b32 v164, 5, v1
    v_bfe_u32 v165, v1, 4, 1
    v_lshl_add_u32 v160, v164, 10, v163
    v_lshl_add_u32 v160, v165, 9, v160
    v_lshl_add_u32 v161, v164, 9, v163
    v_lshl_add_u32 v161, v165, 5, v161
    v_and_b32 v4, 7, v1
    v_mul_u32_u24 v6, 1088, v4
    v_add_u32 v6, 133120, v6
    v_bfe_u32 v5, v1, 3, 2
    v_lshl_add_u32 v123, v5, 5, v6
    v_lshrrev_b32 v5, 5, v1
    v_lshl_add_u32 v123, v5, 3, v123
    v_add_u32 v123, s49, v123
    v_lshrrev_b32 v4, 4, v1
    v_lshl_add_u32 v124, v4, 5, v6
    v_bfe_u32 v2, v1, 3, 1
    v_lshl_add_u32 v124, v2, 4, v124
    v_cmp_eq_u32 vcc, 0, v2
    v_mov_b32 v2, 0xeeee
    v_mov_b32 v6, 0x4444
    v_cndmask_b32 v125, v2, v6, vcc
    v_and_b32 v2, 1, v4
    v_mul_u32_u24 v126, 8256, v2
    v_and_b32 v2, 15, v1
    v_lshl_add_u32 v126, v2, 2, v126
    v_lshl_add_u32 v126, v5, 6, v126
    s_lshl_b32 s58, s6, 9
    s_add_u32 s58, s58, 114688
    v_add_u32 v126, s58, v126
    v_lshrrev_b32 v2, 5, v0
    v_mul_u32_u24 v127, 2064, v2
    v_and_b32 v4, 31, v0
    v_lshl_add_u32 v127, v4, 5, v127
    v_add_u32 v127, 114688, v127
    v_xor_b32 v5, v2, v4
    v_and_b32 v5, 7, v5
    v_lshlrev_b32 v5, 4, v5
    v_lshl_add_u32 v5, v4, 7, v5
    v_add_u32 v5, 133120, v5
    v_lshrrev_b32 v6, 3, v0
    v_xor_b32 v2, v6, v0
    v_and_b32 v2, 7, v2
    v_lshlrev_b32 v6, 9, v6
    v_lshl_add_u32 v6, v2, 4, v6
    s_cmp_lg_u32 s6, 0
    s_cbranch_scc1 w0_17
    s_waitcnt vmcnt(0)
    v_readfirstlane_b32 s58, v110
    s_cmp_lg_u32 s58, 15
    s_cbranch_scc1 notlast_18
    s_add_u32 s59, s7, 32768
    v_mov_b32 v110, 1
    s_mov_b64 exec, 1
    buffer_atomic_add v110, off, s[16:19], s59 sc0 sc1
    s_waitcnt vmcnt(0)
    v_readfirstlane_b32 s58, v110
    v_mov_b32 v110, 16
    s_cmp_eq_u32 s58, 15
    s_cselect_b32 s59, s59, 2130706432
    buffer_store_dword v110, off, s[16:19], s59 offset:256 sc1
    s_mov_b64 exec, -1
notlast_18:
    s_lshl_b32 s59, s4, 9
    s_add_u32 s59, s59, s7
    v_lshlrev_b32 v2, 8, v1
    s_mov_b32 s60, 200000
    s_mov_b64 exec, 3
poll_19:
    v_mov_b32 v4, 0
    buffer_atomic_add v4, v2, s[16:19], s59 offen sc0 sc1
    s_sub_u32 s60, s60, 1
    s_cmp_eq_u32 s60, 0
    s_cbranch_scc1 pollout_20
    s_waitcnt vmcnt(0)
    v_cmp_gt_u32 vcc, 16, v4
    s_cbranch_vccz pollout_20
    s_sleep 1
    s_branch poll_19
pollout_20:
    s_mov_b64 exec, -1
w0_17:
    s_barrier
    buffer_load_dwordx4 v[8:11], v3, s[12:15], 0 offen offset:0
    buffer_load_dwordx4 v[12:15], v3, s[12:15], 0 offen offset:1024
    s_add_u32 m0, s51, 0
    s_xor_b32 s52, s50, 0
    buffer_load_dwordx4 v108, s[12:15], s52 offen lds
    buffer_load_dwordx4 v108, s[12:15], s52 offen offset:1024 lds
    s_add_u32 m0, s51, 8320
    s_xor_b32 s52, s50, 8192
    buffer_load_dwordx4 v108, s[12:15], s52 offen lds
    buffer_load_dwordx4 v108, s[12:15], s52 offen offset:1024 lds
    s_waitcnt vmcnt(2) lgkmcnt(0)
    s_barrier
    ds_read_b128 v[16:19], v105 offset:0
    ds_read_b128 v[24:27], v106 offset:0
    ds_read_b128 v[28:31], v107 offset:0
    s_waitcnt lgkmcnt(0)
    v_mfma_f32_32x32x16_bf16 v[40:55], v[16:19], v[8:11], 0
    s_nop 11
    v_exp_f32 v40, v40
    v_exp_f32 v41, v41
    ds_read_b128 v[20:23], v105 offset:2080
    ds_read_b128 v[32:35], v106 offset:2080
    ds_read_b128 v[36:39], v107 offset:2080
    v_exp_f32 v42, v42
    v_exp_f32 v43, v43
    v_exp_f32 v44, v44
    v_mfma_f32_32x32x16_bf16 v[56:71], v[16:19], v[12:15], 0
    v_exp_f32 v45, v45
    v_exp_f32 v46, v46
    v_exp_f32 v47, v47
    v_exp_f32 v48, v48
    v_exp_f32 v49, v49
    v_smfmac_f32_32x32x32_bf16 v[72:87], v[24:27], v[40:47], v104
    v_exp_f32 v50, v50
    v_exp_f32 v51, v51
    v_exp_f32 v52, v52
    v_exp_f32 v53, v53
    v_exp_f32 v54, v54
    v_exp_f32 v55, v55
    v_exp_f32 v56, v56
    v_exp_f32 v57, v57
    v_smfmac_f32_32x32x32_bf16 v[72:87], v[28:31], v[48:55], v104
    s_waitcnt lgkmcnt(0)
    v_exp_f32 v58, v58
    v_exp_f32 v59, v59
    v_exp_f32 v60, v60
    v_mfma_f32_32x32x16_bf16 v[40:55], v[20:23], v[8:11], 0
    v_exp_f32 v61, v61
    v_exp_f32 v62, v62
    v_exp_f32 v63, v63
    v_exp_f32 v64, v64
    v_exp_f32 v65, v65
    v_smfmac_f32_32x32x32_bf16 v[88:103], v[24:27], v[56:63], v104
    v_exp_f32 v66, v66
    v_exp_f32 v67, v67
    v_exp_f32 v68, v68
    v_exp_f32 v69, v69
    v_exp_f32 v70, v70
    v_exp_f32 v71, v71
    v_exp_f32 v40, v40
    v_exp_f32 v41, v41
    v_smfmac_f32_32x32x32_bf16 v[88:103], v[28:31], v[64:71], v104
    ds_read_b128 v[16:19], v105 offset:4160
    ds_read_b128 v[24:27], v106 offset:4160
    ds_read_b128 v[28:31], v107 offset:4160
    v_exp_f32 v42, v42
    v_exp_f32 v43, v43
    v_exp_f32 v44, v44
    v_mfma_f32_32x32x16_bf16 v[56:71], v[20:23], v[12:15], 0
    s_add_u32 s58, s7, 33024
    v_exp_f32 v45, v45
    v_exp_f32 v46, v46
    v_exp_f32 v47, v47
    v_exp_f32 v48, v48
    v_exp_f32 v49, v49
    v_smfmac_f32_32x32x32_bf16 v[72:87], v[32:35], v[40:47], v104
    s_cmp_eq_u32 s6, 0
    s_cselect_b32 s58, s58, 2130706432
    v_exp_f32 v50, v50
    v_exp_f32 v51, v51
    v_exp_f32 v52, v52
    v_exp_f32 v53, v53
    v_exp_f32 v54, v54
    v_exp_f32 v55, v55
    v_exp_f32 v56, v56
    v_exp_f32 v57, v57
    v_smfmac_f32_32x32x32_bf16 v[72:87], v[36:39], v[48:55], v104
    s_waitcnt lgkmcnt(0)
    v_exp_f32 v58, v58
    v_exp_f32 v59, v59
    v_exp_f32 v60, v60
    v_mfma_f32_32x32x16_bf16 v[40:55], v[16:19], v[8:11], 0
    v_exp_f32 v61, v61
    v_exp_f32 v62, v62
    v_exp_f32 v63, v63
    v_exp_f32 v64, v64
    v_exp_f32 v65, v65
    v_smfmac_f32_32x32x32_bf16 v[88:103], v[32:35], v[56:63], v104
    buffer_load_dword v111, off, s[16:19], s58 sc1
    v_exp_f32 v66, v66
    v_exp_f32 v67, v67
    v_exp_f32 v68, v68
    v_exp_f32 v69, v69
    v_exp_f32 v70, v70
    v_exp_f32 v71, v71
    v_exp_f32 v40, v40
    v_exp_f32 v41, v41
    v_smfmac_f32_32x32x32_bf16 v[88:103], v[36:39], v[64:71], v104
    ds_read_b128 v[20:23], v105 offset:6240
    ds_read_b128 v[32:35], v106 offset:6240
    ds_read_b128 v[36:39], v107 offset:6240
    v_exp_f32 v42, v42
    v_exp_f32 v43, v43
    v_exp_f32 v44, v44
    v_mfma_f32_32x32x16_bf16 v[56:71], v[16:19], v[12:15], 0
    v_exp_f32 v45, v45
    v_exp_f32 v46, v46
    v_exp_f32 v47, v47
    v_exp_f32 v48, v48
    v_exp_f32 v49, v49
    v_smfmac_f32_32x32x32_bf16 v[72:87], v[24:27], v[40:47], v104
    v_exp_f32 v50, v50
    v_exp_f32 v51, v51
    v_exp_f32 v52, v52
    v_exp_f32 v53, v53
    v_exp_f32 v54, v54
    v_exp_f32 v55, v55
    v_exp_f32 v56, v56
    v_exp_f32 v57, v57
    v_smfmac_f32_32x32x32_bf16 v[72:87], v[28:31], v[48:55], v104
    s_waitcnt lgkmcnt(0)
    v_exp_f32 v58, v58
    v_exp_f32 v59, v59
    v_exp_f32 v60, v60
    v_mfma_f32_32x32x16_bf16 v[40:55], v[20:23], v[8:11], 0
    v_exp_f32 v61, v61
    v_exp_f32 v62, v62
    v_exp_f32 v63, v63
    v_exp_f32 v64, v64
    v_exp_f32 v65, v65
    v_smfmac_f32_32x32x32_bf16 v[88:103], v[24:27], v[56:63], v104
    v_exp_f32 v66, v66
    v_exp_f32 v67, v67
    v_exp_f32 v68, v68
    v_exp_f32 v69, v69
    v_exp_f32 v70, v70
    v_exp_f32 v71, v71
    v_exp_f32 v40, v40
    v_exp_f32 v41, v41
    v_smfmac_f32_32x32x32_bf16 v[88:103], v[28:31], v[64:71], v104
    s_waitcnt vmcnt(0)
    s_cmp_lg_u32 s6, 0
    s_cbranch_scc1 att_cpok_21
    v_cmp_gt_u32 vcc, 16, v111
    s_and_b32 s60, vcc_lo, 0xffff
    s_cbranch_scc0 att_cpok_21
    s_add_u32 s60, s7, 33024
    v_lshlrev_b32 v110, 8, v1
    s_mov_b32 s61, 200000
    s_mov_b64 exec, 1
poll_22:
    buffer_load_dword v111, v110, s[16:19], s60 offen sc1
    s_sub_u32 s61, s61, 1
    s_cmp_eq_u32 s61, 0
    s_cbranch_scc1 pollout_23
    s_waitcnt vmcnt(0)
    v_cmp_gt_u32 vcc, 16, v111
    s_cbranch_vccz pollout_23
    s_sleep 4
    s_branch poll_22
pollout_23:
    s_mov_b64 exec, -1
att_cpok_21:
    s_barrier
    ds_read_b128 v[16:19], v105 offset:8320
    ds_read_b128 v[24:27], v106 offset:8320
    ds_read_b128 v[28:31], v107 offset:8320
    v_exp_f32 v42, v42
    v_exp_f32 v43, v43
    v_exp_f32 v44, v44
    v_mfma_f32_32x32x16_bf16 v[56:71], v[20:23], v[12:15], 0
    s_xor_b32 s52, s50, 16384
    v_exp_f32 v45, v45
    v_exp_f32 v46, v46
    v_exp_f32 v47, v47
    v_exp_f32 v48, v48
    v_exp_f32 v49, v49
    v_smfmac_f32_32x32x32_bf16 v[72:87], v[32:35], v[40:47], v104
    s_add_u32 m0, s51, 16640
    v_exp_f32 v50, v50
    v_exp_f32 v51, v51
    v_exp_f32 v52, v52
    v_exp_f32 v53, v53
    v_exp_f32 v54, v54
    v_exp_f32 v55, v55
    v_exp_f32 v56, v56
    v_exp_f32 v57, v57
    v_smfmac_f32_32x32x32_bf16 v[72:87], v[36:39], v[48:55], v104
    s_waitcnt lgkmcnt(0)
    v_exp_f32 v58, v58
    v_exp_f32 v59, v59
    v_exp_f32 v60, v60
    v_mfma_f32_32x32x16_bf16 v[40:55], v[16:19], v[8:11], 0
    v_exp_f32 v61, v61
    v_exp_f32 v62, v62
    v_exp_f32 v63, v63
    v_exp_f32 v64, v64
    v_exp_f32 v65, v65
    v_smfmac_f32_32x32x32_bf16 v[88:103], v[32:35], v[56:63], v104
    buffer_load_dwordx4 v108, s[12:15], s52 offen lds
    buffer_load_dwordx4 v108, s[12:15], s52 offen offset:1024 lds
    v_exp_f32 v66, v66
    v_exp_f32 v67, v67
    v_exp_f32 v68, v68
    v_exp_f32 v69, v69
    v_exp_f32 v70, v70
    v_exp_f32 v71, v71
    v_exp_f32 v40, v40
    v_exp_f32 v41, v41
    v_smfmac_f32_32x32x32_bf16 v[88:103], v[36:39], v[64:71], v104
    ds_read_b128 v[20:23], v105 offset:10400
    ds_read_b128 v[32:35], v106 offset:10400
    ds_read_b128 v[36:39], v107 offset:10400
    v_exp_f32 v42, v42
    v_exp_f32 v43, v43
    v_exp_f32 v44, v44
    v_mfma_f32_32x32x16_bf16 v[56:71], v[16:19], v[12:15], 0
    s_xor_b32 s52, s50, 24576
    v_exp_f32 v45, v45
    v_exp_f32 v46, v46
    v_exp_f32 v47, v47
    v_exp_f32 v48, v48
    v_exp_f32 v49, v49
    v_smfmac_f32_32x32x32_bf16 v[72:87], v[24:27], v[40:47], v104
    s_add_u32 m0, s51, 24960
    v_exp_f32 v50, v50
    v_exp_f32 v51, v51
    v_exp_f32 v52, v52
    v_exp_f32 v53, v53
    v_exp_f32 v54, v54
    v_exp_f32 v55, v55
    v_exp_f32 v56, v56
    v_exp_f32 v57, v57
    v_smfmac_f32_32x32x32_bf16 v[72:87], v[28:31], v[48:55], v104
    s_waitcnt lgkmcnt(0)
    v_exp_f32 v58, v58
    v_exp_f32 v59, v59
    v_exp_f32 v60, v60
    v_mfma_f32_32x32x16_bf16 v[40:55], v[20:23], v[8:11], 0
    v_exp_f32 v61, v61
    v_exp_f32 v62, v62
    v_exp_f32 v63, v63
    v_exp_f32 v64, v64
    v_exp_f32 v65, v65
    v_smfmac_f32_32x32x32_bf16 v[88:103], v[24:27], v[56:63], v104
    buffer_load_dwordx4 v108, s[12:15], s52 offen lds
    buffer_load_dwordx4 v108, s[12:15], s52 offen offset:1024 lds
    v_exp_f32 v66, v66
    v_exp_f32 v67, v67
    v_exp_f32 v68, v68
    v_exp_f32 v69, v69
    v_exp_f32 v70, v70
    v_exp_f32 v71, v71
    v_exp_f32 v40, v40
    v_exp_f32 v41, v41
    v_smfmac_f32_32x32x32_bf16 v[88:103], v[28:31], v[64:71], v104
    ds_read_b128 v[16:19], v105 offset:12480
    ds_read_b128 v[24:27], v106 offset:12480
    ds_read_b128 v[28:31], v107 offset:12480
    v_exp_f32 v42, v42
    v_exp_f32 v43, v43
    v_exp_f32 v44, v44
    v_mfma_f32_32x32x16_bf16 v[56:71], v[20:23], v[12:15], 0
    s_xor_b32 s52, s50, 32768
    v_exp_f32 v45, v45
    v_exp_f32 v46, v46
    v_exp_f32 v47, v47
    v_exp_f32 v48, v48
    v_exp_f32 v49, v49
    v_smfmac_f32_32x32x32_bf16 v[72:87], v[32:35], v[40:47], v104
    s_add_u32 m0, s51, 33280
    s_lshl_b32 s58, s5, 14
    v_exp_f32 v50, v50
    v_exp_f32 v51, v51
    v_exp_f32 v52, v52
    v_exp_f32 v53, v53
    v_exp_f32 v54, v54
    v_exp_f32 v55, v55
    v_exp_f32 v56, v56
    v_exp_f32 v57, v57
    v_smfmac_f32_32x32x32_bf16 v[72:87], v[36:39], v[48:55], v104
    s_waitcnt lgkmcnt(0)
    s_and_b32 s59, s6, 1
    v_exp_f32 v58, v58
    v_exp_f32 v59, v59
    v_exp_f32 v60, v60
    v_mfma_f32_32x32x16_bf16 v[40:55], v[16:19], v[8:11], 0
    s_lshl_b32 s59, s59, 13
    v_exp_f32 v61, v61
    v_exp_f32 v62, v62
    v_exp_f32 v63, v63
    v_exp_f32 v64, v64
    v_exp_f32 v65, v65
    v_smfmac_f32_32x32x32_bf16 v[88:103], v[32:35], v[56:63], v104
    s_add_u32 s58, s58, s59
    s_add_u32 s58, s58, 15728640
    buffer_load_dwordx4 v108, s[12:15], s52 offen lds
    buffer_load_dwordx4 v108, s[12:15], s52 offen offset:1024 lds
    buffer_load_dword v110, v109, s[16:19], s58 offen
    v_exp_f32 v66, v66
    v_exp_f32 v67, v67
    v_exp_f32 v68, v68
    v_exp_f32 v69, v69
    v_exp_f32 v70, v70
    v_exp_f32 v71, v71
    v_exp_f32 v40, v40
    v_exp_f32 v41, v41
    v_smfmac_f32_32x32x32_bf16 v[88:103], v[36:39], v[64:71], v104
    ds_read_b128 v[20:23], v105 offset:14560
    ds_read_b128 v[32:35], v106 offset:14560
    ds_read_b128 v[36:39], v107 offset:14560
    v_exp_f32 v42, v42
    v_exp_f32 v43, v43
    v_exp_f32 v44, v44
    v_mfma_f32_32x32x16_bf16 v[56:71], v[16:19], v[12:15], 0
    s_xor_b32 s52, s50, 40960
    v_exp_f32 v45, v45
    v_exp_f32 v46, v46
    v_exp_f32 v47, v47
    v_exp_f32 v48, v48
    v_exp_f32 v49, v49
    v_smfmac_f32_32x32x32_bf16 v[72:87], v[24:27], v[40:47], v104
    s_add_u32 m0, s51, 41600
    v_exp_f32 v50, v50
    v_exp_f32 v51, v51
    v_exp_f32 v52, v52
    v_exp_f32 v53, v53
    v_exp_f32 v54, v54
    v_exp_f32 v55, v55
    v_exp_f32 v56, v56
    v_exp_f32 v57, v57
    v_smfmac_f32_32x32x32_bf16 v[72:87], v[28:31], v[48:55], v104
    s_waitcnt lgkmcnt(0)
    v_exp_f32 v58, v58
    v_exp_f32 v59, v59
    v_exp_f32 v60, v60
    v_mfma_f32_32x32x16_bf16 v[40:55], v[20:23], v[8:11], 0
    v_exp_f32 v61, v61
    v_exp_f32 v62, v62
    v_exp_f32 v63, v63
    v_exp_f32 v64, v64
    v_exp_f32 v65, v65
    v_smfmac_f32_32x32x32_bf16 v[88:103], v[24:27], v[56:63], v104
    buffer_load_dwordx4 v108, s[12:15], s52 offen lds
    buffer_load_dwordx4 v108, s[12:15], s52 offen offset:1024 lds
    v_exp_f32 v66, v66
    v_exp_f32 v67, v67
    v_exp_f32 v68, v68
    v_exp_f32 v69, v69
    v_exp_f32 v70, v70
    v_exp_f32 v71, v71
    v_exp_f32 v40, v40
    v_exp_f32 v41, v41
    v_smfmac_f32_32x32x32_bf16 v[88:103], v[28:31], v[64:71], v104
    s_waitcnt vmcnt(7)
    s_barrier
    ds_read_b128 v[16:19], v105 offset:16640
    ds_read_b128 v[24:27], v106 offset:16640
    ds_read_b128 v[28:31], v107 offset:16640
    v_exp_f32 v42, v42
    v_exp_f32 v43, v43
    v_exp_f32 v44, v44
    v_mfma_f32_32x32x16_bf16 v[56:71], v[20:23], v[12:15], 0
    s_add_u32 m0, s55, 133120
    v_exp_f32 v45, v45
    v_exp_f32 v46, v46
    v_exp_f32 v47, v47
    v_exp_f32 v48, v48
    v_exp_f32 v49, v49
    v_smfmac_f32_32x32x32_bf16 v[72:87], v[32:35], v[40:47], v104
    v_exp_f32 v50, v50
    v_exp_f32 v51, v51
    v_exp_f32 v52, v52
    v_exp_f32 v53, v53
    v_exp_f32 v54, v54
    v_exp_f32 v55, v55
    v_exp_f32 v56, v56
    v_exp_f32 v57, v57
    v_smfmac_f32_32x32x32_bf16 v[72:87], v[36:39], v[48:55], v104
    s_waitcnt lgkmcnt(0)
    v_exp_f32 v58, v58
    v_exp_f32 v59, v59
    v_exp_f32 v60, v60
    v_mfma_f32_32x32x16_bf16 v[40:55], v[16:19], v[8:11], 0
    v_exp_f32 v61, v61
    v_exp_f32 v62, v62
    v_exp_f32 v63, v63
    v_exp_f32 v64, v64
    v_exp_f32 v65, v65
    v_smfmac_f32_32x32x32_bf16 v[88:103], v[32:35], v[56:63], v104
    buffer_load_dwordx4 v166, s[32:35], s57 offen lds
    v_exp_f32 v66, v66
    v_exp_f32 v67, v67
    v_exp_f32 v68, v68
    v_exp_f32 v69, v69
    v_exp_f32 v70, v70
    v_exp_f32 v71, v71
    v_exp_f32 v40, v40
    v_exp_f32 v41, v41
    v_smfmac_f32_32x32x32_bf16 v[88:103], v[36:39], v[64:71], v104
    ds_read_b128 v[20:23], v105 offset:18720
    ds_read_b128 v[32:35], v106 offset:18720
    ds_read_b128 v[36:39], v107 offset:18720
    v_exp_f32 v42, v42
    v_exp_f32 v43, v43
    v_exp_f32 v44, v44
    v_mfma_f32_32x32x16_bf16 v[56:71], v[16:19], v[12:15], 0
    s_add_u32 m0, s55, 134144
    v_exp_f32 v45, v45
    v_exp_f32 v46, v46
    v_exp_f32 v47, v47
    v_exp_f32 v48, v48
    v_exp_f32 v49, v49
    v_smfmac_f32_32x32x32_bf16 v[72:87], v[24:27], v[40:47], v104
    s_add_u32 s54, s53, 0
    v_exp_f32 v50, v50
    v_exp_f32 v51, v51
    v_exp_f32 v52, v52
    v_exp_f32 v53, v53
    v_exp_f32 v54, v54
    v_exp_f32 v55, v55
    v_exp_f32 v56, v56
    v_exp_f32 v57, v57
    v_smfmac_f32_32x32x32_bf16 v[72:87], v[28:31], v[48:55], v104
    s_waitcnt lgkmcnt(0)
    v_exp_f32 v58, v58
    v_exp_f32 v59, v59
    v_exp_f32 v60, v60
    v_mfma_f32_32x32x16_bf16 v[40:55], v[20:23], v[8:11], 0
    v_exp_f32 v61, v61
    v_exp_f32 v62, v62
    v_exp_f32 v63, v63
    v_exp_f32 v64, v64
    v_exp_f32 v65, v65
    v_smfmac_f32_32x32x32_bf16 v[88:103], v[24:27], v[56:63], v104
    buffer_load_dwordx4 v166, s[36:39], s57 offen lds
    buffer_load_dwordx4 a[0:3], v108, s[16:19], s54 offen offset:0
    buffer_load_dwordx4 a[4:7], v108, s[16:19], s54 offen offset:1024
    v_exp_f32 v66, v66
    v_exp_f32 v67, v67
    v_exp_f32 v68, v68
    v_exp_f32 v69, v69
    v_exp_f32 v70, v70
    v_exp_f32 v71, v71
    v_exp_f32 v40, v40
    v_exp_f32 v41, v41
    v_smfmac_f32_32x32x32_bf16 v[88:103], v[28:31], v[64:71], v104
    ds_read_b128 v[16:19], v105 offset:20800
    ds_read_b128 v[24:27], v106 offset:20800
    ds_read_b128 v[28:31], v107 offset:20800
    v_exp_f32 v42, v42
    v_exp_f32 v43, v43
    v_exp_f32 v44, v44
    v_mfma_f32_32x32x16_bf16 v[56:71], v[20:23], v[12:15], 0
    s_add_u32 m0, s55, 141824
    v_exp_f32 v45, v45
    v_exp_f32 v46, v46
    v_exp_f32 v47, v47
    v_exp_f32 v48, v48
    v_exp_f32 v49, v49
    v_smfmac_f32_32x32x32_bf16 v[72:87], v[32:35], v[40:47], v104
    v_exp_f32 v50, v50
    v_exp_f32 v51, v51
    v_exp_f32 v52, v52
    v_exp_f32 v53, v53
    v_exp_f32 v54, v54
    v_exp_f32 v55, v55
    v_exp_f32 v56, v56
    v_exp_f32 v57, v57
    v_smfmac_f32_32x32x32_bf16 v[72:87], v[36:39], v[48:55], v104
    s_waitcnt lgkmcnt(0)
    v_exp_f32 v58, v58
    v_exp_f32 v59, v59
    v_exp_f32 v60, v60
    v_mfma_f32_32x32x16_bf16 v[40:55], v[16:19], v[8:11], 0
    v_exp_f32 v61, v61
    v_exp_f32 v62, v62
    v_exp_f32 v63, v63
    v_exp_f32 v64, v64
    v_exp_f32 v65, v65
    v_smfmac_f32_32x32x32_bf16 v[88:103], v[32:35], v[56:63], v104
    buffer_load_dwordx4 v166, s[32:35], s68 offen lds
    buffer_load_dwordx4 a[8:11], v108, s[16:19], s54 offen offset:2048
    buffer_load_dwordx4 a[12:15], v108, s[16:19], s54 offen offset:3072
    v_exp_f32 v66, v66
    v_exp_f32 v67, v67
    v_exp_f32 v68, v68
    v_exp_f32 v69, v69
    v_exp_f32 v70, v70
    v_exp_f32 v71, v71
    v_exp_f32 v40, v40
    v_exp_f32 v41, v41
    v_smfmac_f32_32x32x32_bf16 v[88:103], v[36:39], v[64:71], v104
    ds_read_b128 v[20:23], v105 offset:22880
    ds_read_b128 v[32:35], v106 offset:22880
    ds_read_b128 v[36:39], v107 offset:22880
    v_exp_f32 v42, v42
    v_exp_f32 v43, v43
    v_exp_f32 v44, v44
    v_mfma_f32_32x32x16_bf16 v[56:71], v[16:19], v[12:15], 0
    s_xor_b32 s52, s50, 49152
    v_exp_f32 v45, v45
    v_exp_f32 v46, v46
    v_exp_f32 v47, v47
    v_exp_f32 v48, v48
    v_exp_f32 v49, v49
    v_smfmac_f32_32x32x32_bf16 v[72:87], v[24:27], v[40:47], v104
    s_add_u32 m0, s51, 49920
    s_add_u32 s54, s53, 4096
    v_exp_f32 v50, v50
    v_exp_f32 v51, v51
    v_exp_f32 v52, v52
    v_exp_f32 v53, v53
    v_exp_f32 v54, v54
    v_exp_f32 v55, v55
    v_exp_f32 v56, v56
    v_exp_f32 v57, v57
    v_smfmac_f32_32x32x32_bf16 v[72:87], v[28:31], v[48:55], v104
    s_waitcnt lgkmcnt(0)
    v_exp_f32 v58, v58
    v_exp_f32 v59, v59
    v_exp_f32 v60, v60
    v_mfma_f32_32x32x16_bf16 v[40:55], v[20:23], v[8:11], 0
    v_exp_f32 v61, v61
    v_exp_f32 v62, v62
    v_exp_f32 v63, v63
    v_exp_f32 v64, v64
    v_exp_f32 v65, v65
    v_smfmac_f32_32x32x32_bf16 v[88:103], v[24:27], v[56:63], v104
    buffer_load_dwordx4 v108, s[12:15], s52 offen lds
    buffer_load_dwordx4 v108, s[12:15], s52 offen offset:1024 lds
    buffer_load_dwordx4 a[16:19], v108, s[16:19], s54 offen offset:0
    v_exp_f32 v66, v66
    v_exp_f32 v67, v67
    v_exp_f32 v68, v68
    v_exp_f32 v69, v69
    v_exp_f32 v70, v70
    v_exp_f32 v71, v71
    v_exp_f32 v40, v40
    v_exp_f32 v41, v41
    v_smfmac_f32_32x32x32_bf16 v[88:103], v[28:31], v[64:71], v104
    s_waitcnt vmcnt(15)
    s_barrier
    ds_read_b128 v[16:19], v105 offset:24960
    ds_read_b128 v[24:27], v106 offset:24960
    ds_read_b128 v[28:31], v107 offset:24960
    v_exp_f32 v42, v42
    v_exp_f32 v43, v43
    v_exp_f32 v44, v44
    v_mfma_f32_32x32x16_bf16 v[56:71], v[20:23], v[12:15], 0
    s_add_u32 m0, s55, 142848
    v_exp_f32 v45, v45
    v_exp_f32 v46, v46
    v_exp_f32 v47, v47
    v_exp_f32 v48, v48
    v_exp_f32 v49, v49
    v_smfmac_f32_32x32x32_bf16 v[72:87], v[32:35], v[40:47], v104
    v_exp_f32 v50, v50
    v_exp_f32 v51, v51
    v_exp_f32 v52, v52
    v_exp_f32 v53, v53
    v_exp_f32 v54, v54
    v_exp_f32 v55, v55
    v_exp_f32 v56, v56
    v_exp_f32 v57, v57
    v_smfmac_f32_32x32x32_bf16 v[72:87], v[36:39], v[48:55], v104
    s_waitcnt lgkmcnt(0)
    v_exp_f32 v58, v58
    v_exp_f32 v59, v59
    v_exp_f32 v60, v60
    v_mfma_f32_32x32x16_bf16 v[40:55], v[16:19], v[8:11], 0
    v_exp_f32 v61, v61
    v_exp_f32 v62, v62
    v_exp_f32 v63, v63
    v_exp_f32 v64, v64
    v_exp_f32 v65, v65
    v_smfmac_f32_32x32x32_bf16 v[88:103], v[32:35], v[56:63], v104
    buffer_load_dwordx4 v166, s[36:39], s68 offen lds
    buffer_load_dwordx4 a[20:23], v108, s[16:19], s54 offen offset:1024
    buffer_load_dwordx4 a[24:27], v108, s[16:19], s54 offen offset:2048
    v_exp_f32 v66, v66
    v_exp_f32 v67, v67
    v_exp_f32 v68, v68
    v_exp_f32 v69, v69
    v_exp_f32 v70, v70
    v_exp_f32 v71, v71
    v_exp_f32 v40, v40
    v_exp_f32 v41, v41
    v_smfmac_f32_32x32x32_bf16 v[88:103], v[36:39], v[64:71], v104
    ds_read_b128 v[20:23], v105 offset:27040
    ds_read_b128 v[32:35], v106 offset:27040
    ds_read_b128 v[36:39], v107 offset:27040
    v_exp_f32 v42, v42
    v_exp_f32 v43, v43
    v_exp_f32 v44, v44
    v_mfma_f32_32x32x16_bf16 v[56:71], v[16:19], v[12:15], 0
    s_add_u32 m0, s55, 150016
    v_exp_f32 v45, v45
    v_exp_f32 v46, v46
    v_exp_f32 v47, v47
    v_exp_f32 v48, v48
    v_exp_f32 v49, v49
    v_smfmac_f32_32x32x32_bf16 v[72:87], v[24:27], v[40:47], v104
    v_exp_f32 v50, v50
    v_exp_f32 v51, v51
    v_exp_f32 v52, v52
    v_exp_f32 v53, v53
    v_exp_f32 v54, v54
    v_exp_f32 v55, v55
    v_exp_f32 v56, v56
    v_exp_f32 v57, v57
    v_smfmac_f32_32x32x32_bf16 v[72:87], v[28:31], v[48:55], v104
    s_waitcnt lgkmcnt(0)
    v_exp_f32 v58, v58
    v_exp_f32 v59, v59
    v_exp_f32 v60, v60
    v_mfma_f32_32x32x16_bf16 v[40:55], v[20:23], v[8:11], 0
    v_exp_f32 v61, v61
    v_exp_f32 v62, v62
    v_exp_f32 v63, v63
    v_exp_f32 v64, v64
    v_exp_f32 v65, v65
    v_smfmac_f32_32x32x32_bf16 v[88:103], v[24:27], v[56:63], v104
    buffer_load_dwordx4 v167, s[40:43], s69 offen lds
    buffer_load_dwordx4 a[28:31], v108, s[16:19], s54 offen offset:3072
    v_exp_f32 v66, v66
    v_exp_f32 v67, v67
    v_exp_f32 v68, v68
    v_exp_f32 v69, v69
    v_exp_f32 v70, v70
    v_exp_f32 v71, v71
    v_exp_f32 v40, v40
    v_exp_f32 v41, v41
    v_smfmac_f32_32x32x32_bf16 v[88:103], v[28:31], v[64:71], v104
    ds_read_b128 v[16:19], v105 offset:29120
    ds_read_b128 v[24:27], v106 offset:29120
    ds_read_b128 v[28:31], v107 offset:29120
    v_exp_f32 v42, v42
    v_exp_f32 v43, v43
    v_exp_f32 v44, v44
    v_mfma_f32_32x32x16_bf16 v[56:71], v[20:23], v[12:15], 0
    s_add_u32 m0, s55, 151040
    v_exp_f32 v45, v45
    v_exp_f32 v46, v46
    v_exp_f32 v47, v47
    v_exp_f32 v48, v48
    v_exp_f32 v49, v49
    v_smfmac_f32_32x32x32_bf16 v[72:87], v[32:35], v[40:47], v104
    s_add_u32 s54, s53, 8192
    v_exp_f32 v50, v50
    v_exp_f32 v51, v51
    v_exp_f32 v52, v52
    v_exp_f32 v53, v53
    v_exp_f32 v54, v54
    v_exp_f32 v55, v55
    v_exp_f32 v56, v56
    v_exp_f32 v57, v57
    v_smfmac_f32_32x32x32_bf16 v[72:87], v[36:39], v[48:55], v104
    s_waitcnt lgkmcnt(0)
    v_exp_f32 v58, v58
    v_exp_f32 v59, v59
    v_exp_f32 v60, v60
    v_mfma_f32_32x32x16_bf16 v[40:55], v[16:19], v[8:11], 0
    v_exp_f32 v61, v61
    v_exp_f32 v62, v62
    v_exp_f32 v63, v63
    v_exp_f32 v64, v64
    v_exp_f32 v65, v65
    v_smfmac_f32_32x32x32_bf16 v[88:103], v[32:35], v[56:63], v104
    buffer_load_dwordx4 v162, s[40:43], s69 offen lds
    buffer_load_dwordx4 a[32:35], v108, s[16:19], s54 offen offset:0
    buffer_load_dwordx4 a[36:39], v108, s[16:19], s54 offen offset:1024
    buffer_load_dwordx4 a[40:43], v108, s[16:19], s54 offen offset:2048
    v_exp_f32 v66, v66
    v_exp_f32 v67, v67
    v_exp_f32 v68, v68
    v_exp_f32 v69, v69
    v_exp_f32 v70, v70
    v_exp_f32 v71, v71
    v_exp_f32 v40, v40
    v_exp_f32 v41, v41
    v_smfmac_f32_32x32x32_bf16 v[88:103], v[36:39], v[64:71], v104
    ds_read_b128 v[20:23], v105 offset:31200
    ds_read_b128 v[32:35], v106 offset:31200
    ds_read_b128 v[36:39], v107 offset:31200
    v_exp_f32 v42, v42
    v_exp_f32 v43, v43
    v_exp_f32 v44, v44
    v_mfma_f32_32x32x16_bf16 v[56:71], v[16:19], v[12:15], 0
    s_xor_b32 s52, s50, 57344
    v_exp_f32 v45, v45
    v_exp_f32 v46, v46
    v_exp_f32 v47, v47
    v_exp_f32 v48, v48
    v_exp_f32 v49, v49
    v_smfmac_f32_32x32x32_bf16 v[72:87], v[24:27], v[40:47], v104
    s_add_u32 m0, s51, 58240
    v_exp_f32 v50, v50
    v_exp_f32 v51, v51
    v_exp_f32 v52, v52
    v_exp_f32 v53, v53
    v_exp_f32 v54, v54
    v_exp_f32 v55, v55
    v_exp_f32 v56, v56
    v_exp_f32 v57, v57
    v_smfmac_f32_32x32x32_bf16 v[72:87], v[28:31], v[48:55], v104
    s_waitcnt lgkmcnt(0)
    v_exp_f32 v58, v58
    v_exp_f32 v59, v59
    v_exp_f32 v60, v60
    v_mfma_f32_32x32x16_bf16 v[40:55], v[20:23], v[8:11], 0
    v_exp_f32 v61, v61
    v_exp_f32 v62, v62
    v_exp_f32 v63, v63
    v_exp_f32 v64, v64
    v_exp_f32 v65, v65
    v_smfmac_f32_32x32x32_bf16 v[88:103], v[24:27], v[56:63], v104
    buffer_load_dwordx4 v108, s[12:15], s52 offen lds
    buffer_load_dwordx4 v108, s[12:15], s52 offen offset:1024 lds
    buffer_load_dwordx4 a[44:47], v108, s[16:19], s54 offen offset:3072
    v_exp_f32 v66, v66
    v_exp_f32 v67, v67
    v_exp_f32 v68, v68
    v_exp_f32 v69, v69
    v_exp_f32 v70, v70
    v_exp_f32 v71, v71
    v_exp_f32 v40, v40
    v_exp_f32 v41, v41
    v_smfmac_f32_32x32x32_bf16 v[88:103], v[28:31], v[64:71], v104
    s_waitcnt vmcnt(22)
    s_barrier
    ds_read_b128 v[16:19], v105 offset:33280
    ds_read_b128 v[24:27], v106 offset:33280
    ds_read_b128 v[28:31], v107 offset:33280
    v_exp_f32 v42, v42
    v_exp_f32 v43, v43
    v_exp_f32 v44, v44
    v_mfma_f32_32x32x16_bf16 v[56:71], v[20:23], v[12:15], 0
    s_add_u32 s52, s53, 102400
    v_exp_f32 v45, v45
    v_exp_f32 v46, v46
    v_exp_f32 v47, v47
    v_exp_f32 v48, v48
    v_exp_f32 v49, v49
    v_smfmac_f32_32x32x32_bf16 v[72:87], v[32:35], v[40:47], v104
    s_add_u32 m0, s55, 0
    s_add_u32 s54, s53, 12288
    v_exp_f32 v50, v50
    v_exp_f32 v51, v51
    v_exp_f32 v52, v52
    v_exp_f32 v53, v53
    v_exp_f32 v54, v54
    v_exp_f32 v55, v55
    v_exp_f32 v56, v56
    v_exp_f32 v57, v57
    v_smfmac_f32_32x32x32_bf16 v[72:87], v[36:39], v[48:55], v104
    s_waitcnt lgkmcnt(0)
    v_exp_f32 v58, v58
    v_exp_f32 v59, v59
    v_exp_f32 v60, v60
    v_mfma_f32_32x32x16_bf16 v[40:55], v[16:19], v[8:11], 0
    v_exp_f32 v61, v61
    v_exp_f32 v62, v62
    v_exp_f32 v63, v63
    v_exp_f32 v64, v64
    v_exp_f32 v65, v65
    v_smfmac_f32_32x32x32_bf16 v[88:103], v[32:35], v[56:63], v104
    buffer_load_dwordx4 v108, s[16:19], s52 offen lds
    buffer_load_dwordx4 v108, s[16:19], s52 offen offset:1024 lds
    buffer_load_dwordx4 a[48:51], v108, s[16:19], s54 offen offset:0
    buffer_load_dwordx4 a[52:55], v108, s[16:19], s54 offen offset:1024
    v_exp_f32 v66, v66
    v_exp_f32 v67, v67
    v_exp_f32 v68, v68
    v_exp_f32 v69, v69
    v_exp_f32 v70, v70
    v_exp_f32 v71, v71
    v_exp_f32 v40, v40
    v_exp_f32 v41, v41
    v_smfmac_f32_32x32x32_bf16 v[88:103], v[36:39], v[64:71], v104
    ds_read_b128 v[20:23], v105 offset:35360
    ds_read_b128 v[32:35], v106 offset:35360
    ds_read_b128 v[36:39], v107 offset:35360
    v_exp_f32 v42, v42
    v_exp_f32 v43, v43
    v_exp_f32 v44, v44
    v_mfma_f32_32x32x16_bf16 v[56:71], v[16:19], v[12:15], 0
    v_exp_f32 v45, v45
    v_exp_f32 v46, v46
    v_exp_f32 v47, v47
    v_exp_f32 v48, v48
    v_exp_f32 v49, v49
    v_smfmac_f32_32x32x32_bf16 v[72:87], v[24:27], v[40:47], v104
    v_exp_f32 v50, v50
    v_exp_f32 v51, v51
    v_exp_f32 v52, v52
    v_exp_f32 v53, v53
    v_exp_f32 v54, v54
    v_exp_f32 v55, v55
    v_exp_f32 v56, v56
    v_exp_f32 v57, v57
    v_smfmac_f32_32x32x32_bf16 v[72:87], v[28:31], v[48:55], v104
    s_waitcnt lgkmcnt(0)
    v_exp_f32 v58, v58
    v_exp_f32 v59, v59
    v_exp_f32 v60, v60
    v_mfma_f32_32x32x16_bf16 v[40:55], v[20:23], v[8:11], 0
    v_exp_f32 v61, v61
    v_exp_f32 v62, v62
    v_exp_f32 v63, v63
    v_exp_f32 v64, v64
    v_exp_f32 v65, v65
    v_smfmac_f32_32x32x32_bf16 v[88:103], v[24:27], v[56:63], v104
    buffer_load_dwordx4 a[56:59], v108, s[16:19], s54 offen offset:2048
    buffer_load_dwordx4 a[60:63], v108, s[16:19], s54 offen offset:3072
    v_exp_f32 v66, v66
    v_exp_f32 v67, v67
    v_exp_f32 v68, v68
    v_exp_f32 v69, v69
    v_exp_f32 v70, v70
    v_exp_f32 v71, v71
    v_exp_f32 v40, v40
    v_exp_f32 v41, v41
    v_smfmac_f32_32x32x32_bf16 v[88:103], v[28:31], v[64:71], v104
    ds_read_b128 v[16:19], v105 offset:37440
    ds_read_b128 v[24:27], v106 offset:37440
    ds_read_b128 v[28:31], v107 offset:37440
    v_exp_f32 v42, v42
    v_exp_f32 v43, v43
    v_exp_f32 v44, v44
    v_mfma_f32_32x32x16_bf16 v[56:71], v[20:23], v[12:15], 0
    s_add_u32 s52, s53, 104448
    v_exp_f32 v45, v45
    v_exp_f32 v46, v46
    v_exp_f32 v47, v47
    v_exp_f32 v48, v48
    v_exp_f32 v49, v49
    v_smfmac_f32_32x32x32_bf16 v[72:87], v[32:35], v[40:47], v104
    s_add_u32 m0, s55, 8192
    s_add_u32 s54, s53, 16384
    v_exp_f32 v50, v50
    v_exp_f32 v51, v51
    v_exp_f32 v52, v52
    v_exp_f32 v53, v53
    v_exp_f32 v54, v54
    v_exp_f32 v55, v55
    v_exp_f32 v56, v56
    v_exp_f32 v57, v57
    v_smfmac_f32_32x32x32_bf16 v[72:87], v[36:39], v[48:55], v104
    s_waitcnt lgkmcnt(0)
    v_exp_f32 v58, v58
    v_exp_f32 v59, v59
    v_exp_f32 v60, v60
    v_mfma_f32_32x32x16_bf16 v[40:55], v[16:19], v[8:11], 0
    v_exp_f32 v61, v61
    v_exp_f32 v62, v62
    v_exp_f32 v63, v63
    v_exp_f32 v64, v64
    v_exp_f32 v65, v65
    v_smfmac_f32_32x32x32_bf16 v[88:103], v[32:35], v[56:63], v104
    buffer_load_dwordx4 v108, s[16:19], s52 offen lds
    buffer_load_dwordx4 v108, s[16:19], s52 offen offset:1024 lds
    buffer_load_dwordx4 a[64:67], v108, s[16:19], s54 offen offset:0
    buffer_load_dwordx4 a[68:71], v108, s[16:19], s54 offen offset:1024
    v_exp_f32 v66, v66
    v_exp_f32 v67, v67
    v_exp_f32 v68, v68
    v_exp_f32 v69, v69
    v_exp_f32 v70, v70
    v_exp_f32 v71, v71
    v_exp_f32 v40, v40
    v_exp_f32 v41, v41
    v_smfmac_f32_32x32x32_bf16 v[88:103], v[36:39], v[64:71], v104
    ds_read_b128 v[20:23], v105 offset:39520
    ds_read_b128 v[32:35], v106 offset:39520
    ds_read_b128 v[36:39], v107 offset:39520
    s_waitcnt vmcnt(30)
    ds_read_b64_tr_b16 v[128:129], v160 offset:0
    ds_read_b64_tr_b16 v[130:131], v160 offset:256
    ds_read_b64_tr_b16 v[132:133], v160 offset:32
    ds_read_b64_tr_b16 v[134:135], v160 offset:288
    v_exp_f32 v42, v42
    v_exp_f32 v43, v43
    v_exp_f32 v44, v44
    v_mfma_f32_32x32x16_bf16 v[56:71], v[16:19], v[12:15], 0
    s_xor_b32 s52, s50, 65536
    v_exp_f32 v45, v45
    v_exp_f32 v46, v46
    v_exp_f32 v47, v47
    v_exp_f32 v48, v48
    v_exp_f32 v49, v49
    v_smfmac_f32_32x32x32_bf16 v[72:87], v[24:27], v[40:47], v104
    s_add_u32 m0, s51, 66560
    v_exp_f32 v50, v50
    v_exp_f32 v51, v51
    v_exp_f32 v52, v52
    v_exp_f32 v53, v53
    v_exp_f32 v54, v54
    v_exp_f32 v55, v55
    v_exp_f32 v56, v56
    v_exp_f32 v57, v57
    v_smfmac_f32_32x32x32_bf16 v[72:87], v[28:31], v[48:55], v104
    s_waitcnt lgkmcnt(0)
    v_exp_f32 v58, v58
    v_exp_f32 v59, v59
    v_exp_f32 v60, v60
    v_mfma_f32_32x32x16_bf16 v[40:55], v[20:23], v[8:11], 0
    v_exp_f32 v61, v61
    v_exp_f32 v62, v62
    v_exp_f32 v63, v63
    v_exp_f32 v64, v64
    v_exp_f32 v65, v65
    v_smfmac_f32_32x32x32_bf16 v[88:103], v[24:27], v[56:63], v104
    buffer_load_dwordx4 v108, s[12:15], s52 offen lds
    buffer_load_dwordx4 v108, s[12:15], s52 offen offset:1024 lds
    buffer_store_dwordx4 v[128:131], v108, s[16:19], s62 offen sc1
    buffer_load_dwordx4 a[72:75], v108, s[16:19], s54 offen offset:2048
    v_exp_f32 v66, v66
    v_exp_f32 v67, v67
    v_exp_f32 v68, v68
    v_exp_f32 v69, v69
    v_exp_f32 v70, v70
    v_exp_f32 v71, v71
    v_exp_f32 v40, v40
    v_exp_f32 v41, v41
    v_smfmac_f32_32x32x32_bf16 v[88:103], v[28:31], v[64:71], v104
    ds_read_b128 v[16:19], v105 offset:41600
    ds_read_b128 v[24:27], v106 offset:41600
    ds_read_b128 v[28:31], v107 offset:41600
    s_waitcnt vmcnt(25)
    ds_read_b64_tr_b16 v[136:137], v160 offset:8704
    ds_read_b64_tr_b16 v[138:139], v160 offset:8960
    ds_read_b64_tr_b16 v[140:141], v160 offset:8736
    ds_read_b64_tr_b16 v[142:143], v160 offset:8992
    v_exp_f32 v42, v42
    v_exp_f32 v43, v43
    v_exp_f32 v44, v44
    v_mfma_f32_32x32x16_bf16 v[56:71], v[20:23], v[12:15], 0
    s_add_u32 s52, s53, 106496
    v_exp_f32 v45, v45
    v_exp_f32 v46, v46
    v_exp_f32 v47, v47
    v_exp_f32 v48, v48
    v_exp_f32 v49, v49
    v_smfmac_f32_32x32x32_bf16 v[72:87], v[32:35], v[40:47], v104
    s_add_u32 m0, s55, 16384
    v_exp_f32 v50, v50
    v_exp_f32 v51, v51
    v_exp_f32 v52, v52
    v_exp_f32 v53, v53
    v_exp_f32 v54, v54
    v_exp_f32 v55, v55
    v_exp_f32 v56, v56
    v_exp_f32 v57, v57
    v_smfmac_f32_32x32x32_bf16 v[72:87], v[36:39], v[48:55], v104
    s_waitcnt lgkmcnt(0)
    v_exp_f32 v58, v58
    v_exp_f32 v59, v59
    v_exp_f32 v60, v60
    v_mfma_f32_32x32x16_bf16 v[40:55], v[16:19], v[8:11], 0
    v_exp_f32 v61, v61
    v_exp_f32 v62, v62
    v_exp_f32 v63, v63
    v_exp_f32 v64, v64
    v_exp_f32 v65, v65
    v_smfmac_f32_32x32x32_bf16 v[88:103], v[32:35], v[56:63], v104
    buffer_load_dwordx4 v108, s[16:19], s52 offen lds
    buffer_load_dwordx4 v108, s[16:19], s52 offen offset:1024 lds
    buffer_store_dwordx4 v[132:135], v108, s[16:19], s63 offen sc1
    buffer_load_dwordx4 a[76:79], v108, s[16:19], s54 offen offset:3072
    v_exp_f32 v66, v66
    v_exp_f32 v67, v67
    v_exp_f32 v68, v68
    v_exp_f32 v69, v69
    v_exp_f32 v70, v70
    v_exp_f32 v71, v71
    v_exp_f32 v40, v40
    v_exp_f32 v41, v41
    v_smfmac_f32_32x32x32_bf16 v[88:103], v[36:39], v[64:71], v104
    ds_read_b128 v[20:23], v105 offset:43680
    ds_read_b128 v[32:35], v106 offset:43680
    ds_read_b128 v[36:39], v107 offset:43680
    s_waitcnt vmcnt(24)
    ds_read_b64_tr_b16 v[144:145], v161 offset:16896
    ds_read_b64_tr_b16 v[146:147], v161 offset:17152
    ds_read_b64_tr_b16 v[148:149], v161 offset:17920
    ds_read_b64_tr_b16 v[150:151], v161 offset:18176
    v_exp_f32 v42, v42
    v_exp_f32 v43, v43
    v_exp_f32 v44, v44
    v_mfma_f32_32x32x16_bf16 v[56:71], v[16:19], v[12:15], 0
    s_add_u32 s54, s53, 20480
    v_exp_f32 v45, v45
    v_exp_f32 v46, v46
    v_exp_f32 v47, v47
    v_exp_f32 v48, v48
    v_exp_f32 v49, v49
    v_smfmac_f32_32x32x32_bf16 v[72:87], v[24:27], v[40:47], v104
    v_exp_f32 v50, v50
    v_exp_f32 v51, v51
    v_exp_f32 v52, v52
    v_exp_f32 v53, v53
    v_exp_f32 v54, v54
    v_exp_f32 v55, v55
    v_exp_f32 v56, v56
    v_exp_f32 v57, v57
    v_smfmac_f32_32x32x32_bf16 v[72:87], v[28:31], v[48:55], v104
    s_waitcnt lgkmcnt(0)
    v_exp_f32 v58, v58
    v_exp_f32 v59, v59
    v_exp_f32 v60, v60
    v_mfma_f32_32x32x16_bf16 v[40:55], v[20:23], v[8:11], 0
    v_exp_f32 v61, v61
    v_exp_f32 v62, v62
    v_exp_f32 v63, v63
    v_exp_f32 v64, v64
    v_exp_f32 v65, v65
    v_smfmac_f32_32x32x32_bf16 v[88:103], v[24:27], v[56:63], v104
    buffer_load_dwordx4 a[80:83], v108, s[16:19], s54 offen offset:0
    buffer_load_dwordx4 a[84:87], v108, s[16:19], s54 offen offset:1024
    buffer_load_dwordx4 a[88:91], v108, s[16:19], s54 offen offset:2048
    buffer_load_dwordx4 a[92:95], v108, s[16:19], s54 offen offset:3072
    v_exp_f32 v66, v66
    v_exp_f32 v67, v67
    v_exp_f32 v68, v68
    v_exp_f32 v69, v69
    v_exp_f32 v70, v70
    v_exp_f32 v71, v71
    v_exp_f32 v40, v40
    v_exp_f32 v41, v41
    v_smfmac_f32_32x32x32_bf16 v[88:103], v[28:31], v[64:71], v104
    ds_read_b128 v[16:19], v105 offset:45760
    ds_read_b128 v[24:27], v106 offset:45760
    ds_read_b128 v[28:31], v107 offset:45760
    v_exp_f32 v42, v42
    v_exp_f32 v43, v43
    v_exp_f32 v44, v44
    v_mfma_f32_32x32x16_bf16 v[56:71], v[20:23], v[12:15], 0
    s_add_u32 s54, s53, 24576
    v_exp_f32 v45, v45
    v_exp_f32 v46, v46
    v_exp_f32 v47, v47
    v_exp_f32 v48, v48
    v_exp_f32 v49, v49
    v_smfmac_f32_32x32x32_bf16 v[72:87], v[32:35], v[40:47], v104
    v_exp_f32 v50, v50
    v_exp_f32 v51, v51
    v_exp_f32 v52, v52
    v_exp_f32 v53, v53
    v_exp_f32 v54, v54
    v_exp_f32 v55, v55
    v_exp_f32 v56, v56
    v_exp_f32 v57, v57
    v_smfmac_f32_32x32x32_bf16 v[72:87], v[36:39], v[48:55], v104
    s_waitcnt lgkmcnt(0)
    v_exp_f32 v58, v58
    v_exp_f32 v59, v59
    v_exp_f32 v60, v60
    v_mfma_f32_32x32x16_bf16 v[40:55], v[16:19], v[8:11], 0
    v_exp_f32 v61, v61
    v_exp_f32 v62, v62
    v_exp_f32 v63, v63
    v_exp_f32 v64, v64
    v_exp_f32 v65, v65
    v_smfmac_f32_32x32x32_bf16 v[88:103], v[32:35], v[56:63], v104
    buffer_store_dwordx4 v[136:139], v108, s[16:19], s64 offen sc1
    buffer_load_dwordx4 a[96:99], v108, s[16:19], s54 offen offset:0
    buffer_load_dwordx4 a[100:103], v108, s[16:19], s54 offen offset:1024
    buffer_load_dwordx4 a[104:107], v108, s[16:19], s54 offen offset:2048
    v_exp_f32 v66, v66
    v_exp_f32 v67, v67
    v_exp_f32 v68, v68
    v_exp_f32 v69, v69
    v_exp_f32 v70, v70
    v_exp_f32 v71, v71
    v_exp_f32 v40, v40
    v_exp_f32 v41, v41
    v_smfmac_f32_32x32x32_bf16 v[88:103], v[36:39], v[64:71], v104
    ds_read_b128 v[20:23], v105 offset:47840
    ds_read_b128 v[32:35], v106 offset:47840
    ds_read_b128 v[36:39], v107 offset:47840
    v_exp_f32 v42, v42
    v_exp_f32 v43, v43
    v_exp_f32 v44, v44
    v_mfma_f32_32x32x16_bf16 v[56:71], v[16:19], v[12:15], 0
    s_xor_b32 s52, s50, 73728
    v_exp_f32 v45, v45
    v_exp_f32 v46, v46
    v_exp_f32 v47, v47
    v_exp_f32 v48, v48
    v_exp_f32 v49, v49
    v_smfmac_f32_32x32x32_bf16 v[72:87], v[24:27], v[40:47], v104
    s_add_u32 m0, s51, 74880
    v_exp_f32 v50, v50
    v_exp_f32 v51, v51
    v_exp_f32 v52, v52
    v_exp_f32 v53, v53
    v_exp_f32 v54, v54
    v_exp_f32 v55, v55
    v_exp_f32 v56, v56
    v_exp_f32 v57, v57
    v_smfmac_f32_32x32x32_bf16 v[72:87], v[28:31], v[48:55], v104
    s_waitcnt lgkmcnt(0)
    v_exp_f32 v58, v58
    v_exp_f32 v59, v59
    v_exp_f32 v60, v60
    v_mfma_f32_32x32x16_bf16 v[40:55], v[20:23], v[8:11], 0
    v_exp_f32 v61, v61
    v_exp_f32 v62, v62
    v_exp_f32 v63, v63
    v_exp_f32 v64, v64
    v_exp_f32 v65, v65
    v_smfmac_f32_32x32x32_bf16 v[88:103], v[24:27], v[56:63], v104
    buffer_load_dwordx4 v108, s[12:15], s52 offen lds
    buffer_load_dwordx4 v108, s[12:15], s52 offen offset:1024 lds
    buffer_store_dwordx4 v[140:143], v108, s[16:19], s65 offen sc1
    buffer_load_dwordx4 a[108:111], v108, s[16:19], s54 offen offset:3072
    v_exp_f32 v66, v66
    v_exp_f32 v67, v67
    v_exp_f32 v68, v68
    v_exp_f32 v69, v69
    v_exp_f32 v70, v70
    v_exp_f32 v71, v71
    v_exp_f32 v40, v40
    v_exp_f32 v41, v41
    v_smfmac_f32_32x32x32_bf16 v[88:103], v[28:31], v[64:71], v104
    s_waitcnt vmcnt(31)
    s_barrier
    ds_read_b128 v[16:19], v105 offset:49920
    ds_read_b128 v[24:27], v106 offset:49920
    ds_read_b128 v[28:31], v107 offset:49920
    v_exp_f32 v42, v42
    v_exp_f32 v43, v43
    v_exp_f32 v44, v44
    v_mfma_f32_32x32x16_bf16 v[56:71], v[20:23], v[12:15], 0
    s_add_u32 s52, s53, 98304
    v_exp_f32 v45, v45
    v_exp_f32 v46, v46
    v_exp_f32 v47, v47
    v_exp_f32 v48, v48
    v_exp_f32 v49, v49
    v_smfmac_f32_32x32x32_bf16 v[72:87], v[32:35], v[40:47], v104
    s_add_u32 m0, s55, 141824
    s_add_u32 s54, s53, 28672
    v_exp_f32 v50, v50
    v_exp_f32 v51, v51
    v_exp_f32 v52, v52
    v_exp_f32 v53, v53
    v_exp_f32 v54, v54
    v_exp_f32 v55, v55
    v_exp_f32 v56, v56
    v_exp_f32 v57, v57
    v_smfmac_f32_32x32x32_bf16 v[72:87], v[36:39], v[48:55], v104
    s_waitcnt lgkmcnt(0)
    v_exp_f32 v58, v58
    v_exp_f32 v59, v59
    v_exp_f32 v60, v60
    v_mfma_f32_32x32x16_bf16 v[40:55], v[16:19], v[8:11], 0
    v_exp_f32 v61, v61
    v_exp_f32 v62, v62
    v_exp_f32 v63, v63
    v_exp_f32 v64, v64
    v_exp_f32 v65, v65
    v_smfmac_f32_32x32x32_bf16 v[88:103], v[32:35], v[56:63], v104
    buffer_load_dwordx4 v108, s[16:19], s52 offen lds
    buffer_load_dwordx4 v108, s[16:19], s52 offen offset:1024 lds
    buffer_load_dwordx4 a[112:115], v108, s[16:19], s54 offen offset:0
    buffer_load_dwordx4 a[116:119], v108, s[16:19], s54 offen offset:1024
    v_exp_f32 v66, v66
    v_exp_f32 v67, v67
    v_exp_f32 v68, v68
    v_exp_f32 v69, v69
    v_exp_f32 v70, v70
    v_exp_f32 v71, v71
    v_exp_f32 v40, v40
    v_exp_f32 v41, v41
    v_smfmac_f32_32x32x32_bf16 v[88:103], v[36:39], v[64:71], v104
    ds_read_b128 v[20:23], v105 offset:52000
    ds_read_b128 v[32:35], v106 offset:52000
    ds_read_b128 v[36:39], v107 offset:52000
    v_exp_f32 v42, v42
    v_exp_f32 v43, v43
    v_exp_f32 v44, v44
    v_mfma_f32_32x32x16_bf16 v[56:71], v[16:19], v[12:15], 0
    v_exp_f32 v45, v45
    v_exp_f32 v46, v46
    v_exp_f32 v47, v47
    v_exp_f32 v48, v48
    v_exp_f32 v49, v49
    v_smfmac_f32_32x32x32_bf16 v[72:87], v[24:27], v[40:47], v104
    v_exp_f32 v50, v50
    v_exp_f32 v51, v51
    v_exp_f32 v52, v52
    v_exp_f32 v53, v53
    v_exp_f32 v54, v54
    v_exp_f32 v55, v55
    v_exp_f32 v56, v56
    v_exp_f32 v57, v57
    v_smfmac_f32_32x32x32_bf16 v[72:87], v[28:31], v[48:55], v104
    s_waitcnt lgkmcnt(0)
    v_exp_f32 v58, v58
    v_exp_f32 v59, v59
    v_exp_f32 v60, v60
    v_mfma_f32_32x32x16_bf16 v[40:55], v[20:23], v[8:11], 0
    v_exp_f32 v61, v61
    v_exp_f32 v62, v62
    v_exp_f32 v63, v63
    v_exp_f32 v64, v64
    v_exp_f32 v65, v65
    v_smfmac_f32_32x32x32_bf16 v[88:103], v[24:27], v[56:63], v104
    buffer_store_dwordx4 v[144:147], v108, s[16:19], s66 offen sc1
    buffer_load_dwordx4 a[120:123], v108, s[16:19], s54 offen offset:2048
    buffer_load_dwordx4 a[124:127], v108, s[16:19], s54 offen offset:3072
    v_exp_f32 v66, v66
    v_exp_f32 v67, v67
    v_exp_f32 v68, v68
    v_exp_f32 v69, v69
    v_exp_f32 v70, v70
    v_exp_f32 v71, v71
    v_exp_f32 v40, v40
    v_exp_f32 v41, v41
    v_smfmac_f32_32x32x32_bf16 v[88:103], v[28:31], v[64:71], v104
    ds_read_b128 v[16:19], v105 offset:54080
    ds_read_b128 v[24:27], v106 offset:54080
    ds_read_b128 v[28:31], v107 offset:54080
    v_exp_f32 v42, v42
    v_exp_f32 v43, v43
    v_exp_f32 v44, v44
    v_mfma_f32_32x32x16_bf16 v[56:71], v[20:23], v[12:15], 0
    s_add_u32 s52, s53, 100352
    v_exp_f32 v45, v45
    v_exp_f32 v46, v46
    v_exp_f32 v47, v47
    v_exp_f32 v48, v48
    v_exp_f32 v49, v49
    v_smfmac_f32_32x32x32_bf16 v[72:87], v[32:35], v[40:47], v104
    s_add_u32 m0, s55, 150016
    s_add_u32 s54, s53, 32768
    v_exp_f32 v50, v50
    v_exp_f32 v51, v51
    v_exp_f32 v52, v52
    v_exp_f32 v53, v53
    v_exp_f32 v54, v54
    v_exp_f32 v55, v55
    v_exp_f32 v56, v56
    v_exp_f32 v57, v57
    v_smfmac_f32_32x32x32_bf16 v[72:87], v[36:39], v[48:55], v104
    s_waitcnt lgkmcnt(0)
    v_exp_f32 v58, v58
    v_exp_f32 v59, v59
    v_exp_f32 v60, v60
    v_mfma_f32_32x32x16_bf16 v[40:55], v[16:19], v[8:11], 0
    v_exp_f32 v61, v61
    v_exp_f32 v62, v62
    v_exp_f32 v63, v63
    v_exp_f32 v64, v64
    v_exp_f32 v65, v65
    v_smfmac_f32_32x32x32_bf16 v[88:103], v[32:35], v[56:63], v104
    buffer_load_dwordx4 v108, s[16:19], s52 offen lds
    buffer_load_dwordx4 v108, s[16:19], s52 offen offset:1024 lds
    buffer_store_dwordx4 v[148:151], v108, s[16:19], s67 offen sc1
    buffer_load_dwordx4 a[128:131], v108, s[16:19], s54 offen offset:0
    v_exp_f32 v66, v66
    v_exp_f32 v67, v67
    v_exp_f32 v68, v68
    v_exp_f32 v69, v69
    v_exp_f32 v70, v70
    v_exp_f32 v71, v71
    v_exp_f32 v40, v40
    v_exp_f32 v41, v41
    v_smfmac_f32_32x32x32_bf16 v[88:103], v[36:39], v[64:71], v104
    ds_read_b128 v[20:23], v105 offset:56160
    ds_read_b128 v[32:35], v106 offset:56160
    ds_read_b128 v[36:39], v107 offset:56160
    v_exp_f32 v42, v42
    v_exp_f32 v43, v43
    v_exp_f32 v44, v44
    v_mfma_f32_32x32x16_bf16 v[56:71], v[16:19], v[12:15], 0
    s_xor_b32 s52, s50, 81920
    v_exp_f32 v45, v45
    v_exp_f32 v46, v46
    v_exp_f32 v47, v47
    v_exp_f32 v48, v48
    v_exp_f32 v49, v49
    v_smfmac_f32_32x32x32_bf16 v[72:87], v[24:27], v[40:47], v104
    s_add_u32 m0, s51, 83200
    v_exp_f32 v50, v50
    v_exp_f32 v51, v51
    v_exp_f32 v52, v52
    v_exp_f32 v53, v53
    v_exp_f32 v54, v54
    v_exp_f32 v55, v55
    v_exp_f32 v56, v56
    v_exp_f32 v57, v57
    v_smfmac_f32_32x32x32_bf16 v[72:87], v[28:31], v[48:55], v104
    s_waitcnt lgkmcnt(0)
    v_exp_f32 v58, v58
    v_exp_f32 v59, v59
    v_exp_f32 v60, v60
    v_mfma_f32_32x32x16_bf16 v[40:55], v[20:23], v[8:11], 0
    v_exp_f32 v61, v61
    v_exp_f32 v62, v62
    v_exp_f32 v63, v63
    v_exp_f32 v64, v64
    v_exp_f32 v65, v65
    v_smfmac_f32_32x32x32_bf16 v[88:103], v[24:27], v[56:63], v104
    buffer_load_dwordx4 v108, s[12:15], s52 offen lds
    buffer_load_dwordx4 v108, s[12:15], s52 offen offset:1024 lds
    buffer_load_dwordx4 a[132:135], v108, s[16:19], s54 offen offset:1024
    buffer_load_dwordx4 a[136:139], v108, s[16:19], s54 offen offset:2048
    v_exp_f32 v66, v66
    v_exp_f32 v67, v67
    v_exp_f32 v68, v68
    v_exp_f32 v69, v69
    v_exp_f32 v70, v70
    v_exp_f32 v71, v71
    v_exp_f32 v40, v40
    v_exp_f32 v41, v41
    v_smfmac_f32_32x32x32_bf16 v[88:103], v[28:31], v[64:71], v104
    ds_read_b128 v[16:19], v105 offset:58240
    ds_read_b128 v[24:27], v106 offset:58240
    ds_read_b128 v[28:31], v107 offset:58240
    v_exp_f32 v42, v42
    v_exp_f32 v43, v43
    v_exp_f32 v44, v44
    v_mfma_f32_32x32x16_bf16 v[56:71], v[20:23], v[12:15], 0
    s_add_u32 s52, s53, 108544
    v_exp_f32 v45, v45
    v_exp_f32 v46, v46
    v_exp_f32 v47, v47
    v_exp_f32 v48, v48
    v_exp_f32 v49, v49
    v_smfmac_f32_32x32x32_bf16 v[72:87], v[32:35], v[40:47], v104
    s_add_u32 m0, s55, 24576
    v_exp_f32 v50, v50
    v_exp_f32 v51, v51
    v_exp_f32 v52, v52
    v_exp_f32 v53, v53
    v_exp_f32 v54, v54
    v_exp_f32 v55, v55
    v_exp_f32 v56, v56
    v_exp_f32 v57, v57
    v_smfmac_f32_32x32x32_bf16 v[72:87], v[36:39], v[48:55], v104
    s_waitcnt lgkmcnt(0)
    v_exp_f32 v58, v58
    v_exp_f32 v59, v59
    v_exp_f32 v60, v60
    v_mfma_f32_32x32x16_bf16 v[40:55], v[16:19], v[8:11], 0
    v_exp_f32 v61, v61
    v_exp_f32 v62, v62
    v_exp_f32 v63, v63
    v_exp_f32 v64, v64
    v_exp_f32 v65, v65
    v_smfmac_f32_32x32x32_bf16 v[88:103], v[32:35], v[56:63], v104
    buffer_load_dwordx4 v108, s[16:19], s52 offen lds
    buffer_load_dwordx4 v108, s[16:19], s52 offen offset:1024 lds
    buffer_load_dwordx4 a[140:143], v108, s[16:19], s54 offen offset:3072
    v_exp_f32 v66, v66
    v_exp_f32 v67, v67
    v_exp_f32 v68, v68
    v_exp_f32 v69, v69
    v_exp_f32 v70, v70
    v_exp_f32 v71, v71
    v_exp_f32 v40, v40
    v_exp_f32 v41, v41
    v_smfmac_f32_32x32x32_bf16 v[88:103], v[36:39], v[64:71], v104
    ds_read_b128 v[20:23], v105 offset:60320
    ds_read_b128 v[32:35], v106 offset:60320
    ds_read_b128 v[36:39], v107 offset:60320
    v_exp_f32 v42, v42
    v_exp_f32 v43, v43
    v_exp_f32 v44, v44
    v_mfma_f32_32x32x16_bf16 v[56:71], v[16:19], v[12:15], 0
    s_add_u32 s54, s53, 36864
    v_exp_f32 v45, v45
    v_exp_f32 v46, v46
    v_exp_f32 v47, v47
    v_exp_f32 v48, v48
    v_exp_f32 v49, v49
    v_smfmac_f32_32x32x32_bf16 v[72:87], v[24:27], v[40:47], v104
    v_exp_f32 v50, v50
    v_exp_f32 v51, v51
    v_exp_f32 v52, v52
    v_exp_f32 v53, v53
    v_exp_f32 v54, v54
    v_exp_f32 v55, v55
    v_exp_f32 v56, v56
    v_exp_f32 v57, v57
    v_smfmac_f32_32x32x32_bf16 v[72:87], v[28:31], v[48:55], v104
    s_waitcnt lgkmcnt(0)
    v_exp_f32 v58, v58
    v_exp_f32 v59, v59
    v_exp_f32 v60, v60
    v_mfma_f32_32x32x16_bf16 v[40:55], v[20:23], v[8:11], 0
    v_exp_f32 v61, v61
    v_exp_f32 v62, v62
    v_exp_f32 v63, v63
    v_exp_f32 v64, v64
    v_exp_f32 v65, v65
    v_smfmac_f32_32x32x32_bf16 v[88:103], v[24:27], v[56:63], v104
    buffer_load_dwordx4 a[144:147], v108, s[16:19], s54 offen offset:0
    buffer_load_dwordx4 a[148:151], v108, s[16:19], s54 offen offset:1024
    buffer_load_dwordx4 a[152:155], v108, s[16:19], s54 offen offset:2048
    buffer_load_dwordx4 a[156:159], v108, s[16:19], s54 offen offset:3072
    v_exp_f32 v66, v66
    v_exp_f32 v67, v67
    v_exp_f32 v68, v68
    v_exp_f32 v69, v69
    v_exp_f32 v70, v70
    v_exp_f32 v71, v71
    v_exp_f32 v40, v40
    v_exp_f32 v41, v41
    v_smfmac_f32_32x32x32_bf16 v[88:103], v[28:31], v[64:71], v104
    ds_read_b128 v[16:19], v105 offset:62400
    ds_read_b128 v[24:27], v106 offset:62400
    ds_read_b128 v[28:31], v107 offset:62400
    v_exp_f32 v42, v42
    v_exp_f32 v43, v43
    v_exp_f32 v44, v44
    v_mfma_f32_32x32x16_bf16 v[56:71], v[20:23], v[12:15], 0
    s_add_u32 s52, s53, 110592
    v_exp_f32 v45, v45
    v_exp_f32 v46, v46
    v_exp_f32 v47, v47
    v_exp_f32 v48, v48
    v_exp_f32 v49, v49
    v_smfmac_f32_32x32x32_bf16 v[72:87], v[32:35], v[40:47], v104
    s_add_u32 m0, s55, 32768
    s_add_u32 s54, s53, 40960
    v_exp_f32 v50, v50
    v_exp_f32 v51, v51
    v_exp_f32 v52, v52
    v_exp_f32 v53, v53
    v_exp_f32 v54, v54
    v_exp_f32 v55, v55
    v_exp_f32 v56, v56
    v_exp_f32 v57, v57
    v_smfmac_f32_32x32x32_bf16 v[72:87], v[36:39], v[48:55], v104
    s_waitcnt lgkmcnt(0)
    v_exp_f32 v58, v58
    v_exp_f32 v59, v59
    v_exp_f32 v60, v60
    v_mfma_f32_32x32x16_bf16 v[40:55], v[16:19], v[8:11], 0
    v_exp_f32 v61, v61
    v_exp_f32 v62, v62
    v_exp_f32 v63, v63
    v_exp_f32 v64, v64
    v_exp_f32 v65, v65
    v_smfmac_f32_32x32x32_bf16 v[88:103], v[32:35], v[56:63], v104
    buffer_load_dwordx4 v108, s[16:19], s52 offen lds
    buffer_load_dwordx4 v108, s[16:19], s52 offen offset:1024 lds
    buffer_load_dwordx4 a[160:163], v108, s[16:19], s54 offen offset:0
    buffer_load_dwordx4 a[164:167], v108, s[16:19], s54 offen offset:1024
    v_exp_f32 v66, v66
    v_exp_f32 v67, v67
    v_exp_f32 v68, v68
    v_exp_f32 v69, v69
    v_exp_f32 v70, v70
    v_exp_f32 v71, v71
    v_exp_f32 v40, v40
    v_add_u32 v105, 64480, v105
    v_add_u32 v106, 64480, v106
    v_add_u32 v107, 64480, v107
    v_exp_f32 v41, v41
    v_smfmac_f32_32x32x32_bf16 v[88:103], v[36:39], v[64:71], v104
    ds_read_b128 v[20:23], v105 offset:0
    ds_read_b128 v[32:35], v106 offset:0
    ds_read_b128 v[36:39], v107 offset:0
    v_exp_f32 v42, v42
    v_exp_f32 v43, v43
    v_exp_f32 v44, v44
    v_mfma_f32_32x32x16_bf16 v[56:71], v[16:19], v[12:15], 0
    s_xor_b32 s52, s50, 90112
    v_exp_f32 v45, v45
    v_exp_f32 v46, v46
    v_exp_f32 v47, v47
    v_exp_f32 v48, v48
    v_exp_f32 v49, v49
    v_smfmac_f32_32x32x32_bf16 v[72:87], v[24:27], v[40:47], v104
    s_add_u32 m0, s51, 91520
    v_exp_f32 v50, v50
    v_exp_f32 v51, v51
    v_exp_f32 v52, v52
    v_exp_f32 v53, v53
    v_exp_f32 v54, v54
    v_exp_f32 v55, v55
    v_exp_f32 v56, v56
    v_exp_f32 v57, v57
    v_smfmac_f32_32x32x32_bf16 v[72:87], v[28:31], v[48:55], v104
    s_waitcnt lgkmcnt(0)
    v_exp_f32 v58, v58
    v_exp_f32 v59, v59
    v_exp_f32 v60, v60
    v_mfma_f32_32x32x16_bf16 v[40:55], v[20:23], v[8:11], 0
    v_exp_f32 v61, v61
    v_exp_f32 v62, v62
    v_exp_f32 v63, v63
    v_exp_f32 v64, v64
    v_exp_f32 v65, v65
    v_smfmac_f32_32x32x32_bf16 v[88:103], v[24:27], v[56:63], v104
    buffer_load_dwordx4 v108, s[12:15], s52 offen lds
    buffer_load_dwordx4 v108, s[12:15], s52 offen offset:1024 lds
    buffer_load_dwordx4 a[168:171], v108, s[16:19], s54 offen offset:2048
    buffer_load_dwordx4 a[172:175], v108, s[16:19], s54 offen offset:3072
    v_exp_f32 v66, v66
    v_exp_f32 v67, v67
    v_exp_f32 v68, v68
    v_exp_f32 v69, v69
    v_exp_f32 v70, v70
    v_exp_f32 v71, v71
    v_exp_f32 v40, v40
    v_exp_f32 v41, v41
    v_smfmac_f32_32x32x32_bf16 v[88:103], v[28:31], v[64:71], v104
    s_waitcnt vmcnt(20)
    s_barrier
    s_or_b32 s60, s6, s3
    s_cmp_lg_u32 s60, 0
    s_cbranch_scc1 att_cp_24
    s_lshr_b32 s60, s48, 7
    s_lshl_b32 s60, s60, 8
    s_add_u32 s60, s60, 16277504
    v_mov_b32 v110, 1
    s_mov_b64 exec, 1
    buffer_atomic_add v110, off, s[16:19], s60 sc1
    s_mov_b64 exec, -1
att_cp_24:
    ds_read_b128 v[16:19], v105 offset:2080
    ds_read_b128 v[24:27], v106 offset:2080
    ds_read_b128 v[28:31], v107 offset:2080
    v_exp_f32 v42, v42
    v_exp_f32 v43, v43
    v_exp_f32 v44, v44
    v_mfma_f32_32x32x16_bf16 v[56:71], v[20:23], v[12:15], 0
    s_add_u32 s52, s53, 112640
    v_exp_f32 v45, v45
    v_exp_f32 v46, v46
    v_exp_f32 v47, v47
    v_exp_f32 v48, v48
    v_exp_f32 v49, v49
    v_smfmac_f32_32x32x32_bf16 v[72:87], v[32:35], v[40:47], v104
    s_add_u32 m0, s55, 40960
    s_add_u32 s54, s53, 45056
    v_exp_f32 v50, v50
    v_exp_f32 v51, v51
    v_exp_f32 v52, v52
    v_exp_f32 v53, v53
    v_exp_f32 v54, v54
    v_exp_f32 v55, v55
    v_exp_f32 v56, v56
    v_exp_f32 v57, v57
    v_smfmac_f32_32x32x32_bf16 v[72:87], v[36:39], v[48:55], v104
    s_waitcnt lgkmcnt(0)
    v_exp_f32 v58, v58
    v_exp_f32 v59, v59
    v_exp_f32 v60, v60
    v_mfma_f32_32x32x16_bf16 v[40:55], v[16:19], v[8:11], 0
    v_exp_f32 v61, v61
    v_exp_f32 v62, v62
    v_exp_f32 v63, v63
    v_exp_f32 v64, v64
    v_exp_f32 v65, v65
    v_smfmac_f32_32x32x32_bf16 v[88:103], v[32:35], v[56:63], v104
    buffer_load_dwordx4 v108, s[16:19], s52 offen lds
    buffer_load_dwordx4 v108, s[16:19], s52 offen offset:1024 lds
    buffer_load_dwordx4 a[176:179], v108, s[16:19], s54 offen offset:0
    buffer_load_dwordx4 a[180:183], v108, s[16:19], s54 offen offset:1024
    v_exp_f32 v66, v66
    v_exp_f32 v67, v67
    v_exp_f32 v68, v68
    v_exp_f32 v69, v69
    v_exp_f32 v70, v70
    v_exp_f32 v71, v71
    v_exp_f32 v40, v40
    v_exp_f32 v41, v41
    v_smfmac_f32_32x32x32_bf16 v[88:103], v[36:39], v[64:71], v104
    ds_read_b128 v[20:23], v105 offset:4160
    ds_read_b128 v[32:35], v106 offset:4160
    ds_read_b128 v[36:39], v107 offset:4160
    v_exp_f32 v42, v42
    v_exp_f32 v43, v43
    v_exp_f32 v44, v44
    v_mfma_f32_32x32x16_bf16 v[56:71], v[16:19], v[12:15], 0
    v_exp_f32 v45, v45
    v_exp_f32 v46, v46
    v_exp_f32 v47, v47
    v_exp_f32 v48, v48
    v_exp_f32 v49, v49
    v_smfmac_f32_32x32x32_bf16 v[72:87], v[24:27], v[40:47], v104
    v_exp_f32 v50, v50
    v_exp_f32 v51, v51
    v_exp_f32 v52, v52
    v_exp_f32 v53, v53
    v_exp_f32 v54, v54
    v_exp_f32 v55, v55
    v_exp_f32 v56, v56
    v_exp_f32 v57, v57
    v_smfmac_f32_32x32x32_bf16 v[72:87], v[28:31], v[48:55], v104
    s_waitcnt lgkmcnt(0)
    v_exp_f32 v58, v58
    v_exp_f32 v59, v59
    v_exp_f32 v60, v60
    v_mfma_f32_32x32x16_bf16 v[40:55], v[20:23], v[8:11], 0
    v_exp_f32 v61, v61
    v_exp_f32 v62, v62
    v_exp_f32 v63, v63
    v_exp_f32 v64, v64
    v_exp_f32 v65, v65
    v_smfmac_f32_32x32x32_bf16 v[88:103], v[24:27], v[56:63], v104
    buffer_load_dwordx4 a[184:187], v108, s[16:19], s54 offen offset:2048
    buffer_load_dwordx4 a[188:191], v108, s[16:19], s54 offen offset:3072
    v_exp_f32 v66, v66
    v_exp_f32 v67, v67
    v_exp_f32 v68, v68
    v_exp_f32 v69, v69
    v_exp_f32 v70, v70
    v_exp_f32 v71, v71
    v_exp_f32 v40, v40
    v_exp_f32 v41, v41
    v_smfmac_f32_32x32x32_bf16 v[88:103], v[28:31], v[64:71], v104
    ds_read_b128 v[16:19], v105 offset:6240
    ds_read_b128 v[24:27], v106 offset:6240
    ds_read_b128 v[28:31], v107 offset:6240
    v_exp_f32 v42, v42
    v_exp_f32 v43, v43
    v_exp_f32 v44, v44
    v_mfma_f32_32x32x16_bf16 v[56:71], v[20:23], v[12:15], 0
    s_add_u32 s52, s53, 114688
    v_exp_f32 v45, v45
    v_exp_f32 v46, v46
    v_exp_f32 v47, v47
    v_exp_f32 v48, v48
    v_exp_f32 v49, v49
    v_smfmac_f32_32x32x32_bf16 v[72:87], v[32:35], v[40:47], v104
    s_add_u32 m0, s55, 49152
    s_add_u32 s54, s53, 49152
    v_exp_f32 v50, v50
    v_exp_f32 v51, v51
    v_exp_f32 v52, v52
    v_exp_f32 v53, v53
    v_exp_f32 v54, v54
    v_exp_f32 v55, v55
    v_exp_f32 v56, v56
    v_exp_f32 v57, v57
    v_smfmac_f32_32x32x32_bf16 v[72:87], v[36:39], v[48:55], v104
    s_waitcnt lgkmcnt(0)
    v_exp_f32 v58, v58
    v_exp_f32 v59, v59
    v_exp_f32 v60, v60
    v_mfma_f32_32x32x16_bf16 v[40:55], v[16:19], v[8:11], 0
    v_exp_f32 v61, v61
    v_exp_f32 v62, v62
    v_exp_f32 v63, v63
    v_exp_f32 v64, v64
    v_exp_f32 v65, v65
    v_smfmac_f32_32x32x32_bf16 v[88:103], v[32:35], v[56:63], v104
    buffer_load_dwordx4 v108, s[16:19], s52 offen lds
    buffer_load_dwordx4 v108, s[16:19], s52 offen offset:1024 lds
    buffer_load_dwordx4 a[192:195], v108, s[16:19], s54 offen offset:0
    buffer_load_dwordx4 a[196:199], v108, s[16:19], s54 offen offset:1024
    v_exp_f32 v66, v66
    v_exp_f32 v67, v67
    v_exp_f32 v68, v68
    v_exp_f32 v69, v69
    v_exp_f32 v70, v70
    v_exp_f32 v71, v71
    v_exp_f32 v40, v40
    v_exp_f32 v41, v41
    v_smfmac_f32_32x32x32_bf16 v[88:103], v[36:39], v[64:71], v104
    ds_read_b128 v[20:23], v105 offset:8320
    ds_read_b128 v[32:35], v106 offset:8320
    ds_read_b128 v[36:39], v107 offset:8320
    v_exp_f32 v42, v42
    v_exp_f32 v43, v43
    v_exp_f32 v44, v44
    v_mfma_f32_32x32x16_bf16 v[56:71], v[16:19], v[12:15], 0
    s_xor_b32 s52, s50, 98304
    v_exp_f32 v45, v45
    v_exp_f32 v46, v46
    v_exp_f32 v47, v47
    v_exp_f32 v48, v48
    v_exp_f32 v49, v49
    v_smfmac_f32_32x32x32_bf16 v[72:87], v[24:27], v[40:47], v104
    s_add_u32 m0, s51, 99840
    v_exp_f32 v50, v50
    v_exp_f32 v51, v51
    v_exp_f32 v52, v52
    v_exp_f32 v53, v53
    v_exp_f32 v54, v54
    v_exp_f32 v55, v55
    v_exp_f32 v56, v56
    v_exp_f32 v57, v57
    v_smfmac_f32_32x32x32_bf16 v[72:87], v[28:31], v[48:55], v104
    s_waitcnt lgkmcnt(0)
    v_exp_f32 v58, v58
    v_exp_f32 v59, v59
    v_exp_f32 v60, v60
    v_mfma_f32_32x32x16_bf16 v[40:55], v[20:23], v[8:11], 0
    v_exp_f32 v61, v61
    v_exp_f32 v62, v62
    v_exp_f32 v63, v63
    v_exp_f32 v64, v64
    v_exp_f32 v65, v65
    v_smfmac_f32_32x32x32_bf16 v[88:103], v[24:27], v[56:63], v104
    buffer_load_dwordx4 v108, s[12:15], s52 offen lds
    buffer_load_dwordx4 v108, s[12:15], s52 offen offset:1024 lds
    buffer_load_dwordx4 a[200:203], v108, s[16:19], s54 offen offset:2048
    buffer_load_dwordx4 a[204:207], v108, s[16:19], s54 offen offset:3072
    v_exp_f32 v66, v66
    v_exp_f32 v67, v67
    v_exp_f32 v68, v68
    v_exp_f32 v69, v69
    v_exp_f32 v70, v70
    v_exp_f32 v71, v71
    v_exp_f32 v40, v40
    v_exp_f32 v41, v41
    v_smfmac_f32_32x32x32_bf16 v[88:103], v[28:31], v[64:71], v104
    ds_read_b128 v[16:19], v105 offset:10400
    ds_read_b128 v[24:27], v106 offset:10400
    ds_read_b128 v[28:31], v107 offset:10400
    v_exp_f32 v42, v42
    v_exp_f32 v43, v43
    v_exp_f32 v44, v44
    v_mfma_f32_32x32x16_bf16 v[56:71], v[20:23], v[12:15], 0
    s_add_u32 s52, s53, 116736
    v_exp_f32 v45, v45
    v_exp_f32 v46, v46
    v_exp_f32 v47, v47
    v_exp_f32 v48, v48
    v_exp_f32 v49, v49
    v_smfmac_f32_32x32x32_bf16 v[72:87], v[32:35], v[40:47], v104
    s_add_u32 m0, s55, 57344
    s_add_u32 s54, s53, 53248
    v_exp_f32 v50, v50
    v_exp_f32 v51, v51
    v_exp_f32 v52, v52
    v_exp_f32 v53, v53
    v_exp_f32 v54, v54
    v_exp_f32 v55, v55
    v_exp_f32 v56, v56
    v_exp_f32 v57, v57
    v_smfmac_f32_32x32x32_bf16 v[72:87], v[36:39], v[48:55], v104
    s_waitcnt lgkmcnt(0)
    v_exp_f32 v58, v58
    v_exp_f32 v59, v59
    v_exp_f32 v60, v60
    v_mfma_f32_32x32x16_bf16 v[40:55], v[16:19], v[8:11], 0
    v_exp_f32 v61, v61
    v_exp_f32 v62, v62
    v_exp_f32 v63, v63
    v_exp_f32 v64, v64
    v_exp_f32 v65, v65
    v_smfmac_f32_32x32x32_bf16 v[88:103], v[32:35], v[56:63], v104
    buffer_load_dwordx4 v108, s[16:19], s52 offen lds
    buffer_load_dwordx4 v108, s[16:19], s52 offen offset:1024 lds
    buffer_load_dwordx4 a[208:211], v108, s[16:19], s54 offen offset:0
    buffer_load_dwordx4 a[212:215], v108, s[16:19], s54 offen offset:1024
    v_exp_f32 v66, v66
    v_exp_f32 v67, v67
    v_exp_f32 v68, v68
    v_exp_f32 v69, v69
    v_exp_f32 v70, v70
    v_exp_f32 v71, v71
    v_exp_f32 v40, v40
    v_exp_f32 v41, v41
    v_smfmac_f32_32x32x32_bf16 v[88:103], v[36:39], v[64:71], v104
    ds_read_b128 v[20:23], v105 offset:12480
    ds_read_b128 v[32:35], v106 offset:12480
    ds_read_b128 v[36:39], v107 offset:12480
    v_exp_f32 v42, v42
    v_exp_f32 v43, v43
    v_exp_f32 v44, v44
    v_mfma_f32_32x32x16_bf16 v[56:71], v[16:19], v[12:15], 0
    s_cmp_eq_u32 s3, 0
    v_exp_f32 v45, v45
    v_exp_f32 v46, v46
    v_exp_f32 v47, v47
    v_exp_f32 v48, v48
    v_exp_f32 v49, v49
    v_smfmac_f32_32x32x32_bf16 v[72:87], v[24:27], v[40:47], v104
    s_cselect_b32 s58, 16277504, s57
    v_exp_f32 v50, v50
    v_exp_f32 v51, v51
    v_exp_f32 v52, v52
    v_exp_f32 v53, v53
    v_exp_f32 v54, v54
    v_exp_f32 v55, v55
    v_exp_f32 v56, v56
    v_exp_f32 v57, v57
    v_smfmac_f32_32x32x32_bf16 v[72:87], v[28:31], v[48:55], v104
    s_waitcnt lgkmcnt(0)
    v_exp_f32 v58, v58
    v_exp_f32 v59, v59
    v_exp_f32 v60, v60
    v_mfma_f32_32x32x16_bf16 v[40:55], v[20:23], v[8:11], 0
    v_exp_f32 v61, v61
    v_exp_f32 v62, v62
    v_exp_f32 v63, v63
    v_exp_f32 v64, v64
    v_exp_f32 v65, v65
    v_smfmac_f32_32x32x32_bf16 v[88:103], v[24:27], v[56:63], v104
    buffer_load_dword v122, v120, s[16:19], s58 offen sc1
    buffer_load_dwordx4 a[216:219], v108, s[16:19], s54 offen offset:2048
    buffer_load_dwordx4 a[220:223], v108, s[16:19], s54 offen offset:3072
    v_exp_f32 v66, v66
    v_exp_f32 v67, v67
    v_exp_f32 v68, v68
    v_exp_f32 v69, v69
    v_exp_f32 v70, v70
    v_exp_f32 v71, v71
    v_exp_f32 v40, v40
    v_exp_f32 v41, v41
    v_smfmac_f32_32x32x32_bf16 v[88:103], v[28:31], v[64:71], v104
    ds_read_b128 v[16:19], v105 offset:14560
    ds_read_b128 v[24:27], v106 offset:14560
    ds_read_b128 v[28:31], v107 offset:14560
    v_exp_f32 v42, v42
    v_exp_f32 v43, v43
    v_exp_f32 v44, v44
    v_mfma_f32_32x32x16_bf16 v[56:71], v[20:23], v[12:15], 0
    s_add_u32 s54, s53, 57344
    v_exp_f32 v45, v45
    v_exp_f32 v46, v46
    v_exp_f32 v47, v47
    v_exp_f32 v48, v48
    v_exp_f32 v49, v49
    v_smfmac_f32_32x32x32_bf16 v[72:87], v[32:35], v[40:47], v104
    v_exp_f32 v50, v50
    v_exp_f32 v51, v51
    v_exp_f32 v52, v52
    v_exp_f32 v53, v53
    v_exp_f32 v54, v54
    v_exp_f32 v55, v55
    v_exp_f32 v56, v56
    v_exp_f32 v57, v57
    v_smfmac_f32_32x32x32_bf16 v[72:87], v[36:39], v[48:55], v104
    s_waitcnt lgkmcnt(0)
    v_exp_f32 v58, v58
    v_exp_f32 v59, v59
    v_exp_f32 v60, v60
    v_mfma_f32_32x32x16_bf16 v[40:55], v[16:19], v[8:11], 0
    v_exp_f32 v61, v61
    v_exp_f32 v62, v62
    v_exp_f32 v63, v63
    v_exp_f32 v64, v64
    v_exp_f32 v65, v65
    v_smfmac_f32_32x32x32_bf16 v[88:103], v[32:35], v[56:63], v104
    buffer_load_dwordx4 a[224:227], v108, s[16:19], s54 offen offset:0
    buffer_load_dwordx4 a[228:231], v108, s[16:19], s54 offen offset:1024
    v_exp_f32 v66, v66
    v_exp_f32 v67, v67
    v_exp_f32 v68, v68
    v_exp_f32 v69, v69
    v_exp_f32 v70, v70
    v_exp_f32 v71, v71
    v_exp_f32 v40, v40
    v_exp_f32 v41, v41
    v_smfmac_f32_32x32x32_bf16 v[88:103], v[36:39], v[64:71], v104
    ds_read_b128 v[20:23], v105 offset:16640
    ds_read_b128 v[32:35], v106 offset:16640
    ds_read_b128 v[36:39], v107 offset:16640
    v_exp_f32 v42, v42
    v_exp_f32 v43, v43
    v_exp_f32 v44, v44
    v_mfma_f32_32x32x16_bf16 v[56:71], v[16:19], v[12:15], 0
    s_xor_b32 s52, s50, 106496
    v_exp_f32 v45, v45
    v_exp_f32 v46, v46
    v_exp_f32 v47, v47
    v_exp_f32 v48, v48
    v_exp_f32 v49, v49
    v_smfmac_f32_32x32x32_bf16 v[72:87], v[24:27], v[40:47], v104
    s_add_u32 m0, s51, 108160
    v_exp_f32 v50, v50
    v_exp_f32 v51, v51
    v_exp_f32 v52, v52
    v_exp_f32 v53, v53
    v_exp_f32 v54, v54
    v_exp_f32 v55, v55
    v_exp_f32 v56, v56
    v_exp_f32 v57, v57
    v_smfmac_f32_32x32x32_bf16 v[72:87], v[28:31], v[48:55], v104
    s_waitcnt lgkmcnt(0)
    v_exp_f32 v58, v58
    v_exp_f32 v59, v59
    v_exp_f32 v60, v60
    v_mfma_f32_32x32x16_bf16 v[40:55], v[20:23], v[8:11], 0
    v_exp_f32 v61, v61
    v_exp_f32 v62, v62
    v_exp_f32 v63, v63
    v_exp_f32 v64, v64
    v_exp_f32 v65, v65
    v_smfmac_f32_32x32x32_bf16 v[88:103], v[24:27], v[56:63], v104
    buffer_load_dwordx4 v108, s[12:15], s52 offen lds
    buffer_load_dwordx4 v108, s[12:15], s52 offen offset:1024 lds
    buffer_load_dwordx4 a[232:235], v108, s[16:19], s54 offen offset:2048
    buffer_load_dwordx4 a[236:239], v108, s[16:19], s54 offen offset:3072
    v_exp_f32 v66, v66
    v_exp_f32 v67, v67
    v_exp_f32 v68, v68
    v_exp_f32 v69, v69
    v_exp_f32 v70, v70
    v_exp_f32 v71, v71
    v_exp_f32 v40, v40
    v_exp_f32 v41, v41
    v_smfmac_f32_32x32x32_bf16 v[88:103], v[28:31], v[64:71], v104
    s_waitcnt vmcnt(8)
    s_or_b32 s60, s6, s3
    s_cmp_lg_u32 s60, 0
    s_cbranch_scc1 att_cpok_25
    v_cmp_gt_u32 vcc, 16, v122
    s_and_b32 s60, vcc_lo, 0xffff
    s_cbranch_scc0 att_cpok_25
    s_mov_b32 s60, 16277504
    v_lshlrev_b32 v110, 8, v1
    s_mov_b32 s61, 200000
    s_mov_b64 exec, 65535
poll_26:
    buffer_load_dword v111, v110, s[16:19], s60 offen sc1
    s_sub_u32 s61, s61, 1
    s_cmp_eq_u32 s61, 0
    s_cbranch_scc1 pollout_27
    s_waitcnt vmcnt(0)
    v_cmp_gt_u32 vcc, 16, v111
    s_cbranch_vccz pollout_27
    s_sleep 4
    s_branch poll_26
pollout_27:
    s_mov_b64 exec, -1
att_cpok_25:
    s_barrier
    ds_read_b128 v[16:19], v105 offset:18720
    ds_read_b128 v[24:27], v106 offset:18720
    ds_read_b128 v[28:31], v107 offset:18720
    v_exp_f32 v42, v42
    v_exp_f32 v43, v43
    v_exp_f32 v44, v44
    v_mfma_f32_32x32x16_bf16 v[56:71], v[20:23], v[12:15], 0
    s_add_u32 s54, s53, 61440
    v_exp_f32 v45, v45
    v_exp_f32 v46, v46
    v_exp_f32 v47, v47
    v_exp_f32 v48, v48
    v_exp_f32 v49, v49
    v_smfmac_f32_32x32x32_bf16 v[72:87], v[32:35], v[40:47], v104
    v_exp_f32 v50, v50
    v_exp_f32 v51, v51
    v_exp_f32 v52, v52
    v_exp_f32 v53, v53
    v_exp_f32 v54, v54
    v_exp_f32 v55, v55
    v_exp_f32 v56, v56
    v_exp_f32 v57, v57
    v_smfmac_f32_32x32x32_bf16 v[72:87], v[36:39], v[48:55], v104
    s_waitcnt lgkmcnt(0)
    v_exp_f32 v58, v58
    v_exp_f32 v59, v59
    v_exp_f32 v60, v60
    v_mfma_f32_32x32x16_bf16 v[40:55], v[16:19], v[8:11], 0
    v_exp_f32 v61, v61
    v_exp_f32 v62, v62
    v_exp_f32 v63, v63
    v_exp_f32 v64, v64
    v_exp_f32 v65, v65
    v_smfmac_f32_32x32x32_bf16 v[88:103], v[32:35], v[56:63], v104
    buffer_load_dwordx4 a[240:243], v108, s[16:19], s54 offen offset:0
    buffer_load_dwordx4 a[244:247], v108, s[16:19], s54 offen offset:1024
    v_exp_f32 v66, v66
    v_exp_f32 v67, v67
    v_exp_f32 v68, v68
    v_exp_f32 v69, v69
    v_exp_f32 v70, v70
    v_exp_f32 v71, v71
    v_exp_f32 v40, v40
    v_exp_f32 v41, v41
    v_smfmac_f32_32x32x32_bf16 v[88:103], v[36:39], v[64:71], v104
    ds_read_b128 v[20:23], v105 offset:20800
    ds_read_b128 v[32:35], v106 offset:20800
    ds_read_b128 v[36:39], v107 offset:20800
    v_exp_f32 v42, v42
    v_exp_f32 v43, v43
    v_exp_f32 v44, v44
    v_mfma_f32_32x32x16_bf16 v[56:71], v[16:19], v[12:15], 0
    s_add_u32 s52, s53, 118784
    v_exp_f32 v45, v45
    v_exp_f32 v46, v46
    v_exp_f32 v47, v47
    v_exp_f32 v48, v48
    v_exp_f32 v49, v49
    v_smfmac_f32_32x32x32_bf16 v[72:87], v[24:27], v[40:47], v104
    s_add_u32 m0, s55, 65536
    s_add_u32 s58, s56, 0
    v_exp_f32 v50, v50
    v_exp_f32 v51, v51
    v_exp_f32 v52, v52
    v_exp_f32 v53, v53
    v_exp_f32 v54, v54
    v_exp_f32 v55, v55
    v_exp_f32 v56, v56
    v_exp_f32 v57, v57
    v_smfmac_f32_32x32x32_bf16 v[72:87], v[28:31], v[48:55], v104
    s_waitcnt lgkmcnt(0)
    v_exp_f32 v58, v58
    v_exp_f32 v59, v59
    v_exp_f32 v60, v60
    v_mfma_f32_32x32x16_bf16 v[40:55], v[20:23], v[8:11], 0
    v_exp_f32 v61, v61
    v_exp_f32 v62, v62
    v_exp_f32 v63, v63
    v_exp_f32 v64, v64
    v_exp_f32 v65, v65
    v_smfmac_f32_32x32x32_bf16 v[88:103], v[24:27], v[56:63], v104
    buffer_load_dwordx4 v108, s[16:19], s52 offen lds
    buffer_load_dwordx4 v108, s[16:19], s52 offen offset:1024 lds
    buffer_load_dword v110, v121, s[16:19], s58 offen
    buffer_load_dwordx4 a[248:251], v108, s[16:19], s54 offen offset:2048
    v_exp_f32 v66, v66
    v_exp_f32 v67, v67
    v_exp_f32 v68, v68
    v_exp_f32 v69, v69
    v_exp_f32 v70, v70
    v_exp_f32 v71, v71
    v_exp_f32 v40, v40
    v_exp_f32 v41, v41
    v_smfmac_f32_32x32x32_bf16 v[88:103], v[28:31], v[64:71], v104
    ds_read_b128 v[16:19], v105 offset:22880
    ds_read_b128 v[24:27], v106 offset:22880
    ds_read_b128 v[28:31], v107 offset:22880
    v_exp_f32 v42, v42
    v_exp_f32 v43, v43
    v_exp_f32 v44, v44
    v_mfma_f32_32x32x16_bf16 v[56:71], v[20:23], v[12:15], 0
    s_add_u32 s58, s56, 8192
    v_exp_f32 v45, v45
    v_exp_f32 v46, v46
    v_exp_f32 v47, v47
    v_exp_f32 v48, v48
    v_exp_f32 v49, v49
    v_smfmac_f32_32x32x32_bf16 v[72:87], v[32:35], v[40:47], v104
    v_exp_f32 v50, v50
    v_exp_f32 v51, v51
    v_exp_f32 v52, v52
    v_exp_f32 v53, v53
    v_exp_f32 v54, v54
    v_exp_f32 v55, v55
    v_exp_f32 v56, v56
    v_exp_f32 v57, v57
    v_smfmac_f32_32x32x32_bf16 v[72:87], v[36:39], v[48:55], v104
    s_waitcnt lgkmcnt(0)
    v_exp_f32 v58, v58
    v_exp_f32 v59, v59
    v_exp_f32 v60, v60
    v_mfma_f32_32x32x16_bf16 v[40:55], v[16:19], v[8:11], 0
    v_exp_f32 v61, v61
    v_exp_f32 v62, v62
    v_exp_f32 v63, v63
    v_exp_f32 v64, v64
    v_exp_f32 v65, v65
    v_smfmac_f32_32x32x32_bf16 v[88:103], v[32:35], v[56:63], v104
    buffer_load_dword v110, v121, s[16:19], s58 offen
    buffer_load_dwordx4 a[252:255], v108, s[16:19], s54 offen offset:3072
    v_exp_f32 v66, v66
    v_exp_f32 v67, v67
    v_exp_f32 v68, v68
    v_exp_f32 v69, v69
    v_exp_f32 v70, v70
    v_exp_f32 v71, v71
    v_exp_f32 v40, v40
    v_exp_f32 v41, v41
    v_smfmac_f32_32x32x32_bf16 v[88:103], v[36:39], v[64:71], v104
    ds_read_b128 v[20:23], v105 offset:24960
    ds_read_b128 v[32:35], v106 offset:24960
    ds_read_b128 v[36:39], v107 offset:24960
    v_exp_f32 v42, v42
    v_exp_f32 v43, v43
    v_exp_f32 v44, v44
    v_mfma_f32_32x32x16_bf16 v[56:71], v[16:19], v[12:15], 0
    s_xor_b32 s52, s50, 114688
    v_exp_f32 v45, v45
    v_exp_f32 v46, v46
    v_exp_f32 v47, v47
    v_exp_f32 v48, v48
    v_exp_f32 v49, v49
    v_smfmac_f32_32x32x32_bf16 v[72:87], v[24:27], v[40:47], v104
    s_add_u32 m0, s51, 116480
    s_add_u32 s54, s53, 65536
    v_exp_f32 v50, v50
    v_exp_f32 v51, v51
    v_exp_f32 v52, v52
    v_exp_f32 v53, v53
    v_exp_f32 v54, v54
    v_exp_f32 v55, v55
    v_exp_f32 v56, v56
    v_exp_f32 v57, v57
    v_smfmac_f32_32x32x32_bf16 v[72:87], v[28:31], v[48:55], v104
    s_waitcnt lgkmcnt(0)
    v_exp_f32 v58, v58
    v_exp_f32 v59, v59
    v_exp_f32 v60, v60
    v_mfma_f32_32x32x16_bf16 v[40:55], v[20:23], v[8:11], 0
    v_exp_f32 v61, v61
    v_exp_f32 v62, v62
    v_exp_f32 v63, v63
    v_exp_f32 v64, v64
    v_exp_f32 v65, v65
    v_smfmac_f32_32x32x32_bf16 v[88:103], v[24:27], v[56:63], v104
    buffer_load_dwordx4 v108, s[12:15], s52 offen lds
    buffer_load_dwordx4 v108, s[12:15], s52 offen offset:1024 lds
    buffer_load_dwordx4 v[128:131], v108, s[16:19], s54 offen offset:0
    buffer_load_dwordx4 v[132:135], v108, s[16:19], s54 offen offset:1024
    v_exp_f32 v66, v66
    v_exp_f32 v67, v67
    v_exp_f32 v68, v68
    v_exp_f32 v69, v69
    v_exp_f32 v70, v70
    v_exp_f32 v71, v71
    v_exp_f32 v40, v40
    v_exp_f32 v41, v41
    v_smfmac_f32_32x32x32_bf16 v[88:103], v[28:31], v[64:71], v104
    ds_read_b128 v[16:19], v105 offset:27040
    ds_read_b128 v[24:27], v106 offset:27040
    ds_read_b128 v[28:31], v107 offset:27040
    v_exp_f32 v42, v42
    v_exp_f32 v43, v43
    v_exp_f32 v44, v44
    v_mfma_f32_32x32x16_bf16 v[56:71], v[20:23], v[12:15], 0
    s_add_u32 s52, s53, 120832
    v_exp_f32 v45, v45
    v_exp_f32 v46, v46
    v_exp_f32 v47, v47
    v_exp_f32 v48, v48
    v_exp_f32 v49, v49
    v_smfmac_f32_32x32x32_bf16 v[72:87], v[32:35], v[40:47], v104
    s_add_u32 m0, s55, 73728
    s_add_u32 s58, s56, 16384
    v_exp_f32 v50, v50
    v_exp_f32 v51, v51
    v_exp_f32 v52, v52
    v_exp_f32 v53, v53
    v_exp_f32 v54, v54
    v_exp_f32 v55, v55
    v_exp_f32 v56, v56
    v_exp_f32 v57, v57
    v_smfmac_f32_32x32x32_bf16 v[72:87], v[36:39], v[48:55], v104
    s_waitcnt lgkmcnt(0)
    v_exp_f32 v58, v58
    v_exp_f32 v59, v59
    v_exp_f32 v60, v60
    v_mfma_f32_32x32x16_bf16 v[40:55], v[16:19], v[8:11], 0
    v_exp_f32 v61, v61
    v_exp_f32 v62, v62
    v_exp_f32 v63, v63
    v_exp_f32 v64, v64
    v_exp_f32 v65, v65
    v_smfmac_f32_32x32x32_bf16 v[88:103], v[32:35], v[56:63], v104
    buffer_load_dwordx4 v108, s[16:19], s52 offen lds
    buffer_load_dwordx4 v108, s[16:19], s52 offen offset:1024 lds
    buffer_load_dword v110, v121, s[16:19], s58 offen
    buffer_load_dwordx4 v[136:139], v108, s[16:19], s54 offen offset:2048
    v_exp_f32 v66, v66
    v_exp_f32 v67, v67
    v_exp_f32 v68, v68
    v_exp_f32 v69, v69
    v_exp_f32 v70, v70
    v_exp_f32 v71, v71
    v_exp_f32 v40, v40
    v_exp_f32 v41, v41
    v_smfmac_f32_32x32x32_bf16 v[88:103], v[36:39], v[64:71], v104
    ds_read_b128 v[20:23], v105 offset:29120
    ds_read_b128 v[32:35], v106 offset:29120
    ds_read_b128 v[36:39], v107 offset:29120
    v_exp_f32 v42, v42
    v_exp_f32 v43, v43
    v_exp_f32 v44, v44
    v_mfma_f32_32x32x16_bf16 v[56:71], v[16:19], v[12:15], 0
    s_add_u32 s58, s56, 24576
    v_exp_f32 v45, v45
    v_exp_f32 v46, v46
    v_exp_f32 v47, v47
    v_exp_f32 v48, v48
    v_exp_f32 v49, v49
    v_smfmac_f32_32x32x32_bf16 v[72:87], v[24:27], v[40:47], v104
    v_exp_f32 v50, v50
    v_exp_f32 v51, v51
    v_exp_f32 v52, v52
    v_exp_f32 v53, v53
    v_exp_f32 v54, v54
    v_exp_f32 v55, v55
    v_exp_f32 v56, v56
    v_exp_f32 v57, v57
    v_smfmac_f32_32x32x32_bf16 v[72:87], v[28:31], v[48:55], v104
    s_waitcnt lgkmcnt(0)
    v_exp_f32 v58, v58
    v_exp_f32 v59, v59
    v_exp_f32 v60, v60
    v_mfma_f32_32x32x16_bf16 v[40:55], v[20:23], v[8:11], 0
    v_exp_f32 v61, v61
    v_exp_f32 v62, v62
    v_exp_f32 v63, v63
    v_exp_f32 v64, v64
    v_exp_f32 v65, v65
    v_smfmac_f32_32x32x32_bf16 v[88:103], v[24:27], v[56:63], v104
    buffer_load_dword v110, v121, s[16:19], s58 offen
    buffer_load_dwordx4 v[140:143], v108, s[16:19], s54 offen offset:3072
    v_exp_f32 v66, v66
    v_exp_f32 v67, v67
    v_exp_f32 v68, v68
    v_exp_f32 v69, v69
    v_exp_f32 v70, v70
    v_exp_f32 v71, v71
    v_exp_f32 v40, v40
    v_exp_f32 v41, v41
    v_smfmac_f32_32x32x32_bf16 v[88:103], v[28:31], v[64:71], v104
    ds_read_b128 v[16:19], v105 offset:31200
    ds_read_b128 v[24:27], v106 offset:31200
    ds_read_b128 v[28:31], v107 offset:31200
    v_exp_f32 v42, v42
    v_exp_f32 v43, v43
    v_exp_f32 v44, v44
    v_mfma_f32_32x32x16_bf16 v[56:71], v[20:23], v[12:15], 0
    s_add_u32 s54, s53, 69632
    v_exp_f32 v45, v45
    v_exp_f32 v46, v46
    v_exp_f32 v47, v47
    v_exp_f32 v48, v48
    v_exp_f32 v49, v49
    v_smfmac_f32_32x32x32_bf16 v[72:87], v[32:35], v[40:47], v104
    v_exp_f32 v50, v50
    v_exp_f32 v51, v51
    v_exp_f32 v52, v52
    v_exp_f32 v53, v53
    v_exp_f32 v54, v54
    v_exp_f32 v55, v55
    v_exp_f32 v56, v56
    v_exp_f32 v57, v57
    v_smfmac_f32_32x32x32_bf16 v[72:87], v[36:39], v[48:55], v104
    s_waitcnt lgkmcnt(0)
    v_exp_f32 v58, v58
    v_exp_f32 v59, v59
    v_exp_f32 v60, v60
    v_mfma_f32_32x32x16_bf16 v[40:55], v[16:19], v[8:11], 0
    v_exp_f32 v61, v61
    v_exp_f32 v62, v62
    v_exp_f32 v63, v63
    v_exp_f32 v64, v64
    v_exp_f32 v65, v65
    v_smfmac_f32_32x32x32_bf16 v[88:103], v[32:35], v[56:63], v104
    buffer_load_dwordx4 v[144:147], v108, s[16:19], s54 offen offset:0
    buffer_load_dwordx4 v[148:151], v108, s[16:19], s54 offen offset:1024
    buffer_load_dwordx4 v[152:155], v108, s[16:19], s54 offen offset:2048
    buffer_load_dwordx4 v[156:159], v108, s[16:19], s54 offen offset:3072
    v_exp_f32 v66, v66
    v_exp_f32 v67, v67
    v_exp_f32 v68, v68
    v_exp_f32 v69, v69
    v_exp_f32 v70, v70
    v_exp_f32 v71, v71
    v_exp_f32 v40, v40
    v_exp_f32 v41, v41
    v_smfmac_f32_32x32x32_bf16 v[88:103], v[36:39], v[64:71], v104
    ds_read_b128 v[20:23], v105 offset:33280
    ds_read_b128 v[32:35], v106 offset:33280
    ds_read_b128 v[36:39], v107 offset:33280
    v_exp_f32 v42, v42
    v_exp_f32 v43, v43
    v_exp_f32 v44, v44
    v_mfma_f32_32x32x16_bf16 v[56:71], v[16:19], v[12:15], 0
    s_xor_b32 s52, s50, 122880
    v_exp_f32 v45, v45
    v_exp_f32 v46, v46
    v_exp_f32 v47, v47
    v_exp_f32 v48, v48
    v_exp_f32 v49, v49
    v_smfmac_f32_32x32x32_bf16 v[72:87], v[24:27], v[40:47], v104
    s_add_u32 m0, s51, 124800
    s_add_u32 s58, s56, 32768
    v_exp_f32 v50, v50
    v_exp_f32 v51, v51
    v_exp_f32 v52, v52
    v_exp_f32 v53, v53
    v_exp_f32 v54, v54
    v_exp_f32 v55, v55
    v_exp_f32 v56, v56
    v_exp_f32 v57, v57
    v_smfmac_f32_32x32x32_bf16 v[72:87], v[28:31], v[48:55], v104
    s_waitcnt lgkmcnt(0)
    s_add_u32 s54, s53, 73728
    v_exp_f32 v58, v58
    v_exp_f32 v59, v59
    v_exp_f32 v60, v60
    v_mfma_f32_32x32x16_bf16 v[40:55], v[20:23], v[8:11], 0
    v_exp_f32 v61, v61
    v_exp_f32 v62, v62
    v_exp_f32 v63, v63
    v_exp_f32 v64, v64
    v_exp_f32 v65, v65
    v_smfmac_f32_32x32x32_bf16 v[88:103], v[24:27], v[56:63], v104
    buffer_load_dwordx4 v108, s[12:15], s52 offen lds
    buffer_load_dwordx4 v108, s[12:15], s52 offen offset:1024 lds
    buffer_load_dword v110, v121, s[16:19], s58 offen
    buffer_load_dwordx4 v[160:163], v108, s[16:19], s54 offen offset:0
    v_exp_f32 v66, v66
    v_exp_f32 v67, v67
    v_exp_f32 v68, v68
    v_exp_f32 v69, v69
    v_exp_f32 v70, v70
    v_exp_f32 v71, v71
    v_exp_f32 v40, v40
    v_exp_f32 v41, v41
    v_smfmac_f32_32x32x32_bf16 v[88:103], v[28:31], v[64:71], v104
    s_waitcnt vmcnt(28)
    s_barrier
    ds_read_b128 v[16:19], v105 offset:35360
    ds_read_b128 v[24:27], v106 offset:35360
    ds_read_b128 v[28:31], v107 offset:35360
    v_exp_f32 v42, v42
    v_exp_f32 v43, v43
    v_exp_f32 v44, v44
    v_mfma_f32_32x32x16_bf16 v[56:71], v[20:23], v[12:15], 0
    s_add_u32 s58, s56, 40960
    v_exp_f32 v45, v45
    v_exp_f32 v46, v46
    v_exp_f32 v47, v47
    v_exp_f32 v48, v48
    v_exp_f32 v49, v49
    v_smfmac_f32_32x32x32_bf16 v[72:87], v[32:35], v[40:47], v104
    v_exp_f32 v50, v50
    v_exp_f32 v51, v51
    v_exp_f32 v52, v52
    v_exp_f32 v53, v53
    v_exp_f32 v54, v54
    v_exp_f32 v55, v55
    v_exp_f32 v56, v56
    v_exp_f32 v57, v57
    v_smfmac_f32_32x32x32_bf16 v[72:87], v[36:39], v[48:55], v104
    s_waitcnt lgkmcnt(0)
    v_exp_f32 v58, v58
    v_exp_f32 v59, v59
    v_exp_f32 v60, v60
    v_mfma_f32_32x32x16_bf16 v[40:55], v[16:19], v[8:11], 0
    v_exp_f32 v61, v61
    v_exp_f32 v62, v62
    v_exp_f32 v63, v63
    v_exp_f32 v64, v64
    v_exp_f32 v65, v65
    v_smfmac_f32_32x32x32_bf16 v[88:103], v[32:35], v[56:63], v104
    buffer_load_dword v110, v121, s[16:19], s58 offen
    buffer_load_dwordx4 v[164:167], v108, s[16:19], s54 offen offset:1024
    buffer_load_dwordx4 v[168:171], v108, s[16:19], s54 offen offset:2048
    buffer_load_dwordx4 v[172:175], v108, s[16:19], s54 offen offset:3072
    v_exp_f32 v66, v66
    v_exp_f32 v67, v67
    v_exp_f32 v68, v68
    v_exp_f32 v69, v69
    v_exp_f32 v70, v70
    v_exp_f32 v71, v71
    v_exp_f32 v40, v40
    v_exp_f32 v41, v41
    v_smfmac_f32_32x32x32_bf16 v[88:103], v[36:39], v[64:71], v104
    ds_read_b128 v[20:23], v105 offset:37440
    ds_read_b128 v[32:35], v106 offset:37440
    ds_read_b128 v[36:39], v107 offset:37440
    v_exp_f32 v42, v42
    v_exp_f32 v43, v43
    v_exp_f32 v44, v44
    v_mfma_f32_32x32x16_bf16 v[56:71], v[16:19], v[12:15], 0
    s_add_u32 s52, s53, 122880
    v_exp_f32 v45, v45
    v_exp_f32 v46, v46
    v_exp_f32 v47, v47
    v_exp_f32 v48, v48
    v_exp_f32 v49, v49
    v_smfmac_f32_32x32x32_bf16 v[72:87], v[24:27], v[40:47], v104
    s_add_u32 m0, s55, 81920
    s_add_u32 s54, s53, 77824
    v_exp_f32 v50, v50
    v_exp_f32 v51, v51
    v_exp_f32 v52, v52
    v_exp_f32 v53, v53
    v_exp_f32 v54, v54
    v_exp_f32 v55, v55
    v_exp_f32 v56, v56
    v_exp_f32 v57, v57
    v_smfmac_f32_32x32x32_bf16 v[72:87], v[28:31], v[48:55], v104
    s_waitcnt lgkmcnt(0)
    v_exp_f32 v58, v58
    v_exp_f32 v59, v59
    v_exp_f32 v60, v60
    v_mfma_f32_32x32x16_bf16 v[40:55], v[20:23], v[8:11], 0
    v_exp_f32 v61, v61
    v_exp_f32 v62, v62
    v_exp_f32 v63, v63
    v_exp_f32 v64, v64
    v_exp_f32 v65, v65
    v_smfmac_f32_32x32x32_bf16 v[88:103], v[24:27], v[56:63], v104
    buffer_load_dwordx4 v108, s[16:19], s52 offen lds
    buffer_load_dwordx4 v108, s[16:19], s52 offen offset:1024 lds
    buffer_load_dwordx4 v[176:179], v108, s[16:19], s54 offen offset:0
    buffer_load_dwordx4 v[180:183], v108, s[16:19], s54 offen offset:1024
    v_exp_f32 v66, v66
    v_exp_f32 v67, v67
    v_exp_f32 v68, v68
    v_exp_f32 v69, v69
    v_exp_f32 v70, v70
    v_exp_f32 v71, v71
    v_exp_f32 v40, v40
    v_exp_f32 v41, v41
    v_smfmac_f32_32x32x32_bf16 v[88:103], v[28:31], v[64:71], v104
    ds_read_b128 v[16:19], v105 offset:39520
    ds_read_b128 v[24:27], v106 offset:39520
    ds_read_b128 v[28:31], v107 offset:39520
    v_exp_f32 v42, v42
    v_exp_f32 v43, v43
    v_exp_f32 v44, v44
    v_mfma_f32_32x32x16_bf16 v[56:71], v[20:23], v[12:15], 0
    s_add_u32 s58, s56, 49152
    v_exp_f32 v45, v45
    v_exp_f32 v46, v46
    v_exp_f32 v47, v47
    v_exp_f32 v48, v48
    v_exp_f32 v49, v49
    v_smfmac_f32_32x32x32_bf16 v[72:87], v[32:35], v[40:47], v104
    v_exp_f32 v50, v50
    v_exp_f32 v51, v51
    v_exp_f32 v52, v52
    v_exp_f32 v53, v53
    v_exp_f32 v54, v54
    v_exp_f32 v55, v55
    v_exp_f32 v56, v56
    v_exp_f32 v57, v57
    v_smfmac_f32_32x32x32_bf16 v[72:87], v[36:39], v[48:55], v104
    s_waitcnt lgkmcnt(0)
    v_exp_f32 v58, v58
    v_exp_f32 v59, v59
    v_exp_f32 v60, v60
    v_mfma_f32_32x32x16_bf16 v[40:55], v[16:19], v[8:11], 0
    v_exp_f32 v61, v61
    v_exp_f32 v62, v62
    v_exp_f32 v63, v63
    v_exp_f32 v64, v64
    v_exp_f32 v65, v65
    v_smfmac_f32_32x32x32_bf16 v[88:103], v[32:35], v[56:63], v104
    buffer_load_dword v110, v121, s[16:19], s58 offen
    buffer_load_dwordx4 v[184:187], v108, s[16:19], s54 offen offset:2048
    buffer_load_dwordx4 v[188:191], v108, s[16:19], s54 offen offset:3072
    v_exp_f32 v66, v66
    v_exp_f32 v67, v67
    v_exp_f32 v68, v68
    v_exp_f32 v69, v69
    v_exp_f32 v70, v70
    v_exp_f32 v71, v71
    v_exp_f32 v40, v40
    v_exp_f32 v41, v41
    v_smfmac_f32_32x32x32_bf16 v[88:103], v[36:39], v[64:71], v104
    ds_read_b128 v[20:23], v105 offset:41600
    ds_read_b128 v[32:35], v106 offset:41600
    ds_read_b128 v[36:39], v107 offset:41600
    v_exp_f32 v42, v42
    v_exp_f32 v43, v43
    v_exp_f32 v44, v44
    v_mfma_f32_32x32x16_bf16 v[56:71], v[16:19], v[12:15], 0
    s_add_u32 s52, s53, 124928
    v_exp_f32 v45, v45
    v_exp_f32 v46, v46
    v_exp_f32 v47, v47
    v_exp_f32 v48, v48
    v_exp_f32 v49, v49
    v_smfmac_f32_32x32x32_bf16 v[72:87], v[24:27], v[40:47], v104
    s_add_u32 m0, s55, 90112
    s_add_u32 s58, s56, 57344
    v_exp_f32 v50, v50
    v_exp_f32 v51, v51
    v_exp_f32 v52, v52
    v_exp_f32 v53, v53
    v_exp_f32 v54, v54
    v_exp_f32 v55, v55
    v_exp_f32 v56, v56
    v_exp_f32 v57, v57
    v_smfmac_f32_32x32x32_bf16 v[72:87], v[28:31], v[48:55], v104
    s_waitcnt lgkmcnt(0)
    s_add_u32 s54, s53, 81920
    v_exp_f32 v58, v58
    v_exp_f32 v59, v59
    v_exp_f32 v60, v60
    v_mfma_f32_32x32x16_bf16 v[40:55], v[20:23], v[8:11], 0
    v_exp_f32 v61, v61
    v_exp_f32 v62, v62
    v_exp_f32 v63, v63
    v_exp_f32 v64, v64
    v_exp_f32 v65, v65
    v_smfmac_f32_32x32x32_bf16 v[88:103], v[24:27], v[56:63], v104
    buffer_load_dwordx4 v108, s[16:19], s52 offen lds
    buffer_load_dwordx4 v108, s[16:19], s52 offen offset:1024 lds
    buffer_load_dword v110, v121, s[16:19], s58 offen
    buffer_load_dwordx4 v[192:195], v108, s[16:19], s54 offen offset:0
    v_exp_f32 v66, v66
    v_exp_f32 v67, v67
    v_exp_f32 v68, v68
    v_exp_f32 v69, v69
    v_exp_f32 v70, v70
    v_exp_f32 v71, v71
    v_exp_f32 v40, v40
    v_exp_f32 v41, v41
    v_smfmac_f32_32x32x32_bf16 v[88:103], v[28:31], v[64:71], v104
    ds_read_b128 v[16:19], v105 offset:43680
    ds_read_b128 v[24:27], v106 offset:43680
    ds_read_b128 v[28:31], v107 offset:43680
    v_exp_f32 v42, v42
    v_exp_f32 v43, v43
    v_exp_f32 v44, v44
    v_mfma_f32_32x32x16_bf16 v[56:71], v[20:23], v[12:15], 0
    v_exp_f32 v45, v45
    v_exp_f32 v46, v46
    v_exp_f32 v47, v47
    v_exp_f32 v48, v48
    v_exp_f32 v49, v49
    v_smfmac_f32_32x32x32_bf16 v[72:87], v[32:35], v[40:47], v104
    v_exp_f32 v50, v50
    v_exp_f32 v51, v51
    v_exp_f32 v52, v52
    v_exp_f32 v53, v53
    v_exp_f32 v54, v54
    v_exp_f32 v55, v55
    v_exp_f32 v56, v56
    v_exp_f32 v57, v57
    v_smfmac_f32_32x32x32_bf16 v[72:87], v[36:39], v[48:55], v104
    s_waitcnt lgkmcnt(0)
    v_exp_f32 v58, v58
    v_exp_f32 v59, v59
    v_exp_f32 v60, v60
    v_mfma_f32_32x32x16_bf16 v[40:55], v[16:19], v[8:11], 0
    v_exp_f32 v61, v61
    v_exp_f32 v62, v62
    v_exp_f32 v63, v63
    v_exp_f32 v64, v64
    v_exp_f32 v65, v65
    v_smfmac_f32_32x32x32_bf16 v[88:103], v[32:35], v[56:63], v104
    buffer_load_dwordx4 v[196:199], v108, s[16:19], s54 offen offset:1024
    buffer_load_dwordx4 v[200:203], v108, s[16:19], s54 offen offset:2048
    buffer_load_dwordx4 v[204:207], v108, s[16:19], s54 offen offset:3072
    v_exp_f32 v66, v66
    v_exp_f32 v67, v67
    v_exp_f32 v68, v68
    v_exp_f32 v69, v69
    v_exp_f32 v70, v70
    v_exp_f32 v71, v71
    v_exp_f32 v40, v40
    v_exp_f32 v41, v41
    v_smfmac_f32_32x32x32_bf16 v[88:103], v[36:39], v[64:71], v104
    ds_read_b128 v[20:23], v105 offset:45760
    ds_read_b128 v[32:35], v106 offset:45760
    ds_read_b128 v[36:39], v107 offset:45760
    v_exp_f32 v42, v42
    v_exp_f32 v43, v43
    v_exp_f32 v44, v44
    v_mfma_f32_32x32x16_bf16 v[56:71], v[16:19], v[12:15], 0
    s_add_u32 s58, s56, 65536
    v_exp_f32 v45, v45
    v_exp_f32 v46, v46
    v_exp_f32 v47, v47
    v_exp_f32 v48, v48
    v_exp_f32 v49, v49
    v_smfmac_f32_32x32x32_bf16 v[72:87], v[24:27], v[40:47], v104
    s_add_u32 s54, s53, 86016
    v_exp_f32 v50, v50
    v_exp_f32 v51, v51
    v_exp_f32 v52, v52
    v_exp_f32 v53, v53
    v_exp_f32 v54, v54
    v_exp_f32 v55, v55
    v_exp_f32 v56, v56
    v_exp_f32 v57, v57
    v_smfmac_f32_32x32x32_bf16 v[72:87], v[28:31], v[48:55], v104
    s_waitcnt lgkmcnt(0)
    v_exp_f32 v58, v58
    v_exp_f32 v59, v59
    v_exp_f32 v60, v60
    v_mfma_f32_32x32x16_bf16 v[40:55], v[20:23], v[8:11], 0
    v_exp_f32 v61, v61
    v_exp_f32 v62, v62
    v_exp_f32 v63, v63
    v_exp_f32 v64, v64
    v_exp_f32 v65, v65
    v_smfmac_f32_32x32x32_bf16 v[88:103], v[24:27], v[56:63], v104
    buffer_load_dword v110, v121, s[16:19], s58 offen
    buffer_load_dwordx4 v[208:211], v108, s[16:19], s54 offen offset:0
    buffer_load_dwordx4 v[212:215], v108, s[16:19], s54 offen offset:1024
    buffer_load_dwordx4 v[216:219], v108, s[16:19], s54 offen offset:2048
    v_exp_f32 v66, v66
    v_exp_f32 v67, v67
    v_exp_f32 v68, v68
    v_exp_f32 v69, v69
    v_exp_f32 v70, v70
    v_exp_f32 v71, v71
    v_exp_f32 v40, v40
    v_exp_f32 v41, v41
    v_smfmac_f32_32x32x32_bf16 v[88:103], v[28:31], v[64:71], v104
    ds_read_b128 v[16:19], v105 offset:47840
    ds_read_b128 v[24:27], v106 offset:47840
    ds_read_b128 v[28:31], v107 offset:47840
    v_exp_f32 v42, v42
    v_exp_f32 v43, v43
    v_exp_f32 v44, v44
    v_mfma_f32_32x32x16_bf16 v[56:71], v[20:23], v[12:15], 0
    s_add_u32 s58, s56, 73728
    v_exp_f32 v45, v45
    v_exp_f32 v46, v46
    v_exp_f32 v47, v47
    v_exp_f32 v48, v48
    v_exp_f32 v49, v49
    v_smfmac_f32_32x32x32_bf16 v[72:87], v[32:35], v[40:47], v104
    v_exp_f32 v50, v50
    v_exp_f32 v51, v51
    v_exp_f32 v52, v52
    v_exp_f32 v53, v53
    v_exp_f32 v54, v54
    v_exp_f32 v55, v55
    v_exp_f32 v56, v56
    v_exp_f32 v57, v57
    v_smfmac_f32_32x32x32_bf16 v[72:87], v[36:39], v[48:55], v104
    s_waitcnt lgkmcnt(0)
    v_exp_f32 v58, v58
    v_exp_f32 v59, v59
    v_exp_f32 v60, v60
    v_mfma_f32_32x32x16_bf16 v[40:55], v[16:19], v[8:11], 0
    v_exp_f32 v61, v61
    v_exp_f32 v62, v62
    v_exp_f32 v63, v63
    v_exp_f32 v64, v64
    v_exp_f32 v65, v65
    v_smfmac_f32_32x32x32_bf16 v[88:103], v[32:35], v[56:63], v104
    buffer_load_dword v110, v121, s[16:19], s58 offen
    buffer_load_dwordx4 v[220:223], v108, s[16:19], s54 offen offset:3072
    v_exp_f32 v66, v66
    v_exp_f32 v67, v67
    v_exp_f32 v68, v68
    v_exp_f32 v69, v69
    v_exp_f32 v70, v70
    v_exp_f32 v71, v71
    v_exp_f32 v40, v40
    v_exp_f32 v41, v41
    v_smfmac_f32_32x32x32_bf16 v[88:103], v[36:39], v[64:71], v104
    ds_read_b128 v[20:23], v105 offset:49920
    ds_read_b128 v[32:35], v106 offset:49920
    ds_read_b128 v[36:39], v107 offset:49920
    v_exp_f32 v42, v42
    v_exp_f32 v43, v43
    v_exp_f32 v44, v44
    v_mfma_f32_32x32x16_bf16 v[56:71], v[16:19], v[12:15], 0
    s_add_u32 s54, s53, 90112
    v_exp_f32 v45, v45
    v_exp_f32 v46, v46
    v_exp_f32 v47, v47
    v_exp_f32 v48, v48
    v_exp_f32 v49, v49
    v_smfmac_f32_32x32x32_bf16 v[72:87], v[24:27], v[40:47], v104
    v_exp_f32 v50, v50
    v_exp_f32 v51, v51
    v_exp_f32 v52, v52
    v_exp_f32 v53, v53
    v_exp_f32 v54, v54
    v_exp_f32 v55, v55
    v_exp_f32 v56, v56
    v_exp_f32 v57, v57
    v_smfmac_f32_32x32x32_bf16 v[72:87], v[28:31], v[48:55], v104
    s_waitcnt lgkmcnt(0)
    v_exp_f32 v58, v58
    v_exp_f32 v59, v59
    v_exp_f32 v60, v60
    v_mfma_f32_32x32x16_bf16 v[40:55], v[20:23], v[8:11], 0
    v_exp_f32 v61, v61
    v_exp_f32 v62, v62
    v_exp_f32 v63, v63
    v_exp_f32 v64, v64
    v_exp_f32 v65, v65
    v_smfmac_f32_32x32x32_bf16 v[88:103], v[24:27], v[56:63], v104
    buffer_load_dwordx4 v[224:227], v108, s[16:19], s54 offen offset:0
    buffer_load_dwordx4 v[228:231], v108, s[16:19], s54 offen offset:1024
    buffer_load_dwordx4 v[232:235], v108, s[16:19], s54 offen offset:2048
    v_exp_f32 v66, v66
    v_exp_f32 v67, v67
    v_exp_f32 v68, v68
    v_exp_f32 v69, v69
    v_exp_f32 v70, v70
    v_exp_f32 v71, v71
    v_exp_f32 v40, v40
    v_exp_f32 v41, v41
    v_smfmac_f32_32x32x32_bf16 v[88:103], v[28:31], v[64:71], v104
    s_waitcnt vmcnt(29)
    s_barrier
    ds_read_b128 v[16:19], v105 offset:52000
    ds_read_b128 v[24:27], v106 offset:52000
    ds_read_b128 v[28:31], v107 offset:52000
    v_exp_f32 v42, v42
    v_exp_f32 v43, v43
    v_exp_f32 v44, v44
    v_mfma_f32_32x32x16_bf16 v[56:71], v[20:23], v[12:15], 0
    s_add_u32 s58, s56, 81920
    v_exp_f32 v45, v45
    v_exp_f32 v46, v46
    v_exp_f32 v47, v47
    v_exp_f32 v48, v48
    v_exp_f32 v49, v49
    v_smfmac_f32_32x32x32_bf16 v[72:87], v[32:35], v[40:47], v104
    v_exp_f32 v50, v50
    v_exp_f32 v51, v51
    v_exp_f32 v52, v52
    v_exp_f32 v53, v53
    v_exp_f32 v54, v54
    v_exp_f32 v55, v55
    v_exp_f32 v56, v56
    v_exp_f32 v57, v57
    v_smfmac_f32_32x32x32_bf16 v[72:87], v[36:39], v[48:55], v104
    s_waitcnt lgkmcnt(0)
    v_exp_f32 v58, v58
    v_exp_f32 v59, v59
    v_exp_f32 v60, v60
    v_mfma_f32_32x32x16_bf16 v[40:55], v[16:19], v[8:11], 0
    v_exp_f32 v61, v61
    v_exp_f32 v62, v62
    v_exp_f32 v63, v63
    v_exp_f32 v64, v64
    v_exp_f32 v65, v65
    v_smfmac_f32_32x32x32_bf16 v[88:103], v[32:35], v[56:63], v104
    buffer_load_dword v110, v121, s[16:19], s58 offen
    buffer_load_dwordx4 v[236:239], v108, s[16:19], s54 offen offset:3072
    v_exp_f32 v66, v66
    v_exp_f32 v67, v67
    v_exp_f32 v68, v68
    v_exp_f32 v69, v69
    v_exp_f32 v70, v70
    v_exp_f32 v71, v71
    v_exp_f32 v40, v40
    v_exp_f32 v41, v41
    v_smfmac_f32_32x32x32_bf16 v[88:103], v[36:39], v[64:71], v104
    ds_read_b128 v[20:23], v105 offset:54080
    ds_read_b128 v[32:35], v106 offset:54080
    ds_read_b128 v[36:39], v107 offset:54080
    v_exp_f32 v42, v42
    v_exp_f32 v43, v43
    v_exp_f32 v44, v44
    v_mfma_f32_32x32x16_bf16 v[56:71], v[16:19], v[12:15], 0
    s_add_u32 s52, s53, 126976
    v_exp_f32 v45, v45
    v_exp_f32 v46, v46
    v_exp_f32 v47, v47
    v_exp_f32 v48, v48
    v_exp_f32 v49, v49
    v_smfmac_f32_32x32x32_bf16 v[72:87], v[24:27], v[40:47], v104
    s_add_u32 m0, s55, 98304
    s_add_u32 s58, s56, 90112
    v_exp_f32 v50, v50
    v_exp_f32 v51, v51
    v_exp_f32 v52, v52
    v_exp_f32 v53, v53
    v_exp_f32 v54, v54
    v_exp_f32 v55, v55
    v_exp_f32 v56, v56
    v_exp_f32 v57, v57
    v_smfmac_f32_32x32x32_bf16 v[72:87], v[28:31], v[48:55], v104
    s_waitcnt lgkmcnt(0)
    s_add_u32 s54, s53, 94208
    v_exp_f32 v58, v58
    v_exp_f32 v59, v59
    v_exp_f32 v60, v60
    v_mfma_f32_32x32x16_bf16 v[40:55], v[20:23], v[8:11], 0
    v_exp_f32 v61, v61
    v_exp_f32 v62, v62
    v_exp_f32 v63, v63
    v_exp_f32 v64, v64
    v_exp_f32 v65, v65
    v_smfmac_f32_32x32x32_bf16 v[88:103], v[24:27], v[56:63], v104
    buffer_load_dwordx4 v108, s[16:19], s52 offen lds
    buffer_load_dwordx4 v108, s[16:19], s52 offen offset:1024 lds
    buffer_load_dword v110, v121, s[16:19], s58 offen
    buffer_load_dwordx4 v[240:243], v108, s[16:19], s54 offen offset:0
    v_exp_f32 v66, v66
    v_exp_f32 v67, v67
    v_exp_f32 v68, v68
    v_exp_f32 v69, v69
    v_exp_f32 v70, v70
    v_exp_f32 v71, v71
    v_exp_f32 v40, v40
    v_exp_f32 v41, v41
    v_smfmac_f32_32x32x32_bf16 v[88:103], v[28:31], v[64:71], v104
    ds_read_b128 v[16:19], v105 offset:56160
    ds_read_b128 v[24:27], v106 offset:56160
    ds_read_b128 v[28:31], v107 offset:56160
    v_exp_f32 v42, v42
    v_exp_f32 v43, v43
    v_exp_f32 v44, v44
    v_mfma_f32_32x32x16_bf16 v[56:71], v[20:23], v[12:15], 0
    s_add_u32 s52, s53, 129024
    v_exp_f32 v45, v45
    v_exp_f32 v46, v46
    v_exp_f32 v47, v47
    v_exp_f32 v48, v48
    v_exp_f32 v49, v49
    v_smfmac_f32_32x32x32_bf16 v[72:87], v[32:35], v[40:47], v104
    s_add_u32 m0, s55, 106496
    v_exp_f32 v50, v50
    v_exp_f32 v51, v51
    v_exp_f32 v52, v52
    v_exp_f32 v53, v53
    v_exp_f32 v54, v54
    v_exp_f32 v55, v55
    v_exp_f32 v56, v56
    v_exp_f32 v57, v57
    v_smfmac_f32_32x32x32_bf16 v[72:87], v[36:39], v[48:55], v104
    s_waitcnt lgkmcnt(0)
    v_exp_f32 v58, v58
    v_exp_f32 v59, v59
    v_exp_f32 v60, v60
    v_mfma_f32_32x32x16_bf16 v[40:55], v[16:19], v[8:11], 0
    v_exp_f32 v61, v61
    v_exp_f32 v62, v62
    v_exp_f32 v63, v63
    v_exp_f32 v64, v64
    v_exp_f32 v65, v65
    v_smfmac_f32_32x32x32_bf16 v[88:103], v[32:35], v[56:63], v104
    buffer_load_dwordx4 v108, s[16:19], s52 offen lds
    buffer_load_dwordx4 v108, s[16:19], s52 offen offset:1024 lds
    buffer_load_dwordx4 v[244:247], v108, s[16:19], s54 offen offset:1024
    buffer_load_dwordx4 v[248:251], v108, s[16:19], s54 offen offset:2048
    v_exp_f32 v66, v66
    v_exp_f32 v67, v67
    v_exp_f32 v68, v68
    v_exp_f32 v69, v69
    v_exp_f32 v70, v70
    v_exp_f32 v71, v71
    v_exp_f32 v40, v40
    v_exp_f32 v41, v41
    v_smfmac_f32_32x32x32_bf16 v[88:103], v[36:39], v[64:71], v104
    ds_read_b128 v[20:23], v105 offset:58240
    ds_read_b128 v[32:35], v106 offset:58240
    ds_read_b128 v[36:39], v107 offset:58240
    v_exp_f32 v42, v42
    v_exp_f32 v43, v43
    v_exp_f32 v44, v44
    v_mfma_f32_32x32x16_bf16 v[56:71], v[16:19], v[12:15], 0
    v_exp_f32 v45, v45
    v_exp_f32 v46, v46
    v_exp_f32 v47, v47
    v_exp_f32 v48, v48
    v_exp_f32 v49, v49
    v_smfmac_f32_32x32x32_bf16 v[72:87], v[24:27], v[40:47], v104
    v_exp_f32 v50, v50
    v_exp_f32 v51, v51
    v_exp_f32 v52, v52
    v_exp_f32 v53, v53
    v_exp_f32 v54, v54
    v_exp_f32 v55, v55
    v_exp_f32 v56, v56
    v_exp_f32 v57, v57
    v_smfmac_f32_32x32x32_bf16 v[72:87], v[28:31], v[48:55], v104
    s_waitcnt lgkmcnt(0)
    v_exp_f32 v58, v58
    v_exp_f32 v59, v59
    v_exp_f32 v60, v60
    v_mfma_f32_32x32x16_bf16 v[40:55], v[20:23], v[8:11], 0
    v_exp_f32 v61, v61
    v_exp_f32 v62, v62
    v_exp_f32 v63, v63
    v_exp_f32 v64, v64
    v_exp_f32 v65, v65
    v_smfmac_f32_32x32x32_bf16 v[88:103], v[24:27], v[56:63], v104
    buffer_load_dwordx4 v[252:255], v108, s[16:19], s54 offen offset:3072
    buffer_load_dwordx4 v[112:115], v7, s[8:11], 0 offen offset:0
    buffer_load_dwordx4 v[116:119], v7, s[8:11], 0 offen offset:512
    v_exp_f32 v66, v66
    v_exp_f32 v67, v67
    v_exp_f32 v68, v68
    v_exp_f32 v69, v69
    v_exp_f32 v70, v70
    v_exp_f32 v71, v71
    v_exp_f32 v40, v40
    v_exp_f32 v41, v41
    v_smfmac_f32_32x32x32_bf16 v[88:103], v[28:31], v[64:71], v104
    ds_read_b128 v[16:19], v105 offset:60320
    ds_read_b128 v[24:27], v106 offset:60320
    ds_read_b128 v[28:31], v107 offset:60320
    v_exp_f32 v42, v42
    v_exp_f32 v43, v43
    v_exp_f32 v44, v44
    v_mfma_f32_32x32x16_bf16 v[56:71], v[20:23], v[12:15], 0
    v_exp_f32 v45, v45
    v_exp_f32 v46, v46
    v_exp_f32 v47, v47
    v_exp_f32 v48, v48
    v_exp_f32 v49, v49
    v_smfmac_f32_32x32x32_bf16 v[72:87], v[32:35], v[40:47], v104
    v_exp_f32 v50, v50
    v_exp_f32 v51, v51
    v_exp_f32 v52, v52
    v_exp_f32 v53, v53
    v_exp_f32 v54, v54
    v_exp_f32 v55, v55
    v_exp_f32 v56, v56
    v_exp_f32 v57, v57
    v_smfmac_f32_32x32x32_bf16 v[72:87], v[36:39], v[48:55], v104
    s_waitcnt lgkmcnt(0)
    v_exp_f32 v58, v58
    v_exp_f32 v59, v59
    v_exp_f32 v60, v60
    v_mfma_f32_32x32x16_bf16 v[40:55], v[16:19], v[8:11], 0
    v_exp_f32 v61, v61
    v_exp_f32 v62, v62
    v_exp_f32 v63, v63
    v_exp_f32 v64, v64
    v_exp_f32 v65, v65
    v_smfmac_f32_32x32x32_bf16 v[88:103], v[32:35], v[56:63], v104
    v_exp_f32 v66, v66
    v_exp_f32 v67, v67
    v_exp_f32 v68, v68
    v_exp_f32 v69, v69
    v_exp_f32 v70, v70
    v_exp_f32 v71, v71
    v_exp_f32 v40, v40
    v_exp_f32 v41, v41
    v_smfmac_f32_32x32x32_bf16 v[88:103], v[36:39], v[64:71], v104
    ds_read_b128 v[20:23], v105 offset:62400
    ds_read_b128 v[32:35], v106 offset:62400
    ds_read_b128 v[36:39], v107 offset:62400
    v_exp_f32 v42, v42
    v_exp_f32 v43, v43
    v_exp_f32 v44, v44
    v_mfma_f32_32x32x16_bf16 v[56:71], v[16:19], v[12:15], 0
    v_exp_f32 v45, v45
    v_exp_f32 v46, v46
    v_exp_f32 v47, v47
    v_exp_f32 v48, v48
    v_exp_f32 v49, v49
    v_smfmac_f32_32x32x32_bf16 v[72:87], v[24:27], v[40:47], v104
    v_exp_f32 v50, v50
    v_exp_f32 v51, v51
    v_exp_f32 v52, v52
    v_exp_f32 v53, v53
    v_exp_f32 v54, v54
    v_exp_f32 v55, v55
    v_exp_f32 v56, v56
    v_exp_f32 v57, v57
    v_smfmac_f32_32x32x32_bf16 v[72:87], v[28:31], v[48:55], v104
    s_waitcnt lgkmcnt(0)
    v_exp_f32 v58, v58
    v_exp_f32 v59, v59
    v_exp_f32 v60, v60
    v_mfma_f32_32x32x16_bf16 v[40:55], v[20:23], v[8:11], 0
    v_exp_f32 v61, v61
    v_exp_f32 v62, v62
    v_exp_f32 v63, v63
    v_exp_f32 v64, v64
    v_exp_f32 v65, v65
    v_smfmac_f32_32x32x32_bf16 v[88:103], v[24:27], v[56:63], v104
    v_exp_f32 v66, v66
    v_exp_f32 v67, v67
    v_exp_f32 v68, v68
    v_exp_f32 v69, v69
    v_exp_f32 v70, v70
    v_exp_f32 v71, v71
    v_exp_f32 v40, v40
    v_add_u32 v105, 64480, v105
    v_add_u32 v106, 64480, v106
    v_add_u32 v107, 64480, v107
    v_exp_f32 v41, v41
    v_smfmac_f32_32x32x32_bf16 v[88:103], v[28:31], v[64:71], v104
    ds_read_b128 v[16:19], v105 offset:0
    ds_read_b128 v[24:27], v106 offset:0
    ds_read_b128 v[28:31], v107 offset:0
    v_exp_f32 v42, v42
    v_exp_f32 v43, v43
    v_exp_f32 v44, v44
    v_mfma_f32_32x32x16_bf16 v[56:71], v[20:23], v[12:15], 0
    v_exp_f32 v45, v45
    v_exp_f32 v46, v46
    v_exp_f32 v47, v47
    v_exp_f32 v48, v48
    v_exp_f32 v49, v49
    v_smfmac_f32_32x32x32_bf16 v[72:87], v[32:35], v[40:47], v104
    v_exp_f32 v50, v50
    v_exp_f32 v51, v51
    v_exp_f32 v52, v52
    v_exp_f32 v53, v53
    v_exp_f32 v54, v54
    v_exp_f32 v55, v55
    v_exp_f32 v56, v56
    v_exp_f32 v57, v57
    v_smfmac_f32_32x32x32_bf16 v[72:87], v[36:39], v[48:55], v104
    s_waitcnt lgkmcnt(0)
    v_exp_f32 v58, v58
    v_exp_f32 v59, v59
    v_exp_f32 v60, v60
    v_mfma_f32_32x32x16_bf16 v[40:55], v[16:19], v[8:11], 0
    v_exp_f32 v61, v61
    v_exp_f32 v62, v62
    v_exp_f32 v63, v63
    v_exp_f32 v64, v64
    v_exp_f32 v65, v65
    v_smfmac_f32_32x32x32_bf16 v[88:103], v[32:35], v[56:63], v104
    v_exp_f32 v66, v66
    v_exp_f32 v67, v67
    v_exp_f32 v68, v68
    v_exp_f32 v69, v69
    v_exp_f32 v70, v70
    v_exp_f32 v71, v71
    v_exp_f32 v40, v40
    v_exp_f32 v41, v41
    v_smfmac_f32_32x32x32_bf16 v[88:103], v[36:39], v[64:71], v104
    ds_read_b128 v[20:23], v105 offset:2080
    ds_read_b128 v[32:35], v106 offset:2080
    ds_read_b128 v[36:39], v107 offset:2080
    v_exp_f32 v42, v42
    v_exp_f32 v43, v43
    v_exp_f32 v44, v44
    v_mfma_f32_32x32x16_bf16 v[56:71], v[16:19], v[12:15], 0
    v_exp_f32 v45, v45
    v_exp_f32 v46, v46
    v_exp_f32 v47, v47
    v_exp_f32 v48, v48
    v_exp_f32 v49, v49
    v_smfmac_f32_32x32x32_bf16 v[72:87], v[24:27], v[40:47], v104
    v_exp_f32 v50, v50
    v_exp_f32 v51, v51
    v_exp_f32 v52, v52
    v_exp_f32 v53, v53
    v_exp_f32 v54, v54
    v_exp_f32 v55, v55
    v_exp_f32 v56, v56
    v_exp_f32 v57, v57
    v_smfmac_f32_32x32x32_bf16 v[72:87], v[28:31], v[48:55], v104
    s_waitcnt lgkmcnt(0)
    v_exp_f32 v58, v58
    v_exp_f32 v59, v59
    v_exp_f32 v60, v60
    v_mfma_f32_32x32x16_bf16 v[40:55], v[20:23], v[8:11], 0
    v_exp_f32 v61, v61
    v_exp_f32 v62, v62
    v_exp_f32 v63, v63
    v_exp_f32 v64, v64
    v_exp_f32 v65, v65
    v_smfmac_f32_32x32x32_bf16 v[88:103], v[24:27], v[56:63], v104
    v_exp_f32 v66, v66
    v_exp_f32 v67, v67
    v_exp_f32 v68, v68
    v_exp_f32 v69, v69
    v_exp_f32 v70, v70
    v_exp_f32 v71, v71
    v_exp_f32 v40, v40
    v_exp_f32 v41, v41
    v_smfmac_f32_32x32x32_bf16 v[88:103], v[28:31], v[64:71], v104
    v_exp_f32 v42, v42
    v_exp_f32 v43, v43
    v_exp_f32 v44, v44
    v_mfma_f32_32x32x16_bf16 v[56:71], v[20:23], v[12:15], 0
    v_exp_f32 v45, v45
    v_exp_f32 v46, v46
    v_exp_f32 v47, v47
    v_exp_f32 v48, v48
    v_exp_f32 v49, v49
    v_smfmac_f32_32x32x32_bf16 v[72:87], v[32:35], v[40:47], v104
    v_exp_f32 v50, v50
    v_exp_f32 v51, v51
    v_exp_f32 v52, v52
    v_exp_f32 v53, v53
    v_exp_f32 v54, v54
    v_exp_f32 v55, v55
    v_exp_f32 v56, v56
    v_exp_f32 v57, v57
    v_smfmac_f32_32x32x32_bf16 v[72:87], v[36:39], v[48:55], v104
    v_exp_f32 v58, v58
    v_exp_f32 v59, v59
    v_exp_f32 v60, v60
    v_exp_f32 v61, v61
    v_exp_f32 v62, v62
    v_exp_f32 v63, v63
    v_exp_f32 v64, v64
    v_exp_f32 v65, v65
    v_smfmac_f32_32x32x32_bf16 v[88:103], v[32:35], v[56:63], v104
    v_exp_f32 v66, v66
    v_exp_f32 v67, v67
    v_exp_f32 v68, v68
    v_exp_f32 v69, v69
    v_exp_f32 v70, v70
    v_exp_f32 v71, v71
    s_nop 1
    v_smfmac_f32_32x32x32_bf16 v[88:103], v[36:39], v[64:71], v104
    s_mov_b32 s61, 0
attn_norm:
    v_rcp_f32 v2, v80
    v_maximum3_f32 v4, |v72|, |v73|, |v73|
    v_maximum3_f32 v4, v4, |v74|, |v75|
    v_maximum3_f32 v4, v4, |v76|, |v77|
    v_maximum3_f32 v4, v4, |v78|, |v79|
    v_pk_mul_f32 v[72:73], v[72:73], v[2:3] op_sel_hi:[1,0]
    v_pk_mul_f32 v[74:75], v[74:75], v[2:3] op_sel_hi:[1,0]
    v_pk_mul_f32 v[76:77], v[76:77], v[2:3] op_sel_hi:[1,0]
    v_pk_mul_f32 v[78:79], v[78:79], v[2:3] op_sel_hi:[1,0]
    v_cvt_pk_bf16_f32 v72, v72, v73
    v_cvt_pk_bf16_f32 v73, v74, v75
    v_cvt_pk_bf16_f32 v74, v76, v77
    v_cvt_pk_bf16_f32 v75, v78, v79
    ds_write_b64 v123, v[72:73] offset:0
    ds_write_b64 v123, v[74:75] offset:16
    v_rcp_f32 v2, v96
    v_maximum3_f32 v4, v4, |v88|, |v89|
    v_maximum3_f32 v4, v4, |v90|, |v91|
    v_maximum3_f32 v4, v4, |v92|, |v93|
    v_maximum3_f32 v4, v4, |v94|, |v95|
    v_pk_mul_f32 v[88:89], v[88:89], v[2:3] op_sel_hi:[1,0]
    v_pk_mul_f32 v[90:91], v[90:91], v[2:3] op_sel_hi:[1,0]
    v_pk_mul_f32 v[92:93], v[92:93], v[2:3] op_sel_hi:[1,0]
    v_pk_mul_f32 v[94:95], v[94:95], v[2:3] op_sel_hi:[1,0]
    v_cvt_pk_bf16_f32 v88, v88, v89
    v_cvt_pk_bf16_f32 v89, v90, v91
    v_cvt_pk_bf16_f32 v90, v92, v93
    v_cvt_pk_bf16_f32 v91, v94, v95
    ds_write_b64 v123, v[88:89] offset:128
    ds_write_b64 v123, v[90:91] offset:144
    v_cmpx_le_f32 vcc, 0x33800000, v80
    v_cmpx_ge_f32 vcc, 0x53800000, v80
    v_cmpx_le_f32 vcc, 0x33800000, v96
    v_cmpx_ge_f32 vcc, 0x53800000, v96
    v_cmpx_ge_f32 vcc, 0x7b800000, v4
    s_nop 0
    s_cmp_eq_u64 exec, -1
    s_mov_b64 exec, -1
    s_cselect_b32 s60, 1, s61
    s_cmp_eq_u32 s60, 0
    s_cbranch_scc1 attn_fallback
    v_mov_b64 v[40:41], 0
    v_mov_b64 v[42:43], 0
    v_mov_b64 v[44:45], 0
    v_mov_b64 v[46:47], 0
    v_mov_b64 v[48:49], 0
    v_mov_b64 v[50:51], 0
    v_mov_b64 v[52:53], 0
    v_mov_b64 v[54:55], 0
    v_mov_b64 v[56:57], 0
    v_mov_b64 v[58:59], 0
    v_mov_b64 v[60:61], 0
    v_mov_b64 v[62:63], 0
    v_mov_b64 v[64:65], 0
    v_mov_b64 v[66:67], 0
    v_mov_b64 v[68:69], 0
    v_mov_b64 v[70:71], 0
    s_waitcnt vmcnt(0) lgkmcnt(0)
    s_barrier
    ds_read_b128 v[88:91], v124 offset:512
    ds_read_b128 v[92:95], v124 offset:640
    ds_read_b128 v[72:75], v124 offset:0
    ds_read_b128 v[76:79], v124 offset:128
    ds_read_b128 v[80:83], v124 offset:256
    ds_read_b128 v[84:87], v124 offset:384
    ds_read_b128 v[96:99], v124 offset:768
    ds_read_b128 v[100:103], v124 offset:896
    v_add_u32 v104, s55, v108
    v_add_u32 v105, 0x10000, v104
    v_add_u32 v106, 141824, v104
    s_mul_i32 s69, s5, 98304
    s_add_u32 s69, s69, 30408704
    s_lshl_b32 s58, s6, 12
    s_add_u32 s69, s69, s58
    s_cmp_lt_u32 s5, 29
    s_cselect_b32 s69, s69, 2130706432
    s_waitcnt lgkmcnt(7)
    v_smfmac_f32_16x16x64_bf16 v[40:43], v[88:91], v[128:135], v125
    v_lshlrev_b32 v24, 4, v0
    v_smfmac_f32_16x16x64_bf16 v[44:47], v[88:91], v[136:143], v125
    v_add_u32 v24, 133120, v24
    v_smfmac_f32_16x16x64_bf16 v[48:51], v[88:91], v[144:151], v125
    v_lshlrev_b32 v8, 16, v112
    v_smfmac_f32_16x16x64_bf16 v[52:55], v[88:91], v[152:159], v125
    v_and_b32 v9, 0xffff0000, v112
    v_smfmac_f32_16x16x64_bf16 v[56:59], v[88:91], v[160:167], v125
    v_lshlrev_b32 v10, 16, v113
    v_smfmac_f32_16x16x64_bf16 v[60:63], v[88:91], v[168:175], v125
    v_and_b32 v11, 0xffff0000, v113
    v_smfmac_f32_16x16x64_bf16 v[64:67], v[88:91], v[176:183], v125
    v_lshlrev_b32 v12, 16, v114
    v_smfmac_f32_16x16x64_bf16 v[68:71], v[88:91], v[184:191], v125
    v_and_b32 v13, 0xffff0000, v114
    s_waitcnt lgkmcnt(6)
    v_smfmac_f32_16x16x64_bf16 v[40:43], v[92:95], v[192:199], v125
    ds_read_b128 v[128:131], v106 offset:0
    v_smfmac_f32_16x16x64_bf16 v[44:47], v[92:95], v[200:207], v125
    ds_read_b128 v[132:135], v106 offset:1024
    v_smfmac_f32_16x16x64_bf16 v[48:51], v[92:95], v[208:215], v125
    ds_read_b128 v[136:139], v106 offset:8192
    v_smfmac_f32_16x16x64_bf16 v[52:55], v[92:95], v[216:223], v125
    ds_read_b128 v[140:143], v106 offset:9216
    v_smfmac_f32_16x16x64_bf16 v[56:59], v[92:95], v[224:231], v125
    ds_read_b128 v[144:147], v104 offset:0
    v_smfmac_f32_16x16x64_bf16 v[60:63], v[92:95], v[232:239], v125
    ds_read_b128 v[148:151], v104 offset:1024
    v_smfmac_f32_16x16x64_bf16 v[64:67], v[92:95], v[240:247], v125
    ds_read_b128 v[152:155], v104 offset:8192
    v_smfmac_f32_16x16x64_bf16 v[68:71], v[92:95], v[248:255], v125
    ds_read_b128 v[156:159], v104 offset:9216
    s_waitcnt lgkmcnt(13)
    v_smfmac_f32_16x16x64_bf16 v[40:43], v[72:75], a[0:7], v125
    ds_read_b128 v[160:163], v104 offset:16384
    v_smfmac_f32_16x16x64_bf16 v[44:47], v[72:75], a[8:15], v125
    ds_read_b128 v[164:167], v104 offset:17408
    v_smfmac_f32_16x16x64_bf16 v[48:51], v[72:75], a[16:23], v125
    ds_read_b128 v[168:171], v104 offset:24576
    v_smfmac_f32_16x16x64_bf16 v[52:55], v[72:75], a[24:31], v125
    ds_read_b128 v[172:175], v104 offset:25600
    v_smfmac_f32_16x16x64_bf16 v[56:59], v[72:75], a[32:39], v125
    ds_read_b128 v[176:179], v104 offset:32768
    v_smfmac_f32_16x16x64_bf16 v[60:63], v[72:75], a[40:47], v125
    ds_read_b128 v[180:183], v104 offset:33792
    v_smfmac_f32_16x16x64_bf16 v[64:67], v[72:75], a[48:55], v125
    ds_read_b128 v[184:187], v104 offset:40960
    v_smfmac_f32_16x16x64_bf16 v[68:71], v[72:75], a[56:63], v125
    ds_read_b128 v[188:191], v104 offset:41984
    s_waitcnt lgkmcnt(15)
    v_smfmac_f32_16x16x64_bf16 v[40:43], v[76:79], a[64:71], v125
    ds_read_b128 v[192:195], v104 offset:49152
    v_smfmac_f32_16x16x64_bf16 v[44:47], v[76:79], a[72:79], v125
    ds_read_b128 v[196:199], v104 offset:50176
    v_smfmac_f32_16x16x64_bf16 v[48:51], v[76:79], a[80:87], v125
    ds_read_b128 v[200:203], v104 offset:57344
    v_smfmac_f32_16x16x64_bf16 v[52:55], v[76:79], a[88:95], v125
    ds_read_b128 v[204:207], v104 offset:58368
    v_smfmac_f32_16x16x64_bf16 v[56:59], v[76:79], a[96:103], v125
    ds_read_b128 v[208:211], v105 offset:0
    v_smfmac_f32_16x16x64_bf16 v[60:63], v[76:79], a[104:111], v125
    ds_read_b128 v[212:215], v105 offset:1024
    v_smfmac_f32_16x16x64_bf16 v[64:67], v[76:79], a[112:119], v125
    ds_read_b128 v[216:219], v105 offset:8192
    v_smfmac_f32_16x16x64_bf16 v[68:71], v[76:79], a[120:127], v125
    ds_read_b128 v[220:223], v105 offset:9216
    s_waitcnt lgkmcnt(15)
    v_smfmac_f32_16x16x64_bf16 v[40:43], v[80:83], a[128:135], v125
    ds_read_b128 v[224:227], v105 offset:16384
    v_smfmac_f32_16x16x64_bf16 v[44:47], v[80:83], a[136:143], v125
    ds_read_b128 v[228:231], v105 offset:17408
    v_smfmac_f32_16x16x64_bf16 v[48:51], v[80:83], a[144:151], v125
    ds_read_b128 v[232:235], v105 offset:24576
    v_smfmac_f32_16x16x64_bf16 v[52:55], v[80:83], a[152:159], v125
    ds_read_b128 v[236:239], v105 offset:25600
    v_smfmac_f32_16x16x64_bf16 v[56:59], v[80:83], a[160:167], v125
    ds_read_b128 v[240:243], v105 offset:32768
    v_smfmac_f32_16x16x64_bf16 v[60:63], v[80:83], a[168:175], v125
    ds_read_b128 v[244:247], v105 offset:33792
    v_smfmac_f32_16x16x64_bf16 v[64:67], v[80:83], a[176:183], v125
    ds_read_b128 v[248:251], v105 offset:40960
    v_smfmac_f32_16x16x64_bf16 v[68:71], v[80:83], a[184:191], v125
    ds_read_b128 v[252:255], v105 offset:41984
    s_waitcnt lgkmcnt(15)
    v_smfmac_f32_16x16x64_bf16 v[40:43], v[84:87], a[192:199], v125
    v_lshlrev_b32 v14, 16, v115
    v_smfmac_f32_16x16x64_bf16 v[44:47], v[84:87], a[200:207], v125
    v_and_b32 v15, 0xffff0000, v115
    v_smfmac_f32_16x16x64_bf16 v[48:51], v[84:87], a[208:215], v125
    v_lshlrev_b32 v16, 16, v116
    v_smfmac_f32_16x16x64_bf16 v[52:55], v[84:87], a[216:223], v125
    v_and_b32 v17, 0xffff0000, v116
    v_smfmac_f32_16x16x64_bf16 v[56:59], v[84:87], a[224:231], v125
    v_lshlrev_b32 v18, 16, v117
    v_smfmac_f32_16x16x64_bf16 v[60:63], v[84:87], a[232:239], v125
    v_and_b32 v19, 0xffff0000, v117
    v_smfmac_f32_16x16x64_bf16 v[64:67], v[84:87], a[240:247], v125
    v_lshlrev_b32 v20, 16, v118
    v_smfmac_f32_16x16x64_bf16 v[68:71], v[84:87], a[248:255], v125
    v_and_b32 v21, 0xffff0000, v118
    s_waitcnt lgkmcnt(15)
    v_smfmac_f32_16x16x64_bf16 v[40:43], v[96:99], v[128:135], v125
    v_lshlrev_b32 v22, 16, v119
    v_smfmac_f32_16x16x64_bf16 v[44:47], v[96:99], v[136:143], v125
    v_and_b32 v23, 0xffff0000, v119
    v_smfmac_f32_16x16x64_bf16 v[48:51], v[96:99], v[144:151], v125
    s_lshr_b32 s63, s48, 5
    v_smfmac_f32_16x16x64_bf16 v[52:55], v[96:99], v[152:159], v125
    s_lshl_b32 s63, s63, 15
    v_smfmac_f32_16x16x64_bf16 v[56:59], v[96:99], v[160:167], v125
    s_and_b32 s60, s48, 31
    v_smfmac_f32_16x16x64_bf16 v[60:63], v[96:99], v[168:175], v125
    s_lshl_b32 s60, s60, 4
    v_smfmac_f32_16x16x64_bf16 v[64:67], v[96:99], v[176:183], v125
    s_add_u32 s63, s63, s60
    v_smfmac_f32_16x16x64_bf16 v[68:71], v[96:99], v[184:191], v125
    s_add_u32 s63, s63, 5242880
    s_waitcnt lgkmcnt(0)
    v_smfmac_f32_16x16x64_bf16 v[40:43], v[100:103], v[192:199], v125
    s_add_u32 s60, s63, 16384
    v_smfmac_f32_16x16x64_bf16 v[44:47], v[100:103], v[200:207], v125
    s_mov_b32 s62, 3145728
    v_smfmac_f32_16x16x64_bf16 v[48:51], v[100:103], v[208:215], v125
    v_smfmac_f32_16x16x64_bf16 v[52:55], v[100:103], v[216:223], v125
    v_smfmac_f32_16x16x64_bf16 v[56:59], v[100:103], v[224:231], v125
    v_smfmac_f32_16x16x64_bf16 v[60:63], v[100:103], v[232:239], v125
    v_smfmac_f32_16x16x64_bf16 v[64:67], v[100:103], v[240:247], v125
    v_smfmac_f32_16x16x64_bf16 v[68:71], v[100:103], v[248:255], v125
    s_nop 1
    v_permlane32_swap_b32 v40, v44
    v_permlane32_swap_b32 v41, v45
    v_permlane32_swap_b32 v42, v46
    v_permlane32_swap_b32 v43, v47
    v_pk_add_f32 v[40:41], v[40:41], v[44:45]
    v_pk_add_f32 v[42:43], v[42:43], v[46:47]
    ds_write_b32 v126, v40 offset:0
    ds_write_b32 v126, v41 offset:2064
    ds_write_b32 v126, v42 offset:4128
    ds_write_b32 v126, v43 offset:6192
    v_permlane32_swap_b32 v48, v52
    v_permlane32_swap_b32 v49, v53
    v_permlane32_swap_b32 v50, v54
    v_permlane32_swap_b32 v51, v55
    v_pk_add_f32 v[48:49], v[48:49], v[52:53]
    v_pk_add_f32 v[50:51], v[50:51], v[54:55]
    ds_write_b32 v126, v48 offset:128
    ds_write_b32 v126, v49 offset:2192
    ds_write_b32 v126, v50 offset:4256
    ds_write_b32 v126, v51 offset:6320
    v_permlane32_swap_b32 v56, v60
    v_permlane32_swap_b32 v57, v61
    v_permlane32_swap_b32 v58, v62
    v_permlane32_swap_b32 v59, v63
    v_pk_add_f32 v[56:57], v[56:57], v[60:61]
    v_pk_add_f32 v[58:59], v[58:59], v[62:63]
    ds_write_b32 v126, v56 offset:256
    ds_write_b32 v126, v57 offset:2320
    ds_write_b32 v126, v58 offset:4384
    ds_write_b32 v126, v59 offset:6448
    v_permlane32_swap_b32 v64, v68
    v_permlane32_swap_b32 v65, v69
    v_permlane32_swap_b32 v66, v70
    v_permlane32_swap_b32 v67, v71
    v_pk_add_f32 v[64:65], v[64:65], v[68:69]
    v_pk_add_f32 v[66:67], v[66:67], v[70:71]
    ds_write_b32 v126, v64 offset:384
    ds_write_b32 v126, v65 offset:2448
    ds_write_b32 v126, v66 offset:4512
    ds_write_b32 v126, v67 offset:6576
    s_waitcnt lgkmcnt(0)
    s_barrier
    ds_read_b128 v[40:43], v127
    ds_read_b128 v[44:47], v127 offset:16
    ds_read_b128 v[48:51], v127 offset:1024
    ds_read_b128 v[52:55], v127 offset:1040
    s_add_u32 m0, s58, 0
    s_add_u32 s59, s69, 0
    buffer_load_dwordx4 v108, s[16:19], s59 offen offset:0 lds
    buffer_load_dwordx4 v108, s[16:19], s59 offen offset:1024 lds
    s_waitcnt lgkmcnt(2)
    v_pk_add_f32 v[40:41], v[40:41], v[8:9]
    v_pk_add_f32 v[42:43], v[42:43], v[10:11]
    v_pk_add_f32 v[44:45], v[44:45], v[12:13]
    v_pk_add_f32 v[46:47], v[46:47], v[14:15]
    v_pk_mul_f32 v[28:29], v[40:41], v[40:41]
    v_pk_add_f32 v[26:27], v[40:41], v[42:43]
    v_pk_fma_f32 v[28:29], v[42:43], v[42:43], v[28:29]
    v_pk_add_f32 v[26:27], v[26:27], v[44:45]
    v_pk_fma_f32 v[28:29], v[44:45], v[44:45], v[28:29]
    v_pk_add_f32 v[26:27], v[26:27], v[46:47]
    v_pk_fma_f32 v[28:29], v[46:47], v[46:47], v[28:29]
    s_waitcnt lgkmcnt(0)
    v_pk_add_f32 v[48:49], v[48:49], v[16:17]
    v_pk_add_f32 v[50:51], v[50:51], v[18:19]
    v_pk_add_f32 v[52:53], v[52:53], v[20:21]
    v_pk_add_f32 v[54:55], v[54:55], v[22:23]
    v_pk_add_f32 v[26:27], v[26:27], v[48:49]
    v_pk_fma_f32 v[28:29], v[48:49], v[48:49], v[28:29]
    v_pk_add_f32 v[26:27], v[26:27], v[50:51]
    v_pk_fma_f32 v[28:29], v[50:51], v[50:51], v[28:29]
    v_pk_add_f32 v[26:27], v[26:27], v[52:53]
    v_pk_fma_f32 v[28:29], v[52:53], v[52:53], v[28:29]
    v_pk_add_f32 v[26:27], v[26:27], v[54:55]
    v_pk_fma_f32 v[28:29], v[54:55], v[54:55], v[28:29]
    v_add_f32 v26, v26, v27
    v_add_f32 v28, v28, v29
    v_cvt_pk_bf16_f32 v112, v40, v41
    v_add_f32_dpp v26, v26, v26 row_ror:8 row_mask:0xf bank_mask:0xf
    v_add_f32_dpp v28, v28, v28 row_ror:8 row_mask:0xf bank_mask:0xf
    v_cvt_pk_bf16_f32 v113, v42, v43
    v_add_f32_dpp v26, v26, v26 row_ror:4 row_mask:0xf bank_mask:0xf
    v_add_f32_dpp v28, v28, v28 row_ror:4 row_mask:0xf bank_mask:0xf
    v_cvt_pk_bf16_f32 v114, v44, v45
    v_add_f32_dpp v26, v26, v26 row_ror:2 row_mask:0xf bank_mask:0xf
    v_add_f32_dpp v28, v28, v28 row_ror:2 row_mask:0xf bank_mask:0xf
    v_cvt_pk_bf16_f32 v115, v46, v47
    v_add_f32_dpp v26, v26, v26 row_ror:1 row_mask:0xf bank_mask:0xf
    v_add_f32_dpp v28, v28, v28 row_ror:1 row_mask:0xf bank_mask:0xf
    v_cvt_pk_bf16_f32 v116, v48, v49
    v_mov_b32 v27, v26
    v_mov_b32 v29, v28
    v_cvt_pk_bf16_f32 v117, v50, v51
    v_cvt_pk_bf16_f32 v118, v52, v53
    v_permlane16_swap_b32 v26, v27
    v_permlane16_swap_b32 v28, v29
    v_cvt_pk_bf16_f32 v119, v54, v55
    v_add_f32 v26, v26, v27
    v_add_f32 v28, v28, v29
    v_mul_f32 v26, 0x3b000000, v26
    v_mul_f32 v28, 0x3b000000, v28
    v_fma_f32 v28, -v26, v26, v28
    v_max_f32 v28, 0, v28
    v_add_f32 v28, 0x3727c5ac, v28
    v_rsq_f32 v30, v28
    s_nop 0
    v_mul_f32 v32, v26, v30
    v_pk_fma_f32 v[40:41], v[40:41], v[30:31], v[32:33] op_sel_hi:[1,0,0] neg_lo:[0,0,1] neg_hi:[0,0,1]
    v_pk_fma_f32 v[42:43], v[42:43], v[30:31], v[32:33] op_sel_hi:[1,0,0] neg_lo:[0,0,1] neg_hi:[0,0,1]
    v_pk_fma_f32 v[44:45], v[44:45], v[30:31], v[32:33] op_sel_hi:[1,0,0] neg_lo:[0,0,1] neg_hi:[0,0,1]
    v_pk_fma_f32 v[46:47], v[46:47], v[30:31], v[32:33] op_sel_hi:[1,0,0] neg_lo:[0,0,1] neg_hi:[0,0,1]
    v_cvt_pk_bf16_f32 v56, v40, v41
    v_cvt_pk_bf16_f32 v57, v42, v43
    v_cvt_pk_bf16_f32 v58, v44, v45
    v_cvt_pk_bf16_f32 v59, v46, v47
    ds_write_b128 v5, v[56:59] offset:0
    v_pk_fma_f32 v[48:49], v[48:49], v[30:31], v[32:33] op_sel_hi:[1,0,0] neg_lo:[0,0,1] neg_hi:[0,0,1]
    v_pk_fma_f32 v[50:51], v[50:51], v[30:31], v[32:33] op_sel_hi:[1,0,0] neg_lo:[0,0,1] neg_hi:[0,0,1]
    v_pk_fma_f32 v[52:53], v[52:53], v[30:31], v[32:33] op_sel_hi:[1,0,0] neg_lo:[0,0,1] neg_hi:[0,0,1]
    v_pk_fma_f32 v[54:55], v[54:55], v[30:31], v[32:33] op_sel_hi:[1,0,0] neg_lo:[0,0,1] neg_hi:[0,0,1]
    v_cvt_pk_bf16_f32 v60, v48, v49
    v_cvt_pk_bf16_f32 v61, v50, v51
    v_cvt_pk_bf16_f32 v62, v52, v53
    v_cvt_pk_bf16_f32 v63, v54, v55
    ds_write_b128 v5, v[60:63] offset:4096
    buffer_store_dwordx4 v[112:115], v7, s[12:15], s62 offen offset:0 sc1
    buffer_store_dwordx4 v[116:119], v7, s[12:15], s62 offen offset:512 sc1
    s_waitcnt lgkmcnt(0)
    s_barrier
    ds_read_b128 v[48:51], v24
    ds_read_b128 v[52:55], v24 offset:4096
    buffer_load_dwordx4 v108, s[16:19], s59 offen offset:2048 lds
    buffer_load_dwordx4 v108, s[16:19], s59 offen offset:3072 lds
    s_waitcnt lgkmcnt(1)
    buffer_store_dwordx4 v[48:51], v6, s[12:15], s63 offen sc1
    s_waitcnt lgkmcnt(0)
    buffer_store_dwordx4 v[52:55], v6, s[12:15], s60 offen sc1
    s_add_u32 m0, s58, 32768
    s_add_u32 s59, s69, 32768
    buffer_load_dwordx4 v108, s[16:19], s59 offen offset:0 lds
    buffer_load_dwordx4 v108, s[16:19], s59 offen offset:1024 lds
    buffer_load_dwordx4 v108, s[16:19], s59 offen offset:2048 lds
    buffer_load_dwordx4 v108, s[16:19], s59 offen offset:3072 lds
    s_add_u32 m0, s58, 65536
    s_add_u32 s59, s69, 65536
    buffer_load_dwordx4 v108, s[16:19], s59 offen offset:0 lds
    buffer_load_dwordx4 v108, s[16:19], s59 offen offset:1024 lds
    buffer_load_dwordx4 v108, s[16:19], s59 offen offset:2048 lds
    buffer_load_dwordx4 v108, s[16:19], s59 offen offset:3072 lds
    s_add_u32 m0, s58, 16384
    s_add_u32 s59, s69, 16384
    buffer_load_dwordx4 v108, s[16:19], s59 offen offset:0 lds
    buffer_load_dwordx4 v108, s[16:19], s59 offen offset:1024 lds
    buffer_load_dwordx4 v108, s[16:19], s59 offen offset:2048 lds
    buffer_load_dwordx4 v108, s[16:19], s59 offen offset:3072 lds
    s_waitcnt vmcnt(12)
    s_barrier
    s_cmp_lg_u32 s6, 0
    s_cbranch_scc1 w0_28
    s_lshr_b32 s65, s48, 7
    s_lshl_b32 s66, s65, 8
    s_add_u32 s66, s66, s7
    s_add_u32 s66, s66, 4096
    v_mov_b32 v2, 1
    s_mov_b64 exec, 1
    buffer_atomic_add v2, off, s[16:19], s66 sc1
    s_mov_b64 exec, -1
w0_28:
    buffer_load_dword v8, v6, s[12:15], s63 offen
    buffer_load_dword v9, v6, s[12:15], s60 offen
    s_add_u32 m0, s58, 49152
    s_add_u32 s59, s69, 49152
    buffer_load_dwordx4 v108, s[16:19], s59 offen offset:0 lds
    buffer_load_dwordx4 v108, s[16:19], s59 offen offset:1024 lds
    buffer_load_dwordx4 v108, s[16:19], s59 offen offset:2048 lds
    buffer_load_dwordx4 v108, s[16:19], s59 offen offset:3072 lds
    s_add_u32 m0, s58, 81920
    s_add_u32 s59, s69, 81920
    buffer_load_dwordx4 v108, s[16:19], s59 offen offset:0 lds
    buffer_load_dwordx4 v108, s[16:19], s59 offen offset:1024 lds
    buffer_load_dwordx4 v108, s[16:19], s59 offen offset:2048 lds
    buffer_load_dwordx4 v108, s[16:19], s59 offen offset:3072 lds
    s_cmp_ge_u32 s5, 29
    s_cbranch_scc1 gu_idle
    s_and_b32 s60, s5, 7
    s_mul_i32 s62, s60, 176128
    s_lshl_b32 s60, s60, 7
    s_lshl_b32 s63, s6, 11
    s_add_u32 s62, s62, s63
    s_add_u32 s62, s62, 33554432
    s_lshl_b32 s67, s4, 3
    s_lshr_b32 s63, s5, 3
    s_add_u32 s67, s67, s63
    s_mul_i32 s61, s67, 88064
    s_add_u32 s61, s61, 7340032
    s_lshl_b32 s63, s6, 10
    s_add_u32 s61, s61, s63
    s_lshl_b32 s68, s67, 8
    s_add_u32 s68, s68, s7
    s_add_u32 s68, s68, 8192
    v_lshlrev_b32 v6, 4, v1
    v_lshrrev_b32 v2, 5, v1
    v_and_b32 v22, 31, v1
    v_lshlrev_b32 v22, 4, v22
    v_lshl_add_u32 v22, v2, 10, v22
    v_add_u32 v23, 0x10000, v22
    v_lshrrev_b32 v2, 4, v1
    v_and_b32 v24, 15, v1
    v_lshlrev_b32 v24, 4, v24
    v_lshl_add_u32 v24, v2, 9, v24
    s_mul_i32 s57, s5, 3
    s_lshl_b32 s50, s4, 3
    s_add_u32 s50, s50, s6
    s_lshl_b32 s48, s50, 15
    s_add_u32 s48, s48, 5242880
    s_mul_i32 s49, s50, 88064
    s_lshl_b32 s51, s57, 10
    s_add_u32 s49, s49, s51
    s_add_u32 s49, s49, 7340032
    s_mov_b32 s55, 0xc0135761
    s_mov_b32 s56, 0xbdd2d3e8
    v_mov_b32 v7, s55
    v_mov_b32 v16, s56
    v_mov_b32 v17, s56
    v_mov_b32 v18, s55
    v_mov_b32 v19, s55
    v_mov_b32 v20, 1.0
    v_mov_b32 v21, 1.0
    v_lshlrev_b32 v3, 7, v1
    v_mov_b32 v4, 2130706432
    s_cmp_eq_u32 s5, 28
    s_cselect_b32 s51, 16, 24
    v_cmp_gt_u32 vcc, s51, v1
    s_nop 1
    v_cndmask_b32 v3, v4, v3, vcc
    s_lshl_b32 s54, s50, 8
    s_add_u32 s54, s54, s7
    s_add_u32 s54, s54, 8192
    s_add_u32 s63, s62, 155648
    buffer_load_dwordx4 a[216:219], v6, s[16:19], s63 offen
    buffer_load_dwordx4 a[220:223], v6, s[16:19], s63 offen offset:1024
    s_add_u32 s63, s62, 163840
    buffer_load_dwordx4 a[224:227], v6, s[16:19], s63 offen
    buffer_load_dwordx4 a[228:231], v6, s[16:19], s63 offen offset:1024
    s_add_u32 s63, s62, 172032
    buffer_load_dwordx4 a[232:235], v6, s[16:19], s63 offen
    buffer_load_dwordx4 a[236:239], v6, s[16:19], s63 offen offset:1024
    s_cmp_lg_u32 s6, 0
    s_cbranch_scc1 w0_29
    s_lshl_b32 s65, s4, 9
    s_add_u32 s65, s65, s7
    s_add_u32 s65, s65, 4096
    v_lshlrev_b32 v10, 8, v1
    s_mov_b32 s66, 200000
    s_mov_b64 exec, 3
poll_30:
    v_mov_b32 v11, 0
    buffer_atomic_add v11, v10, s[16:19], s65 offen sc0 sc1
    s_sub_u32 s66, s66, 1
    s_cmp_eq_u32 s66, 0
    s_cbranch_scc1 pollout_31
    s_waitcnt vmcnt(0)
    v_cmp_gt_u32 vcc, 16, v11
    s_cbranch_vccz pollout_31
    s_sleep 1
    s_branch poll_30
pollout_31:
    s_mov_b64 exec, -1
w0_29:
    s_waitcnt vmcnt(6)
    s_barrier
    s_add_u32 s52, s48, 0
    buffer_load_dwordx4 v[128:131], v24, s[12:15], s52 offen offset:0
    buffer_load_dwordx4 v[132:135], v24, s[12:15], s52 offen offset:256
    buffer_load_dwordx4 v[136:139], v24, s[12:15], s52 offen offset:2048
    buffer_load_dwordx4 v[140:143], v24, s[12:15], s52 offen offset:2304
    ds_read_b128 a[128:131], v22 offset:0
    ds_read_b128 a[132:135], v22 offset:512
    ds_read_b128 a[136:139], v22 offset:32768
    ds_read_b128 a[140:143], v22 offset:33280
    ds_read_b128 a[144:147], v23 offset:0
    ds_read_b128 a[148:151], v23 offset:512
    ds_read_b128 a[152:155], v22 offset:2048
    ds_read_b128 a[156:159], v22 offset:2560
    s_add_u32 s52, s48, 4096
    buffer_load_dwordx4 v[144:147], v24, s[12:15], s52 offen offset:0
    buffer_load_dwordx4 v[148:151], v24, s[12:15], s52 offen offset:256
    buffer_load_dwordx4 v[152:155], v24, s[12:15], s52 offen offset:2048
    buffer_load_dwordx4 v[156:159], v24, s[12:15], s52 offen offset:2304
    s_add_u32 s52, s48, 8192
    buffer_load_dwordx4 v[160:163], v24, s[12:15], s52 offen offset:0
    buffer_load_dwordx4 v[164:167], v24, s[12:15], s52 offen offset:256
    buffer_load_dwordx4 v[168:171], v24, s[12:15], s52 offen offset:2048
    buffer_load_dwordx4 v[172:175], v24, s[12:15], s52 offen offset:2304
    s_waitcnt vmcnt(10)
    s_waitcnt lgkmcnt(7)
    v_mfma_f32_16x16x32_bf16 v[32:35], a[128:131], v[128:131], 0
    ds_read_b128 a[160:163], v22 offset:34816
    v_mfma_f32_16x16x32_bf16 v[36:39], a[128:131], v[132:135], 0
    s_add_u32 s52, s48, 12288
    buffer_load_dwordx4 v[176:179], v24, s[12:15], s52 offen offset:0
    s_waitcnt lgkmcnt(7)
    v_mfma_f32_16x16x32_bf16 v[40:43], a[132:135], v[128:131], 0
    ds_read_b128 a[164:167], v22 offset:35328
    v_mfma_f32_16x16x32_bf16 v[44:47], a[132:135], v[132:135], 0
    s_waitcnt lgkmcnt(7)
    v_mfma_f32_16x16x32_bf16 v[48:51], a[136:139], v[128:131], 0
    ds_read_b128 a[168:171], v23 offset:2048
    v_mfma_f32_16x16x32_bf16 v[52:55], a[136:139], v[132:135], 0
    s_waitcnt lgkmcnt(7)
    v_mfma_f32_16x16x32_bf16 v[56:59], a[140:143], v[128:131], 0
    ds_read_b128 a[172:175], v23 offset:2560
    v_mfma_f32_16x16x32_bf16 v[60:63], a[140:143], v[132:135], 0
    buffer_load_dwordx4 v[180:183], v24, s[12:15], s52 offen offset:256
    s_waitcnt lgkmcnt(7)
    v_mfma_f32_16x16x32_bf16 v[64:67], a[144:147], v[128:131], 0
    ds_read_b128 a[128:131], v22 offset:4096
    v_mfma_f32_16x16x32_bf16 v[68:71], a[144:147], v[132:135], 0
    s_waitcnt lgkmcnt(7)
    v_mfma_f32_16x16x32_bf16 v[72:75], a[148:151], v[128:131], 0
    ds_read_b128 a[132:135], v22 offset:4608
    v_mfma_f32_16x16x32_bf16 v[76:79], a[148:151], v[132:135], 0
    buffer_load_dwordx4 v[184:187], v24, s[12:15], s52 offen offset:2048
    s_waitcnt vmcnt(11)
    s_waitcnt lgkmcnt(7)
    v_mfma_f32_16x16x32_bf16 v[32:35], a[152:155], v[136:139], v[32:35]
    ds_read_b128 a[136:139], v22 offset:36864
    v_mfma_f32_16x16x32_bf16 v[36:39], a[152:155], v[140:143], v[36:39]
    buffer_load_dwordx4 v[188:191], v24, s[12:15], s52 offen offset:2304
    s_waitcnt lgkmcnt(7)
    v_mfma_f32_16x16x32_bf16 v[40:43], a[156:159], v[136:139], v[40:43]
    ds_read_b128 a[140:143], v22 offset:37376
    v_mfma_f32_16x16x32_bf16 v[44:47], a[156:159], v[140:143], v[44:47]
    s_waitcnt lgkmcnt(7)
    v_mfma_f32_16x16x32_bf16 v[48:51], a[160:163], v[136:139], v[48:51]
    ds_read_b128 a[144:147], v23 offset:4096
    v_mfma_f32_16x16x32_bf16 v[52:55], a[160:163], v[140:143], v[52:55]
    s_waitcnt lgkmcnt(7)
    v_mfma_f32_16x16x32_bf16 v[56:59], a[164:167], v[136:139], v[56:59]
    ds_read_b128 a[148:151], v23 offset:4608
    v_mfma_f32_16x16x32_bf16 v[60:63], a[164:167], v[140:143], v[60:63]
    s_add_u32 s52, s48, 16384
    buffer_load_dwordx4 v[192:195], v24, s[12:15], s52 offen offset:0
    s_waitcnt lgkmcnt(7)
    v_mfma_f32_16x16x32_bf16 v[64:67], a[168:171], v[136:139], v[64:67]
    ds_read_b128 a[152:155], v22 offset:6144
    v_mfma_f32_16x16x32_bf16 v[68:71], a[168:171], v[140:143], v[68:71]
    s_waitcnt lgkmcnt(7)
    v_mfma_f32_16x16x32_bf16 v[72:75], a[172:175], v[136:139], v[72:75]
    ds_read_b128 a[156:159], v22 offset:6656
    v_mfma_f32_16x16x32_bf16 v[76:79], a[172:175], v[140:143], v[76:79]
    buffer_load_dwordx4 v[196:199], v24, s[12:15], s52 offen offset:256
    s_waitcnt vmcnt(12)
    s_waitcnt lgkmcnt(7)
    v_mfma_f32_16x16x32_bf16 v[32:35], a[128:131], v[144:147], v[32:35]
    ds_read_b128 a[160:163], v22 offset:38912
    v_mfma_f32_16x16x32_bf16 v[36:39], a[128:131], v[148:151], v[36:39]
    buffer_load_dwordx4 v[200:203], v24, s[12:15], s52 offen offset:2048
    s_waitcnt lgkmcnt(7)
    v_mfma_f32_16x16x32_bf16 v[40:43], a[132:135], v[144:147], v[40:43]
    ds_read_b128 a[164:167], v22 offset:39424
    v_mfma_f32_16x16x32_bf16 v[44:47], a[132:135], v[148:151], v[44:47]
    s_waitcnt lgkmcnt(7)
    v_mfma_f32_16x16x32_bf16 v[48:51], a[136:139], v[144:147], v[48:51]
    ds_read_b128 a[168:171], v23 offset:6144
    v_mfma_f32_16x16x32_bf16 v[52:55], a[136:139], v[148:151], v[52:55]
    s_waitcnt lgkmcnt(7)
    v_mfma_f32_16x16x32_bf16 v[56:59], a[140:143], v[144:147], v[56:59]
    ds_read_b128 a[172:175], v23 offset:6656
    v_mfma_f32_16x16x32_bf16 v[60:63], a[140:143], v[148:151], v[60:63]
    buffer_load_dwordx4 v[204:207], v24, s[12:15], s52 offen offset:2304
    s_waitcnt lgkmcnt(7)
    v_mfma_f32_16x16x32_bf16 v[64:67], a[144:147], v[144:147], v[64:67]
    ds_read_b128 a[128:131], v22 offset:8192
    v_mfma_f32_16x16x32_bf16 v[68:71], a[144:147], v[148:151], v[68:71]
    s_waitcnt lgkmcnt(7)
    v_mfma_f32_16x16x32_bf16 v[72:75], a[148:151], v[144:147], v[72:75]
    ds_read_b128 a[132:135], v22 offset:8704
    v_mfma_f32_16x16x32_bf16 v[76:79], a[148:151], v[148:151], v[76:79]
    s_waitcnt vmcnt(12)
    s_waitcnt lgkmcnt(7)
    v_mfma_f32_16x16x32_bf16 v[32:35], a[152:155], v[152:155], v[32:35]
    ds_read_b128 a[136:139], v22 offset:40960
    v_mfma_f32_16x16x32_bf16 v[36:39], a[152:155], v[156:159], v[36:39]
    s_add_u32 s52, s48, 20480
    buffer_load_dwordx4 v[208:211], v24, s[12:15], s52 offen offset:0
    s_waitcnt lgkmcnt(7)
    v_mfma_f32_16x16x32_bf16 v[40:43], a[156:159], v[152:155], v[40:43]
    ds_read_b128 a[140:143], v22 offset:41472
    v_mfma_f32_16x16x32_bf16 v[44:47], a[156:159], v[156:159], v[44:47]
    s_waitcnt lgkmcnt(7)
    v_mfma_f32_16x16x32_bf16 v[48:51], a[160:163], v[152:155], v[48:51]
    ds_read_b128 a[144:147], v23 offset:8192
    v_mfma_f32_16x16x32_bf16 v[52:55], a[160:163], v[156:159], v[52:55]
    s_waitcnt lgkmcnt(7)
    v_mfma_f32_16x16x32_bf16 v[56:59], a[164:167], v[152:155], v[56:59]
    ds_read_b128 a[148:151], v23 offset:8704
    v_mfma_f32_16x16x32_bf16 v[60:63], a[164:167], v[156:159], v[60:63]
    buffer_load_dwordx4 v[212:215], v24, s[12:15], s52 offen offset:256
    s_waitcnt lgkmcnt(7)
    v_mfma_f32_16x16x32_bf16 v[64:67], a[168:171], v[152:155], v[64:67]
    ds_read_b128 a[152:155], v22 offset:10240
    v_mfma_f32_16x16x32_bf16 v[68:71], a[168:171], v[156:159], v[68:71]
    s_waitcnt lgkmcnt(7)
    v_mfma_f32_16x16x32_bf16 v[72:75], a[172:175], v[152:155], v[72:75]
    ds_read_b128 a[156:159], v22 offset:10752
    v_mfma_f32_16x16x32_bf16 v[76:79], a[172:175], v[156:159], v[76:79]
    buffer_load_dwordx4 v[216:219], v24, s[12:15], s52 offen offset:2048
    s_waitcnt vmcnt(13)
    s_waitcnt lgkmcnt(7)
    v_mfma_f32_16x16x32_bf16 v[32:35], a[128:131], v[160:163], v[32:35]
    ds_read_b128 a[160:163], v22 offset:43008
    v_mfma_f32_16x16x32_bf16 v[36:39], a[128:131], v[164:167], v[36:39]
    buffer_load_dwordx4 v[220:223], v24, s[12:15], s52 offen offset:2304
    s_waitcnt lgkmcnt(7)
    v_mfma_f32_16x16x32_bf16 v[40:43], a[132:135], v[160:163], v[40:43]
    ds_read_b128 a[164:167], v22 offset:43520
    v_mfma_f32_16x16x32_bf16 v[44:47], a[132:135], v[164:167], v[44:47]
    s_waitcnt lgkmcnt(7)
    v_mfma_f32_16x16x32_bf16 v[48:51], a[136:139], v[160:163], v[48:51]
    ds_read_b128 a[168:171], v23 offset:10240
    v_mfma_f32_16x16x32_bf16 v[52:55], a[136:139], v[164:167], v[52:55]
    s_waitcnt lgkmcnt(7)
    v_mfma_f32_16x16x32_bf16 v[56:59], a[140:143], v[160:163], v[56:59]
    ds_read_b128 a[172:175], v23 offset:10752
    v_mfma_f32_16x16x32_bf16 v[60:63], a[140:143], v[164:167], v[60:63]
    s_add_u32 s52, s48, 24576
    buffer_load_dwordx4 v[224:227], v24, s[12:15], s52 offen offset:0
    s_waitcnt lgkmcnt(7)
    v_mfma_f32_16x16x32_bf16 v[64:67], a[144:147], v[160:163], v[64:67]
    ds_read_b128 a[128:131], v22 offset:12288
    v_mfma_f32_16x16x32_bf16 v[68:71], a[144:147], v[164:167], v[68:71]
    s_waitcnt lgkmcnt(7)
    v_mfma_f32_16x16x32_bf16 v[72:75], a[148:151], v[160:163], v[72:75]
    ds_read_b128 a[132:135], v22 offset:12800
    v_mfma_f32_16x16x32_bf16 v[76:79], a[148:151], v[164:167], v[76:79]
    buffer_load_dwordx4 v[228:231], v24, s[12:15], s52 offen offset:256
    s_waitcnt vmcnt(14)
    s_waitcnt lgkmcnt(7)
    v_mfma_f32_16x16x32_bf16 v[32:35], a[152:155], v[168:171], v[32:35]
    ds_read_b128 a[136:139], v22 offset:45056
    v_mfma_f32_16x16x32_bf16 v[36:39], a[152:155], v[172:175], v[36:39]
    buffer_load_dwordx4 v[232:235], v24, s[12:15], s52 offen offset:2048
    s_waitcnt lgkmcnt(7)
    v_mfma_f32_16x16x32_bf16 v[40:43], a[156:159], v[168:171], v[40:43]
    ds_read_b128 a[140:143], v22 offset:45568
    v_mfma_f32_16x16x32_bf16 v[44:47], a[156:159], v[172:175], v[44:47]
    s_add_u32 s63, s62, 114688
    buffer_load_dwordx4 a[176:179], v6, s[16:19], s63 offen
    s_waitcnt lgkmcnt(7)
    v_mfma_f32_16x16x32_bf16 v[48:51], a[160:163], v[168:171], v[48:51]
    ds_read_b128 a[144:147], v23 offset:12288
    v_mfma_f32_16x16x32_bf16 v[52:55], a[160:163], v[172:175], v[52:55]
    s_waitcnt lgkmcnt(7)
    v_mfma_f32_16x16x32_bf16 v[56:59], a[164:167], v[168:171], v[56:59]
    ds_read_b128 a[148:151], v23 offset:12800
    v_mfma_f32_16x16x32_bf16 v[60:63], a[164:167], v[172:175], v[60:63]
    buffer_load_dwordx4 v[236:239], v24, s[12:15], s52 offen offset:2304
    s_waitcnt lgkmcnt(7)
    v_mfma_f32_16x16x32_bf16 v[64:67], a[168:171], v[168:171], v[64:67]
    ds_read_b128 a[152:155], v22 offset:14336
    v_mfma_f32_16x16x32_bf16 v[68:71], a[168:171], v[172:175], v[68:71]
    s_waitcnt lgkmcnt(7)
    v_mfma_f32_16x16x32_bf16 v[72:75], a[172:175], v[168:171], v[72:75]
    ds_read_b128 a[156:159], v22 offset:14848
    v_mfma_f32_16x16x32_bf16 v[76:79], a[172:175], v[172:175], v[76:79]
    s_waitcnt vmcnt(15)
    s_waitcnt lgkmcnt(7)
    v_mfma_f32_16x16x32_bf16 v[32:35], a[128:131], v[176:179], v[32:35]
    ds_read_b128 a[160:163], v22 offset:47104
    v_mfma_f32_16x16x32_bf16 v[36:39], a[128:131], v[180:183], v[36:39]
    s_add_u32 s52, s48, 28672
    buffer_load_dwordx4 v[240:243], v24, s[12:15], s52 offen offset:0
    s_waitcnt lgkmcnt(7)
    v_mfma_f32_16x16x32_bf16 v[40:43], a[132:135], v[176:179], v[40:43]
    ds_read_b128 a[164:167], v22 offset:47616
    v_mfma_f32_16x16x32_bf16 v[44:47], a[132:135], v[180:183], v[44:47]
    buffer_load_dwordx4 a[180:183], v6, s[16:19], s63 offen offset:1024
    s_waitcnt lgkmcnt(7)
    v_mfma_f32_16x16x32_bf16 v[48:51], a[136:139], v[176:179], v[48:51]
    ds_read_b128 a[168:171], v23 offset:14336
    v_mfma_f32_16x16x32_bf16 v[52:55], a[136:139], v[180:183], v[52:55]
    s_waitcnt lgkmcnt(7)
    v_mfma_f32_16x16x32_bf16 v[56:59], a[140:143], v[176:179], v[56:59]
    ds_read_b128 a[172:175], v23 offset:14848
    v_mfma_f32_16x16x32_bf16 v[60:63], a[140:143], v[180:183], v[60:63]
    buffer_load_dwordx4 v[244:247], v24, s[12:15], s52 offen offset:256
    s_waitcnt lgkmcnt(7)
    v_mfma_f32_16x16x32_bf16 v[64:67], a[144:147], v[176:179], v[64:67]
    ds_read_b128 a[128:131], v22 offset:16384
    v_mfma_f32_16x16x32_bf16 v[68:71], a[144:147], v[180:183], v[68:71]
    s_waitcnt lgkmcnt(7)
    v_mfma_f32_16x16x32_bf16 v[72:75], a[148:151], v[176:179], v[72:75]
    ds_read_b128 a[132:135], v22 offset:16896
    v_mfma_f32_16x16x32_bf16 v[76:79], a[148:151], v[180:183], v[76:79]
    buffer_load_dwordx4 v[248:251], v24, s[12:15], s52 offen offset:2048
    s_waitcnt vmcnt(17)
    s_waitcnt lgkmcnt(7)
    v_mfma_f32_16x16x32_bf16 v[32:35], a[152:155], v[184:187], v[32:35]
    ds_read_b128 a[136:139], v22 offset:49152
    v_mfma_f32_16x16x32_bf16 v[36:39], a[152:155], v[188:191], v[36:39]
    buffer_load_dwordx4 v[252:255], v24, s[12:15], s52 offen offset:2304
    s_waitcnt lgkmcnt(7)
    v_mfma_f32_16x16x32_bf16 v[40:43], a[156:159], v[184:187], v[40:43]
    ds_read_b128 a[140:143], v22 offset:49664
    v_mfma_f32_16x16x32_bf16 v[44:47], a[156:159], v[188:191], v[44:47]
    s_add_u32 s63, s62, 122880
    buffer_load_dwordx4 a[184:187], v6, s[16:19], s63 offen
    s_waitcnt lgkmcnt(7)
    v_mfma_f32_16x16x32_bf16 v[48:51], a[160:163], v[184:187], v[48:51]
    ds_read_b128 a[144:147], v23 offset:16384
    v_mfma_f32_16x16x32_bf16 v[52:55], a[160:163], v[188:191], v[52:55]
    s_waitcnt lgkmcnt(7)
    v_mfma_f32_16x16x32_bf16 v[56:59], a[164:167], v[184:187], v[56:59]
    ds_read_b128 a[148:151], v23 offset:16896
    v_mfma_f32_16x16x32_bf16 v[60:63], a[164:167], v[188:191], v[60:63]
    s_add_u32 s52, s48, 131072
    buffer_load_dwordx4 a[0:3], v24, s[12:15], s52 offen offset:0
    s_waitcnt lgkmcnt(7)
    v_mfma_f32_16x16x32_bf16 v[64:67], a[168:171], v[184:187], v[64:67]
    ds_read_b128 a[152:155], v22 offset:18432
    v_mfma_f32_16x16x32_bf16 v[68:71], a[168:171], v[188:191], v[68:71]
    s_waitcnt lgkmcnt(7)
    v_mfma_f32_16x16x32_bf16 v[72:75], a[172:175], v[184:187], v[72:75]
    ds_read_b128 a[156:159], v22 offset:18944
    v_mfma_f32_16x16x32_bf16 v[76:79], a[172:175], v[188:191], v[76:79]
    buffer_load_dwordx4 a[4:7], v24, s[12:15], s52 offen offset:256
    s_waitcnt vmcnt(19)
    s_waitcnt lgkmcnt(7)
    v_mfma_f32_16x16x32_bf16 v[32:35], a[128:131], v[192:195], v[32:35]
    ds_read_b128 a[160:163], v22 offset:51200
    v_mfma_f32_16x16x32_bf16 v[36:39], a[128:131], v[196:199], v[36:39]
    buffer_load_dwordx4 a[8:11], v24, s[12:15], s52 offen offset:2048
    s_waitcnt lgkmcnt(7)
    v_mfma_f32_16x16x32_bf16 v[40:43], a[132:135], v[192:195], v[40:43]
    ds_read_b128 a[164:167], v22 offset:51712
    v_mfma_f32_16x16x32_bf16 v[44:47], a[132:135], v[196:199], v[44:47]
    buffer_load_dwordx4 a[188:191], v6, s[16:19], s63 offen offset:1024
    s_waitcnt lgkmcnt(7)
    v_mfma_f32_16x16x32_bf16 v[48:51], a[136:139], v[192:195], v[48:51]
    ds_read_b128 a[168:171], v23 offset:18432
    v_mfma_f32_16x16x32_bf16 v[52:55], a[136:139], v[196:199], v[52:55]
    s_waitcnt lgkmcnt(7)
    v_mfma_f32_16x16x32_bf16 v[56:59], a[140:143], v[192:195], v[56:59]
    ds_read_b128 a[172:175], v23 offset:18944
    v_mfma_f32_16x16x32_bf16 v[60:63], a[140:143], v[196:199], v[60:63]
    buffer_load_dwordx4 a[12:15], v24, s[12:15], s52 offen offset:2304
    s_waitcnt lgkmcnt(7)
    v_mfma_f32_16x16x32_bf16 v[64:67], a[144:147], v[192:195], v[64:67]
    ds_read_b128 a[128:131], v22 offset:20480
    v_mfma_f32_16x16x32_bf16 v[68:71], a[144:147], v[196:199], v[68:71]
    s_waitcnt lgkmcnt(7)
    v_mfma_f32_16x16x32_bf16 v[72:75], a[148:151], v[192:195], v[72:75]
    ds_read_b128 a[132:135], v22 offset:20992
    v_mfma_f32_16x16x32_bf16 v[76:79], a[148:151], v[196:199], v[76:79]
    s_waitcnt vmcnt(20)
    s_waitcnt lgkmcnt(7)
    v_mfma_f32_16x16x32_bf16 v[32:35], a[152:155], v[200:203], v[32:35]
    ds_read_b128 a[136:139], v22 offset:53248
    v_mfma_f32_16x16x32_bf16 v[36:39], a[152:155], v[204:207], v[36:39]
    s_add_u32 s52, s48, 135168
    buffer_load_dwordx4 a[16:19], v24, s[12:15], s52 offen offset:0
    s_waitcnt lgkmcnt(7)
    v_mfma_f32_16x16x32_bf16 v[40:43], a[156:159], v[200:203], v[40:43]
    ds_read_b128 a[140:143], v22 offset:53760
    v_mfma_f32_16x16x32_bf16 v[44:47], a[156:159], v[204:207], v[44:47]
    s_add_u32 s63, s62, 131072
    buffer_load_dwordx4 a[192:195], v6, s[16:19], s63 offen
    s_waitcnt lgkmcnt(7)
    v_mfma_f32_16x16x32_bf16 v[48:51], a[160:163], v[200:203], v[48:51]
    ds_read_b128 a[144:147], v23 offset:20480
    v_mfma_f32_16x16x32_bf16 v[52:55], a[160:163], v[204:207], v[52:55]
    s_waitcnt lgkmcnt(7)
    v_mfma_f32_16x16x32_bf16 v[56:59], a[164:167], v[200:203], v[56:59]
    ds_read_b128 a[148:151], v23 offset:20992
    v_mfma_f32_16x16x32_bf16 v[60:63], a[164:167], v[204:207], v[60:63]
    buffer_load_dwordx4 a[20:23], v24, s[12:15], s52 offen offset:256
    s_waitcnt lgkmcnt(7)
    v_mfma_f32_16x16x32_bf16 v[64:67], a[168:171], v[200:203], v[64:67]
    ds_read_b128 a[152:155], v22 offset:22528
    v_mfma_f32_16x16x32_bf16 v[68:71], a[168:171], v[204:207], v[68:71]
    s_waitcnt lgkmcnt(7)
    v_mfma_f32_16x16x32_bf16 v[72:75], a[172:175], v[200:203], v[72:75]
    ds_read_b128 a[156:159], v22 offset:23040
    v_mfma_f32_16x16x32_bf16 v[76:79], a[172:175], v[204:207], v[76:79]
    buffer_load_dwordx4 a[24:27], v24, s[12:15], s52 offen offset:2048
    s_waitcnt vmcnt(22)
    s_waitcnt lgkmcnt(7)
    v_mfma_f32_16x16x32_bf16 v[32:35], a[128:131], v[208:211], v[32:35]
    ds_read_b128 a[160:163], v22 offset:55296
    v_mfma_f32_16x16x32_bf16 v[36:39], a[128:131], v[212:215], v[36:39]
    buffer_load_dwordx4 a[28:31], v24, s[12:15], s52 offen offset:2304
    s_waitcnt lgkmcnt(7)
    v_mfma_f32_16x16x32_bf16 v[40:43], a[132:135], v[208:211], v[40:43]
    ds_read_b128 a[164:167], v22 offset:55808
    v_mfma_f32_16x16x32_bf16 v[44:47], a[132:135], v[212:215], v[44:47]
    buffer_load_dwordx4 a[196:199], v6, s[16:19], s63 offen offset:1024
    s_waitcnt lgkmcnt(7)
    v_mfma_f32_16x16x32_bf16 v[48:51], a[136:139], v[208:211], v[48:51]
    ds_read_b128 a[168:171], v23 offset:22528
    v_mfma_f32_16x16x32_bf16 v[52:55], a[136:139], v[212:215], v[52:55]
    s_waitcnt lgkmcnt(7)
    v_mfma_f32_16x16x32_bf16 v[56:59], a[140:143], v[208:211], v[56:59]
    ds_read_b128 a[172:175], v23 offset:23040
    v_mfma_f32_16x16x32_bf16 v[60:63], a[140:143], v[212:215], v[60:63]
    s_add_u32 s52, s48, 139264
    buffer_load_dwordx4 a[32:35], v24, s[12:15], s52 offen offset:0
    s_waitcnt lgkmcnt(7)
    v_mfma_f32_16x16x32_bf16 v[64:67], a[144:147], v[208:211], v[64:67]
    ds_read_b128 a[128:131], v22 offset:24576
    v_mfma_f32_16x16x32_bf16 v[68:71], a[144:147], v[212:215], v[68:71]
    s_waitcnt lgkmcnt(7)
    v_mfma_f32_16x16x32_bf16 v[72:75], a[148:151], v[208:211], v[72:75]
    ds_read_b128 a[132:135], v22 offset:25088
    v_mfma_f32_16x16x32_bf16 v[76:79], a[148:151], v[212:215], v[76:79]
    buffer_load_dwordx4 a[36:39], v24, s[12:15], s52 offen offset:256
    s_waitcnt vmcnt(24)
    s_waitcnt lgkmcnt(7)
    v_mfma_f32_16x16x32_bf16 v[32:35], a[152:155], v[216:219], v[32:35]
    ds_read_b128 a[136:139], v22 offset:57344
    v_mfma_f32_16x16x32_bf16 v[36:39], a[152:155], v[220:223], v[36:39]
    buffer_load_dwordx4 a[40:43], v24, s[12:15], s52 offen offset:2048
    s_waitcnt lgkmcnt(7)
    v_mfma_f32_16x16x32_bf16 v[40:43], a[156:159], v[216:219], v[40:43]
    ds_read_b128 a[140:143], v22 offset:57856
    v_mfma_f32_16x16x32_bf16 v[44:47], a[156:159], v[220:223], v[44:47]
    s_add_u32 s63, s62, 139264
    buffer_load_dwordx4 a[200:203], v6, s[16:19], s63 offen
    s_waitcnt lgkmcnt(7)
    v_mfma_f32_16x16x32_bf16 v[48:51], a[160:163], v[216:219], v[48:51]
    ds_read_b128 a[144:147], v23 offset:24576
    v_mfma_f32_16x16x32_bf16 v[52:55], a[160:163], v[220:223], v[52:55]
    s_waitcnt lgkmcnt(7)
    v_mfma_f32_16x16x32_bf16 v[56:59], a[164:167], v[216:219], v[56:59]
    ds_read_b128 a[148:151], v23 offset:25088
    v_mfma_f32_16x16x32_bf16 v[60:63], a[164:167], v[220:223], v[60:63]
    buffer_load_dwordx4 a[44:47], v24, s[12:15], s52 offen offset:2304
    s_waitcnt lgkmcnt(7)
    v_mfma_f32_16x16x32_bf16 v[64:67], a[168:171], v[216:219], v[64:67]
    ds_read_b128 a[152:155], v22 offset:26624
    v_mfma_f32_16x16x32_bf16 v[68:71], a[168:171], v[220:223], v[68:71]
    s_waitcnt lgkmcnt(7)
    v_mfma_f32_16x16x32_bf16 v[72:75], a[172:175], v[216:219], v[72:75]
    ds_read_b128 a[156:159], v22 offset:27136
    v_mfma_f32_16x16x32_bf16 v[76:79], a[172:175], v[220:223], v[76:79]
    s_waitcnt vmcnt(25)
    s_waitcnt lgkmcnt(7)
    v_mfma_f32_16x16x32_bf16 v[32:35], a[128:131], v[224:227], v[32:35]
    ds_read_b128 a[160:163], v22 offset:59392
    v_mfma_f32_16x16x32_bf16 v[36:39], a[128:131], v[228:231], v[36:39]
    s_add_u32 s52, s48, 143360
    buffer_load_dwordx4 a[48:51], v24, s[12:15], s52 offen offset:0
    s_waitcnt lgkmcnt(7)
    v_mfma_f32_16x16x32_bf16 v[40:43], a[132:135], v[224:227], v[40:43]
    ds_read_b128 a[164:167], v22 offset:59904
    v_mfma_f32_16x16x32_bf16 v[44:47], a[132:135], v[228:231], v[44:47]
    buffer_load_dwordx4 a[204:207], v6, s[16:19], s63 offen offset:1024
    s_waitcnt lgkmcnt(7)
    v_mfma_f32_16x16x32_bf16 v[48:51], a[136:139], v[224:227], v[48:51]
    ds_read_b128 a[168:171], v23 offset:26624
    v_mfma_f32_16x16x32_bf16 v[52:55], a[136:139], v[228:231], v[52:55]
    s_waitcnt lgkmcnt(7)
    v_mfma_f32_16x16x32_bf16 v[56:59], a[140:143], v[224:227], v[56:59]
    ds_read_b128 a[172:175], v23 offset:27136
    v_mfma_f32_16x16x32_bf16 v[60:63], a[140:143], v[228:231], v[60:63]
    buffer_load_dwordx4 a[52:55], v24, s[12:15], s52 offen offset:256
    s_waitcnt lgkmcnt(7)
    v_mfma_f32_16x16x32_bf16 v[64:67], a[144:147], v[224:227], v[64:67]
    ds_read_b128 a[128:131], v22 offset:28672
    v_mfma_f32_16x16x32_bf16 v[68:71], a[144:147], v[228:231], v[68:71]
    s_waitcnt lgkmcnt(7)
    v_mfma_f32_16x16x32_bf16 v[72:75], a[148:151], v[224:227], v[72:75]
    ds_read_b128 a[132:135], v22 offset:29184
    v_mfma_f32_16x16x32_bf16 v[76:79], a[148:151], v[228:231], v[76:79]
    buffer_load_dwordx4 a[56:59], v24, s[12:15], s52 offen offset:2048
    s_waitcnt vmcnt(26)
    s_waitcnt lgkmcnt(7)
    v_mfma_f32_16x16x32_bf16 v[32:35], a[152:155], v[232:235], v[32:35]
    ds_read_b128 a[136:139], v22 offset:61440
    v_mfma_f32_16x16x32_bf16 v[36:39], a[152:155], v[236:239], v[36:39]
    buffer_load_dwordx4 a[60:63], v24, s[12:15], s52 offen offset:2304
    s_waitcnt lgkmcnt(7)
    v_mfma_f32_16x16x32_bf16 v[40:43], a[156:159], v[232:235], v[40:43]
    ds_read_b128 a[140:143], v22 offset:61952
    v_mfma_f32_16x16x32_bf16 v[44:47], a[156:159], v[236:239], v[44:47]
    s_add_u32 s63, s62, 147456
    buffer_load_dwordx4 a[208:211], v6, s[16:19], s63 offen
    s_waitcnt lgkmcnt(7)
    v_mfma_f32_16x16x32_bf16 v[48:51], a[160:163], v[232:235], v[48:51]
    ds_read_b128 a[144:147], v23 offset:28672
    v_mfma_f32_16x16x32_bf16 v[52:55], a[160:163], v[236:239], v[52:55]
    s_waitcnt lgkmcnt(7)
    v_mfma_f32_16x16x32_bf16 v[56:59], a[164:167], v[232:235], v[56:59]
    ds_read_b128 a[148:151], v23 offset:29184
    v_mfma_f32_16x16x32_bf16 v[60:63], a[164:167], v[236:239], v[60:63]
    s_add_u32 s52, s48, 147456
    buffer_load_dwordx4 a[64:67], v24, s[12:15], s52 offen offset:0
    s_waitcnt lgkmcnt(7)
    v_mfma_f32_16x16x32_bf16 v[64:67], a[168:171], v[232:235], v[64:67]
    ds_read_b128 a[152:155], v22 offset:30720
    v_mfma_f32_16x16x32_bf16 v[68:71], a[168:171], v[236:239], v[68:71]
    s_waitcnt lgkmcnt(7)
    v_mfma_f32_16x16x32_bf16 v[72:75], a[172:175], v[232:235], v[72:75]
    ds_read_b128 a[156:159], v22 offset:31232
    v_mfma_f32_16x16x32_bf16 v[76:79], a[172:175], v[236:239], v[76:79]
    buffer_load_dwordx4 a[68:71], v24, s[12:15], s52 offen offset:256
    s_waitcnt vmcnt(27)
    s_waitcnt lgkmcnt(7)
    v_mfma_f32_16x16x32_bf16 v[32:35], a[128:131], v[240:243], v[32:35]
    ds_read_b128 a[160:163], v22 offset:63488
    v_mfma_f32_16x16x32_bf16 v[36:39], a[128:131], v[244:247], v[36:39]
    buffer_load_dwordx4 a[72:75], v24, s[12:15], s52 offen offset:2048
    s_waitcnt lgkmcnt(7)
    v_mfma_f32_16x16x32_bf16 v[40:43], a[132:135], v[240:243], v[40:43]
    ds_read_b128 a[164:167], v22 offset:64000
    v_mfma_f32_16x16x32_bf16 v[44:47], a[132:135], v[244:247], v[44:47]
    buffer_load_dwordx4 a[212:215], v6, s[16:19], s63 offen offset:1024
    s_waitcnt lgkmcnt(7)
    v_mfma_f32_16x16x32_bf16 v[48:51], a[136:139], v[240:243], v[48:51]
    ds_read_b128 a[168:171], v23 offset:30720
    v_mfma_f32_16x16x32_bf16 v[52:55], a[136:139], v[244:247], v[52:55]
    s_waitcnt lgkmcnt(7)
    v_mfma_f32_16x16x32_bf16 v[56:59], a[140:143], v[240:243], v[56:59]
    ds_read_b128 a[172:175], v23 offset:31232
    v_mfma_f32_16x16x32_bf16 v[60:63], a[140:143], v[244:247], v[60:63]
    buffer_load_dwordx4 a[76:79], v24, s[12:15], s52 offen offset:2304
    s_waitcnt lgkmcnt(7)
    v_mfma_f32_16x16x32_bf16 v[64:67], a[144:147], v[240:243], v[64:67]
    ds_read_b128 a[128:131], v22 offset:0
    v_mfma_f32_16x16x32_bf16 v[68:71], a[144:147], v[244:247], v[68:71]
    s_waitcnt lgkmcnt(7)
    v_mfma_f32_16x16x32_bf16 v[72:75], a[148:151], v[240:243], v[72:75]
    ds_read_b128 a[132:135], v22 offset:512
    v_mfma_f32_16x16x32_bf16 v[76:79], a[148:151], v[244:247], v[76:79]
    s_waitcnt vmcnt(28)
    s_waitcnt lgkmcnt(7)
    v_mfma_f32_16x16x32_bf16 v[32:35], a[152:155], v[248:251], v[32:35]
    ds_read_b128 a[136:139], v22 offset:32768
    v_mfma_f32_16x16x32_bf16 v[36:39], a[152:155], v[252:255], v[36:39]
    s_add_u32 s52, s48, 151552
    buffer_load_dwordx4 a[80:83], v24, s[12:15], s52 offen offset:0
    s_waitcnt lgkmcnt(7)
    v_mfma_f32_16x16x32_bf16 v[40:43], a[156:159], v[248:251], v[40:43]
    ds_read_b128 a[140:143], v22 offset:33280
    v_mfma_f32_16x16x32_bf16 v[44:47], a[156:159], v[252:255], v[44:47]
    s_waitcnt lgkmcnt(7)
    v_mfma_f32_16x16x32_bf16 v[48:51], a[160:163], v[248:251], v[48:51]
    ds_read_b128 a[144:147], v23 offset:0
    v_mfma_f32_16x16x32_bf16 v[52:55], a[160:163], v[252:255], v[52:55]
    s_waitcnt lgkmcnt(7)
    v_mfma_f32_16x16x32_bf16 v[56:59], a[164:167], v[248:251], v[56:59]
    ds_read_b128 a[148:151], v23 offset:512
    v_mfma_f32_16x16x32_bf16 v[60:63], a[164:167], v[252:255], v[60:63]
    buffer_load_dwordx4 a[84:87], v24, s[12:15], s52 offen offset:256
    s_waitcnt lgkmcnt(7)
    v_mfma_f32_16x16x32_bf16 v[64:67], a[168:171], v[248:251], v[64:67]
    ds_read_b128 a[152:155], v22 offset:2048
    v_mfma_f32_16x16x32_bf16 v[68:71], a[168:171], v[252:255], v[68:71]
    s_waitcnt lgkmcnt(7)
    v_mfma_f32_16x16x32_bf16 v[72:75], a[172:175], v[248:251], v[72:75]
    ds_read_b128 a[156:159], v22 offset:2560
    v_mfma_f32_16x16x32_bf16 v[76:79], a[172:175], v[252:255], v[76:79]
    buffer_load_dwordx4 a[88:91], v24, s[12:15], s52 offen offset:2048
    s_waitcnt vmcnt(28)
    s_waitcnt lgkmcnt(7)
    v_mfma_f32_16x16x32_bf16 v[80:83], a[128:131], a[0:3], 0
    ds_read_b128 a[160:163], v22 offset:34816
    v_mfma_f32_16x16x32_bf16 v[84:87], a[128:131], a[4:7], 0
    buffer_load_dwordx4 a[92:95], v24, s[12:15], s52 offen offset:2304
    s_waitcnt lgkmcnt(7)
    v_mfma_f32_16x16x32_bf16 v[88:91], a[132:135], a[0:3], 0
    ds_read_b128 a[164:167], v22 offset:35328
    v_mfma_f32_16x16x32_bf16 v[92:95], a[132:135], a[4:7], 0
    s_waitcnt lgkmcnt(7)
    v_mfma_f32_16x16x32_bf16 v[96:99], a[136:139], a[0:3], 0
    ds_read_b128 a[168:171], v23 offset:2048
    v_mfma_f32_16x16x32_bf16 v[100:103], a[136:139], a[4:7], 0
    s_waitcnt lgkmcnt(7)
    v_mfma_f32_16x16x32_bf16 v[104:107], a[140:143], a[0:3], 0
    ds_read_b128 a[172:175], v23 offset:2560
    v_mfma_f32_16x16x32_bf16 v[108:111], a[140:143], a[4:7], 0
    s_add_u32 s52, s48, 155648
    buffer_load_dwordx4 a[96:99], v24, s[12:15], s52 offen offset:0
    s_waitcnt lgkmcnt(7)
    v_mfma_f32_16x16x32_bf16 v[112:115], a[144:147], a[0:3], 0
    ds_read_b128 a[128:131], v22 offset:4096
    v_mfma_f32_16x16x32_bf16 v[116:119], a[144:147], a[4:7], 0
    s_waitcnt lgkmcnt(7)
    v_mfma_f32_16x16x32_bf16 v[120:123], a[148:151], a[0:3], 0
    ds_read_b128 a[132:135], v22 offset:4608
    v_mfma_f32_16x16x32_bf16 v[124:127], a[148:151], a[4:7], 0
    v_mul_f32 v8, v32, v32
    v_mul_f32 v9, v33, v33
    v_mul_f32 v10, v34, v34
    v_mul_f32 v11, v35, v35
    s_waitcnt vmcnt(27)
    s_waitcnt lgkmcnt(7)
    v_mfma_f32_16x16x32_bf16 v[80:83], a[152:155], a[8:11], v[80:83]
    ds_read_b128 a[136:139], v22 offset:36864
    v_mul_f32 v12, v36, v36
    v_mul_f32 v13, v37, v37
    v_mul_f32 v14, v38, v38
    v_mul_f32 v15, v39, v39
    v_mfma_f32_16x16x32_bf16 v[84:87], a[152:155], a[12:15], v[84:87]
    buffer_load_dwordx4 a[100:103], v24, s[12:15], s52 offen offset:256
    s_waitcnt lgkmcnt(7)
    v_mfma_f32_16x16x32_bf16 v[88:91], a[156:159], a[8:11], v[88:91]
    ds_read_b128 a[140:143], v22 offset:37376
    v_fma_f32 v8, v8, s56, v7
    v_fma_f32 v9, v9, s56, v7
    v_fma_f32 v10, v10, s56, v7
    v_fma_f32 v11, v11, s56, v7
    v_mfma_f32_16x16x32_bf16 v[92:95], a[156:159], a[12:15], v[92:95]
    s_add_u32 s63, s62, 0
    buffer_load_dwordx4 v[144:147], v6, s[16:19], s63 offen
    s_waitcnt lgkmcnt(7)
    v_mfma_f32_16x16x32_bf16 v[96:99], a[160:163], a[8:11], v[96:99]
    ds_read_b128 a[144:147], v23 offset:4096
    v_fma_f32 v12, v12, s56, v7
    v_fma_f32 v13, v13, s56, v7
    v_fma_f32 v14, v14, s56, v7
    v_fma_f32 v15, v15, s56, v7
    v_mfma_f32_16x16x32_bf16 v[100:103], a[160:163], a[12:15], v[100:103]
    v_mul_f32 v8, v8, v32
    v_mul_f32 v9, v9, v33
    v_mul_f32 v10, v10, v34
    v_mul_f32 v11, v11, v35
    s_waitcnt lgkmcnt(7)
    v_mfma_f32_16x16x32_bf16 v[104:107], a[164:167], a[8:11], v[104:107]
    ds_read_b128 a[148:151], v23 offset:4608
    v_mul_f32 v12, v12, v36
    v_mul_f32 v13, v13, v37
    v_mul_f32 v14, v14, v38
    v_mul_f32 v15, v15, v39
    v_mfma_f32_16x16x32_bf16 v[108:111], a[164:167], a[12:15], v[108:111]
    buffer_load_dwordx4 a[104:107], v24, s[12:15], s52 offen offset:2048
    s_waitcnt lgkmcnt(7)
    v_mfma_f32_16x16x32_bf16 v[112:115], a[168:171], a[8:11], v[112:115]
    ds_read_b128 a[152:155], v22 offset:6144
    v_exp_f32 v8, v8
    v_mul_f32 v32, v32, v40
    v_exp_f32 v9, v9
    v_mfma_f32_16x16x32_bf16 v[116:119], a[168:171], a[12:15], v[116:119]
    buffer_load_dwordx4 v[148:151], v6, s[16:19], s63 offen offset:1024
    s_waitcnt lgkmcnt(7)
    v_mfma_f32_16x16x32_bf16 v[120:123], a[172:175], a[8:11], v[120:123]
    ds_read_b128 a[156:159], v22 offset:6656
    v_mul_f32 v33, v33, v41
    v_exp_f32 v10, v10
    v_mul_f32 v34, v34, v42
    v_mfma_f32_16x16x32_bf16 v[124:127], a[172:175], a[12:15], v[124:127]
    v_exp_f32 v11, v11
    v_mul_f32 v35, v35, v43
    v_exp_f32 v12, v12
    s_waitcnt vmcnt(28)
    s_waitcnt lgkmcnt(7)
    v_mfma_f32_16x16x32_bf16 v[80:83], a[128:131], a[16:19], v[80:83]
    ds_read_b128 a[160:163], v22 offset:38912
    v_mul_f32 v36, v36, v44
    v_exp_f32 v13, v13
    v_mul_f32 v37, v37, v45
    v_mfma_f32_16x16x32_bf16 v[84:87], a[128:131], a[20:23], v[84:87]
    buffer_load_dwordx4 a[108:111], v24, s[12:15], s52 offen offset:2304
    s_waitcnt lgkmcnt(7)
    v_mfma_f32_16x16x32_bf16 v[88:91], a[132:135], a[16:19], v[88:91]
    ds_read_b128 a[164:167], v22 offset:39424
    v_exp_f32 v14, v14
    v_mul_f32 v38, v38, v46
    v_exp_f32 v15, v15
    v_mfma_f32_16x16x32_bf16 v[92:95], a[132:135], a[20:23], v[92:95]
    s_add_u32 s63, s62, 8192
    buffer_load_dwordx4 v[152:155], v6, s[16:19], s63 offen
    s_waitcnt lgkmcnt(7)
    v_mfma_f32_16x16x32_bf16 v[96:99], a[136:139], a[16:19], v[96:99]
    ds_read_b128 a[168:171], v23 offset:6144
    v_mul_f32 v39, v39, v47
    v_add_f32 v8, 1.0, v8
    v_add_f32 v9, 1.0, v9
    v_add_f32 v10, 1.0, v10
    v_mfma_f32_16x16x32_bf16 v[100:103], a[136:139], a[20:23], v[100:103]
    v_add_f32 v11, 1.0, v11
    v_add_f32 v12, 1.0, v12
    v_add_f32 v13, 1.0, v13
    v_add_f32 v14, 1.0, v14
    s_waitcnt lgkmcnt(7)
    v_mfma_f32_16x16x32_bf16 v[104:107], a[140:143], a[16:19], v[104:107]
    ds_read_b128 a[172:175], v23 offset:6656
    v_add_f32 v15, 1.0, v15
    v_rcp_f32 v8, v8
    v_rcp_f32 v9, v9
    v_mfma_f32_16x16x32_bf16 v[108:111], a[140:143], a[20:23], v[108:111]
    s_add_u32 s52, s48, 159744
    buffer_load_dwordx4 a[112:115], v24, s[12:15], s52 offen offset:0
    s_waitcnt lgkmcnt(7)
    v_mfma_f32_16x16x32_bf16 v[112:115], a[144:147], a[16:19], v[112:115]
    ds_read_b128 a[128:131], v22 offset:8192
    v_mul_f32 v32, v32, v8
    v_rcp_f32 v10, v10
    v_mul_f32 v33, v33, v9
    v_mfma_f32_16x16x32_bf16 v[116:119], a[144:147], a[20:23], v[116:119]
    buffer_load_dwordx4 v[156:159], v6, s[16:19], s63 offen offset:1024
    s_waitcnt lgkmcnt(7)
    v_mfma_f32_16x16x32_bf16 v[120:123], a[148:151], a[16:19], v[120:123]
    ds_read_b128 a[132:135], v22 offset:8704
    v_rcp_f32 v11, v11
    v_mul_f32 v34, v34, v10
    v_rcp_f32 v12, v12
    v_mfma_f32_16x16x32_bf16 v[124:127], a[148:151], a[20:23], v[124:127]
    v_mul_f32 v35, v35, v11
    v_rcp_f32 v13, v13
    v_mul_f32 v36, v36, v12
    s_waitcnt vmcnt(30)
    s_waitcnt lgkmcnt(7)
    v_mfma_f32_16x16x32_bf16 v[80:83], a[152:155], a[24:27], v[80:83]
    ds_read_b128 a[136:139], v22 offset:40960
    v_rcp_f32 v14, v14
    v_mul_f32 v37, v37, v13
    v_rcp_f32 v15, v15
    v_mfma_f32_16x16x32_bf16 v[84:87], a[152:155], a[28:31], v[84:87]
    buffer_load_dwordx4 a[116:119], v24, s[12:15], s52 offen offset:256
    s_waitcnt lgkmcnt(7)
    v_mfma_f32_16x16x32_bf16 v[88:91], a[156:159], a[24:27], v[88:91]
    ds_read_b128 a[140:143], v22 offset:41472
    v_mul_f32 v38, v38, v14
    v_cvt_pk_bf16_f32 v40, v32, v33
    v_mul_f32 v39, v39, v15
    v_cvt_pk_bf16_f32 v41, v34, v35
    v_mfma_f32_16x16x32_bf16 v[92:95], a[156:159], a[28:31], v[92:95]
    s_add_u32 s63, s62, 16384
    buffer_load_dwordx4 v[160:163], v6, s[16:19], s63 offen
    s_waitcnt lgkmcnt(7)
    v_mfma_f32_16x16x32_bf16 v[96:99], a[160:163], a[24:27], v[96:99]
    ds_read_b128 a[144:147], v23 offset:8192
    v_cvt_pk_bf16_f32 v42, v36, v37
    v_cvt_pk_bf16_f32 v43, v38, v39
    s_nop 1
    v_permlane16_swap_b32 v40, v42
    v_mfma_f32_16x16x32_bf16 v[100:103], a[160:163], a[28:31], v[100:103]
    v_permlane16_swap_b32 v41, v43
    s_add_u32 s50, s49, 0
    buffer_store_dwordx4 v[40:43], v6, s[12:15], s50 offen offset:0 sc1
    s_waitcnt lgkmcnt(7)
    v_mfma_f32_16x16x32_bf16 v[104:107], a[164:167], a[24:27], v[104:107]
    ds_read_b128 a[148:151], v23 offset:8704
    v_mul_f32 v8, v48, v48
    v_mul_f32 v9, v49, v49
    v_mul_f32 v10, v50, v50
    v_mul_f32 v11, v51, v51
    v_mfma_f32_16x16x32_bf16 v[108:111], a[164:167], a[28:31], v[108:111]
    buffer_load_dwordx4 a[120:123], v24, s[12:15], s52 offen offset:2048
    s_waitcnt lgkmcnt(7)
    v_mfma_f32_16x16x32_bf16 v[112:115], a[168:171], a[24:27], v[112:115]
    ds_read_b128 a[152:155], v22 offset:10240
    v_mul_f32 v12, v52, v52
    v_mul_f32 v13, v53, v53
    v_mul_f32 v14, v54, v54
    v_mul_f32 v15, v55, v55
    v_mfma_f32_16x16x32_bf16 v[116:119], a[168:171], a[28:31], v[116:119]
    buffer_load_dwordx4 v[164:167], v6, s[16:19], s63 offen offset:1024
    s_waitcnt lgkmcnt(7)
    v_mfma_f32_16x16x32_bf16 v[120:123], a[172:175], a[24:27], v[120:123]
    ds_read_b128 a[156:159], v22 offset:10752
    v_fma_f32 v8, v8, s56, v7
    v_fma_f32 v9, v9, s56, v7
    v_fma_f32 v10, v10, s56, v7
    v_fma_f32 v11, v11, s56, v7
    v_mfma_f32_16x16x32_bf16 v[124:127], a[172:175], a[28:31], v[124:127]
    v_fma_f32 v12, v12, s56, v7
    v_fma_f32 v13, v13, s56, v7
    v_fma_f32 v14, v14, s56, v7
    v_fma_f32 v15, v15, s56, v7
    s_waitcnt vmcnt(32)
    s_waitcnt lgkmcnt(7)
    v_mfma_f32_16x16x32_bf16 v[80:83], a[128:131], a[32:35], v[80:83]
    ds_read_b128 a[160:163], v22 offset:43008
    v_mul_f32 v8, v8, v48
    v_mul_f32 v9, v9, v49
    v_mul_f32 v10, v10, v50
    v_mul_f32 v11, v11, v51
    v_mfma_f32_16x16x32_bf16 v[84:87], a[128:131], a[36:39], v[84:87]
    buffer_load_dwordx4 a[124:127], v24, s[12:15], s52 offen offset:2304
    s_waitcnt lgkmcnt(7)
    v_mfma_f32_16x16x32_bf16 v[88:91], a[132:135], a[32:35], v[88:91]
    ds_read_b128 a[164:167], v22 offset:43520
    v_mul_f32 v12, v12, v52
    v_mul_f32 v13, v13, v53
    v_mul_f32 v14, v14, v54
    v_mul_f32 v15, v15, v55
    v_mfma_f32_16x16x32_bf16 v[92:95], a[132:135], a[36:39], v[92:95]
    s_add_u32 s63, s62, 24576
    buffer_load_dwordx4 v[168:171], v6, s[16:19], s63 offen
    s_waitcnt lgkmcnt(7)
    v_mfma_f32_16x16x32_bf16 v[96:99], a[136:139], a[32:35], v[96:99]
    ds_read_b128 a[168:171], v23 offset:10240
    v_exp_f32 v8, v8
    v_mul_f32 v48, v48, v56
    v_exp_f32 v9, v9
    v_mfma_f32_16x16x32_bf16 v[100:103], a[136:139], a[36:39], v[100:103]
    v_mul_f32 v49, v49, v57
    v_exp_f32 v10, v10
    v_mul_f32 v50, v50, v58
    s_waitcnt lgkmcnt(7)
    v_mfma_f32_16x16x32_bf16 v[104:107], a[140:143], a[32:35], v[104:107]
    ds_read_b128 a[172:175], v23 offset:10752
    v_exp_f32 v11, v11
    v_mul_f32 v51, v51, v59
    v_exp_f32 v12, v12
    v_mfma_f32_16x16x32_bf16 v[108:111], a[140:143], a[36:39], v[108:111]
    v_mul_f32 v52, v52, v60
    v_exp_f32 v13, v13
    v_mul_f32 v53, v53, v61
    s_waitcnt lgkmcnt(7)
    v_mfma_f32_16x16x32_bf16 v[112:115], a[144:147], a[32:35], v[112:115]
    ds_read_b128 a[128:131], v22 offset:12288
    v_exp_f32 v14, v14
    v_mul_f32 v54, v54, v62
    v_exp_f32 v15, v15
    v_mfma_f32_16x16x32_bf16 v[116:119], a[144:147], a[36:39], v[116:119]
    buffer_load_dwordx4 v[172:175], v6, s[16:19], s63 offen offset:1024
    s_waitcnt lgkmcnt(7)
    v_mfma_f32_16x16x32_bf16 v[120:123], a[148:151], a[32:35], v[120:123]
    ds_read_b128 a[132:135], v22 offset:12800
    v_mul_f32 v55, v55, v63
    v_add_f32 v8, 1.0, v8
    v_add_f32 v9, 1.0, v9
    v_add_f32 v10, 1.0, v10
    v_mfma_f32_16x16x32_bf16 v[124:127], a[148:151], a[36:39], v[124:127]
    v_add_f32 v11, 1.0, v11
    v_add_f32 v12, 1.0, v12
    v_add_f32 v13, 1.0, v13
    v_add_f32 v14, 1.0, v14
    s_waitcnt vmcnt(32)
    s_waitcnt lgkmcnt(7)
    v_mfma_f32_16x16x32_bf16 v[80:83], a[152:155], a[40:43], v[80:83]
    ds_read_b128 a[136:139], v22 offset:45056
    v_add_f32 v15, 1.0, v15
    v_rcp_f32 v8, v8
    v_rcp_f32 v9, v9
    v_mfma_f32_16x16x32_bf16 v[84:87], a[152:155], a[44:47], v[84:87]
    v_mul_f32 v48, v48, v8
    v_rcp_f32 v10, v10
    v_mul_f32 v49, v49, v9
    s_waitcnt lgkmcnt(7)
    v_mfma_f32_16x16x32_bf16 v[88:91], a[156:159], a[40:43], v[88:91]
    ds_read_b128 a[140:143], v22 offset:45568
    v_rcp_f32 v11, v11
    v_mul_f32 v50, v50, v10
    v_rcp_f32 v12, v12
    v_mfma_f32_16x16x32_bf16 v[92:95], a[156:159], a[44:47], v[92:95]
    s_add_u32 s63, s62, 32768
    buffer_load_dwordx4 v[176:179], v6, s[16:19], s63 offen
    s_waitcnt lgkmcnt(7)
    v_mfma_f32_16x16x32_bf16 v[96:99], a[160:163], a[40:43], v[96:99]
    ds_read_b128 a[144:147], v23 offset:12288
    v_mul_f32 v51, v51, v11
    v_rcp_f32 v13, v13
    v_mul_f32 v52, v52, v12
    v_mfma_f32_16x16x32_bf16 v[100:103], a[160:163], a[44:47], v[100:103]
    v_rcp_f32 v14, v14
    v_mul_f32 v53, v53, v13
    v_rcp_f32 v15, v15
    s_waitcnt lgkmcnt(7)
    v_mfma_f32_16x16x32_bf16 v[104:107], a[164:167], a[40:43], v[104:107]
    ds_read_b128 a[148:151], v23 offset:12800
    v_mul_f32 v54, v54, v14
    v_cvt_pk_bf16_f32 v56, v48, v49
    v_mul_f32 v55, v55, v15
    v_cvt_pk_bf16_f32 v57, v50, v51
    v_mfma_f32_16x16x32_bf16 v[108:111], a[164:167], a[44:47], v[108:111]
    v_cvt_pk_bf16_f32 v58, v52, v53
    v_cvt_pk_bf16_f32 v59, v54, v55
    s_nop 1
    v_permlane16_swap_b32 v56, v58
    s_waitcnt lgkmcnt(7)
    v_mfma_f32_16x16x32_bf16 v[112:115], a[168:171], a[40:43], v[112:115]
    ds_read_b128 a[152:155], v22 offset:14336
    v_permlane16_swap_b32 v57, v59
    s_add_u32 s50, s49, 0
    buffer_store_dwordx4 v[56:59], v6, s[12:15], s50 offen offset:1024 sc1
    v_mfma_f32_16x16x32_bf16 v[116:119], a[168:171], a[44:47], v[116:119]
    buffer_load_dwordx4 v[180:183], v6, s[16:19], s63 offen offset:1024
    s_waitcnt lgkmcnt(7)
    v_mfma_f32_16x16x32_bf16 v[120:123], a[172:175], a[40:43], v[120:123]
    ds_read_b128 a[156:159], v22 offset:14848
    v_mul_f32 v8, v64, v64
    v_mul_f32 v9, v65, v65
    v_mul_f32 v10, v66, v66
    v_mul_f32 v11, v67, v67
    v_mfma_f32_16x16x32_bf16 v[124:127], a[172:175], a[44:47], v[124:127]
    v_mul_f32 v12, v68, v68
    v_mul_f32 v13, v69, v69
    v_mul_f32 v14, v70, v70
    v_mul_f32 v15, v71, v71
    s_waitcnt vmcnt(32)
    s_waitcnt lgkmcnt(7)
    v_mfma_f32_16x16x32_bf16 v[80:83], a[128:131], a[48:51], v[80:83]
    ds_read_b128 a[160:163], v22 offset:47104
    v_fma_f32 v8, v8, s56, v7
    v_fma_f32 v9, v9, s56, v7
    v_fma_f32 v10, v10, s56, v7
    v_fma_f32 v11, v11, s56, v7
    v_mfma_f32_16x16x32_bf16 v[84:87], a[128:131], a[52:55], v[84:87]
    v_fma_f32 v12, v12, s56, v7
    v_fma_f32 v13, v13, s56, v7
    v_fma_f32 v14, v14, s56, v7
    v_fma_f32 v15, v15, s56, v7
    s_waitcnt lgkmcnt(7)
    v_mfma_f32_16x16x32_bf16 v[88:91], a[132:135], a[48:51], v[88:91]
    ds_read_b128 a[164:167], v22 offset:47616
    v_mul_f32 v8, v8, v64
    v_mul_f32 v9, v9, v65
    v_mul_f32 v10, v10, v66
    v_mul_f32 v11, v11, v67
    v_mfma_f32_16x16x32_bf16 v[92:95], a[132:135], a[52:55], v[92:95]
    s_add_u32 s63, s62, 40960
    buffer_load_dwordx4 v[184:187], v6, s[16:19], s63 offen
    s_waitcnt lgkmcnt(7)
    v_mfma_f32_16x16x32_bf16 v[96:99], a[136:139], a[48:51], v[96:99]
    ds_read_b128 a[168:171], v23 offset:14336
    v_mul_f32 v12, v12, v68
    v_mul_f32 v13, v13, v69
    v_mul_f32 v14, v14, v70
    v_mul_f32 v15, v15, v71
    v_mfma_f32_16x16x32_bf16 v[100:103], a[136:139], a[52:55], v[100:103]
    v_exp_f32 v8, v8
    v_mul_f32 v64, v64, v72
    v_exp_f32 v9, v9
    s_waitcnt lgkmcnt(7)
    v_mfma_f32_16x16x32_bf16 v[104:107], a[140:143], a[48:51], v[104:107]
    ds_read_b128 a[172:175], v23 offset:14848
    v_mul_f32 v65, v65, v73
    v_exp_f32 v10, v10
    v_mul_f32 v66, v66, v74
    v_mfma_f32_16x16x32_bf16 v[108:111], a[140:143], a[52:55], v[108:111]
    v_exp_f32 v11, v11
    v_mul_f32 v67, v67, v75
    v_exp_f32 v12, v12
    s_waitcnt lgkmcnt(7)
    v_mfma_f32_16x16x32_bf16 v[112:115], a[144:147], a[48:51], v[112:115]
    ds_read_b128 a[128:131], v22 offset:16384
    v_mul_f32 v68, v68, v76
    v_exp_f32 v13, v13
    v_mul_f32 v69, v69, v77
    v_mfma_f32_16x16x32_bf16 v[116:119], a[144:147], a[52:55], v[116:119]
    buffer_load_dwordx4 v[188:191], v6, s[16:19], s63 offen offset:1024
    s_waitcnt lgkmcnt(7)
    v_mfma_f32_16x16x32_bf16 v[120:123], a[148:151], a[48:51], v[120:123]
    ds_read_b128 a[132:135], v22 offset:16896
    v_exp_f32 v14, v14
    v_mul_f32 v70, v70, v78
    v_exp_f32 v15, v15
    v_mfma_f32_16x16x32_bf16 v[124:127], a[148:151], a[52:55], v[124:127]
    v_mul_f32 v71, v71, v79
    v_add_f32 v8, 1.0, v8
    v_add_f32 v9, 1.0, v9
    v_add_f32 v10, 1.0, v10
    s_waitcnt vmcnt(32)
    s_waitcnt lgkmcnt(7)
    v_mfma_f32_16x16x32_bf16 v[80:83], a[152:155], a[56:59], v[80:83]
    ds_read_b128 a[136:139], v22 offset:49152
    v_add_f32 v11, 1.0, v11
    v_add_f32 v12, 1.0, v12
    v_add_f32 v13, 1.0, v13
    v_add_f32 v14, 1.0, v14
    v_mfma_f32_16x16x32_bf16 v[84:87], a[152:155], a[60:63], v[84:87]
    v_add_f32 v15, 1.0, v15
    v_rcp_f32 v8, v8
    v_rcp_f32 v9, v9
    s_waitcnt lgkmcnt(7)
    v_mfma_f32_16x16x32_bf16 v[88:91], a[156:159], a[56:59], v[88:91]
    ds_read_b128 a[140:143], v22 offset:49664
    v_mul_f32 v64, v64, v8
    v_rcp_f32 v10, v10
    v_mul_f32 v65, v65, v9
    v_mfma_f32_16x16x32_bf16 v[92:95], a[156:159], a[60:63], v[92:95]
    s_add_u32 s63, s62, 49152
    buffer_load_dwordx4 v[192:195], v6, s[16:19], s63 offen
    s_waitcnt lgkmcnt(7)
    v_mfma_f32_16x16x32_bf16 v[96:99], a[160:163], a[56:59], v[96:99]
    ds_read_b128 a[144:147], v23 offset:16384
    v_rcp_f32 v11, v11
    v_mul_f32 v66, v66, v10
    v_rcp_f32 v12, v12
    v_mfma_f32_16x16x32_bf16 v[100:103], a[160:163], a[60:63], v[100:103]
    v_mul_f32 v67, v67, v11
    v_rcp_f32 v13, v13
    v_mul_f32 v68, v68, v12
    s_waitcnt lgkmcnt(7)
    v_mfma_f32_16x16x32_bf16 v[104:107], a[164:167], a[56:59], v[104:107]
    ds_read_b128 a[148:151], v23 offset:16896
    v_rcp_f32 v14, v14
    v_mul_f32 v69, v69, v13
    v_rcp_f32 v15, v15
    v_mfma_f32_16x16x32_bf16 v[108:111], a[164:167], a[60:63], v[108:111]
    v_mul_f32 v70, v70, v14
    v_cvt_pk_bf16_f32 v72, v64, v65
    v_mul_f32 v71, v71, v15
    v_cvt_pk_bf16_f32 v73, v66, v67
    s_waitcnt lgkmcnt(7)
    v_mfma_f32_16x16x32_bf16 v[112:115], a[168:171], a[56:59], v[112:115]
    ds_read_b128 a[152:155], v22 offset:18432
    v_cvt_pk_bf16_f32 v74, v68, v69
    v_cvt_pk_bf16_f32 v75, v70, v71
    s_nop 1
    v_permlane16_swap_b32 v72, v74
    v_mfma_f32_16x16x32_bf16 v[116:119], a[168:171], a[60:63], v[116:119]
    buffer_load_dwordx4 v[196:199], v6, s[16:19], s63 offen offset:1024
    s_waitcnt lgkmcnt(7)
    v_mfma_f32_16x16x32_bf16 v[120:123], a[172:175], a[56:59], v[120:123]
    ds_read_b128 a[156:159], v22 offset:18944
    v_permlane16_swap_b32 v73, v75
    s_add_u32 s50, s49, 0
    s_cmp_eq_u32 s5, 28
    s_cselect_b32 s50, 2130706432, s50
    buffer_store_dwordx4 v[72:75], v6, s[12:15], s50 offen offset:2048 sc1
    v_mfma_f32_16x16x32_bf16 v[124:127], a[172:175], a[60:63], v[124:127]
    s_waitcnt vmcnt(32)
    s_waitcnt lgkmcnt(7)
    v_mfma_f32_16x16x32_bf16 v[80:83], a[128:131], a[64:67], v[80:83]
    ds_read_b128 a[160:163], v22 offset:51200
    v_mfma_f32_16x16x32_bf16 v[84:87], a[128:131], a[68:71], v[84:87]
    s_waitcnt lgkmcnt(7)
    v_mfma_f32_16x16x32_bf16 v[88:91], a[132:135], a[64:67], v[88:91]
    ds_read_b128 a[164:167], v22 offset:51712
    v_mfma_f32_16x16x32_bf16 v[92:95], a[132:135], a[68:71], v[92:95]
    s_add_u32 s63, s62, 57344
    buffer_load_dwordx4 v[200:203], v6, s[16:19], s63 offen
    s_waitcnt lgkmcnt(7)
    v_mfma_f32_16x16x32_bf16 v[96:99], a[136:139], a[64:67], v[96:99]
    ds_read_b128 a[168:171], v23 offset:18432
    v_mfma_f32_16x16x32_bf16 v[100:103], a[136:139], a[68:71], v[100:103]
    s_waitcnt lgkmcnt(7)
    v_mfma_f32_16x16x32_bf16 v[104:107], a[140:143], a[64:67], v[104:107]
    ds_read_b128 a[172:175], v23 offset:18944
    v_mfma_f32_16x16x32_bf16 v[108:111], a[140:143], a[68:71], v[108:111]
    s_waitcnt lgkmcnt(7)
    v_mfma_f32_16x16x32_bf16 v[112:115], a[144:147], a[64:67], v[112:115]
    ds_read_b128 a[128:131], v22 offset:20480
    v_mfma_f32_16x16x32_bf16 v[116:119], a[144:147], a[68:71], v[116:119]
    buffer_load_dwordx4 v[204:207], v6, s[16:19], s63 offen offset:1024
    s_waitcnt lgkmcnt(7)
    v_mfma_f32_16x16x32_bf16 v[120:123], a[148:151], a[64:67], v[120:123]
    ds_read_b128 a[132:135], v22 offset:20992
    v_mfma_f32_16x16x32_bf16 v[124:127], a[148:151], a[68:71], v[124:127]
    s_waitcnt vmcnt(31)
    s_waitcnt lgkmcnt(7)
    v_mfma_f32_16x16x32_bf16 v[80:83], a[152:155], a[72:75], v[80:83]
    ds_read_b128 a[136:139], v22 offset:53248
    v_mfma_f32_16x16x32_bf16 v[84:87], a[152:155], a[76:79], v[84:87]
    s_waitcnt lgkmcnt(7)
    v_mfma_f32_16x16x32_bf16 v[88:91], a[156:159], a[72:75], v[88:91]
    ds_read_b128 a[140:143], v22 offset:53760
    v_mfma_f32_16x16x32_bf16 v[92:95], a[156:159], a[76:79], v[92:95]
    s_add_u32 s63, s62, 65536
    buffer_load_dwordx4 v[208:211], v6, s[16:19], s63 offen
    s_waitcnt lgkmcnt(7)
    v_mfma_f32_16x16x32_bf16 v[96:99], a[160:163], a[72:75], v[96:99]
    ds_read_b128 a[144:147], v23 offset:20480
    v_mfma_f32_16x16x32_bf16 v[100:103], a[160:163], a[76:79], v[100:103]
    s_waitcnt lgkmcnt(7)
    v_mfma_f32_16x16x32_bf16 v[104:107], a[164:167], a[72:75], v[104:107]
    ds_read_b128 a[148:151], v23 offset:20992
    v_mfma_f32_16x16x32_bf16 v[108:111], a[164:167], a[76:79], v[108:111]
    s_waitcnt lgkmcnt(7)
    v_mfma_f32_16x16x32_bf16 v[112:115], a[168:171], a[72:75], v[112:115]
    ds_read_b128 a[152:155], v22 offset:22528
    v_mfma_f32_16x16x32_bf16 v[116:119], a[168:171], a[76:79], v[116:119]
    buffer_load_dwordx4 v[212:215], v6, s[16:19], s63 offen offset:1024
    s_waitcnt lgkmcnt(7)
    v_mfma_f32_16x16x32_bf16 v[120:123], a[172:175], a[72:75], v[120:123]
    ds_read_b128 a[156:159], v22 offset:23040
    v_mfma_f32_16x16x32_bf16 v[124:127], a[172:175], a[76:79], v[124:127]
    s_waitcnt vmcnt(31)
    s_waitcnt lgkmcnt(7)
    v_mfma_f32_16x16x32_bf16 v[80:83], a[128:131], a[80:83], v[80:83]
    ds_read_b128 a[160:163], v22 offset:55296
    v_mfma_f32_16x16x32_bf16 v[84:87], a[128:131], a[84:87], v[84:87]
    s_waitcnt lgkmcnt(7)
    v_mfma_f32_16x16x32_bf16 v[88:91], a[132:135], a[80:83], v[88:91]
    ds_read_b128 a[164:167], v22 offset:55808
    v_mfma_f32_16x16x32_bf16 v[92:95], a[132:135], a[84:87], v[92:95]
    s_add_u32 s63, s62, 73728
    buffer_load_dwordx4 v[216:219], v6, s[16:19], s63 offen
    s_waitcnt lgkmcnt(7)
    v_mfma_f32_16x16x32_bf16 v[96:99], a[136:139], a[80:83], v[96:99]
    ds_read_b128 a[168:171], v23 offset:22528
    v_mfma_f32_16x16x32_bf16 v[100:103], a[136:139], a[84:87], v[100:103]
    s_waitcnt lgkmcnt(7)
    v_mfma_f32_16x16x32_bf16 v[104:107], a[140:143], a[80:83], v[104:107]
    ds_read_b128 a[172:175], v23 offset:23040
    v_mfma_f32_16x16x32_bf16 v[108:111], a[140:143], a[84:87], v[108:111]
    s_waitcnt lgkmcnt(7)
    v_mfma_f32_16x16x32_bf16 v[112:115], a[144:147], a[80:83], v[112:115]
    ds_read_b128 a[128:131], v22 offset:24576
    v_mfma_f32_16x16x32_bf16 v[116:119], a[144:147], a[84:87], v[116:119]
    buffer_load_dwordx4 v[220:223], v6, s[16:19], s63 offen offset:1024
    s_waitcnt lgkmcnt(7)
    v_mfma_f32_16x16x32_bf16 v[120:123], a[148:151], a[80:83], v[120:123]
    ds_read_b128 a[132:135], v22 offset:25088
    v_mfma_f32_16x16x32_bf16 v[124:127], a[148:151], a[84:87], v[124:127]
    s_waitcnt vmcnt(31)
    s_waitcnt lgkmcnt(7)
    v_mfma_f32_16x16x32_bf16 v[80:83], a[152:155], a[88:91], v[80:83]
    ds_read_b128 a[136:139], v22 offset:57344
    v_mfma_f32_16x16x32_bf16 v[84:87], a[152:155], a[92:95], v[84:87]
    s_waitcnt lgkmcnt(7)
    v_mfma_f32_16x16x32_bf16 v[88:91], a[156:159], a[88:91], v[88:91]
    ds_read_b128 a[140:143], v22 offset:57856
    v_mfma_f32_16x16x32_bf16 v[92:95], a[156:159], a[92:95], v[92:95]
    s_add_u32 s63, s62, 81920
    buffer_load_dwordx4 v[224:227], v6, s[16:19], s63 offen
    s_waitcnt lgkmcnt(7)
    v_mfma_f32_16x16x32_bf16 v[96:99], a[160:163], a[88:91], v[96:99]
    ds_read_b128 a[144:147], v23 offset:24576
    v_mfma_f32_16x16x32_bf16 v[100:103], a[160:163], a[92:95], v[100:103]
    s_waitcnt lgkmcnt(7)
    v_mfma_f32_16x16x32_bf16 v[104:107], a[164:167], a[88:91], v[104:107]
    ds_read_b128 a[148:151], v23 offset:25088
    v_mfma_f32_16x16x32_bf16 v[108:111], a[164:167], a[92:95], v[108:111]
    s_waitcnt lgkmcnt(7)
    v_mfma_f32_16x16x32_bf16 v[112:115], a[168:171], a[88:91], v[112:115]
    ds_read_b128 a[152:155], v22 offset:26624
    v_mfma_f32_16x16x32_bf16 v[116:119], a[168:171], a[92:95], v[116:119]
    buffer_load_dwordx4 v[228:231], v6, s[16:19], s63 offen offset:1024
    s_waitcnt lgkmcnt(7)
    v_mfma_f32_16x16x32_bf16 v[120:123], a[172:175], a[88:91], v[120:123]
    ds_read_b128 a[156:159], v22 offset:27136
    v_mfma_f32_16x16x32_bf16 v[124:127], a[172:175], a[92:95], v[124:127]
    s_waitcnt vmcnt(8)
    s_add_u32 s50, s49, 0
    buffer_load_dword v5, v3, s[12:15], s50 offen
    s_add_u32 s51, s54, 0
    v_mov_b32 v4, 1
    s_mov_b64 exec, 1
    buffer_atomic_add v4, off, s[16:19], s51 sc1
    s_mov_b64 exec, -1
    s_waitcnt vmcnt(33)
    s_waitcnt lgkmcnt(7)
    v_mfma_f32_16x16x32_bf16 v[80:83], a[128:131], a[96:99], v[80:83]
    ds_read_b128 a[160:163], v22 offset:59392
    v_mfma_f32_16x16x32_bf16 v[84:87], a[128:131], a[100:103], v[84:87]
    s_waitcnt lgkmcnt(7)
    v_mfma_f32_16x16x32_bf16 v[88:91], a[132:135], a[96:99], v[88:91]
    ds_read_b128 a[164:167], v22 offset:59904
    v_mfma_f32_16x16x32_bf16 v[92:95], a[132:135], a[100:103], v[92:95]
    s_add_u32 s63, s62, 90112
    buffer_load_dwordx4 v[232:235], v6, s[16:19], s63 offen
    s_waitcnt lgkmcnt(7)
    v_mfma_f32_16x16x32_bf16 v[96:99], a[136:139], a[96:99], v[96:99]
    ds_read_b128 a[168:171], v23 offset:26624
    v_mfma_f32_16x16x32_bf16 v[100:103], a[136:139], a[100:103], v[100:103]
    s_waitcnt lgkmcnt(7)
    v_mfma_f32_16x16x32_bf16 v[104:107], a[140:143], a[96:99], v[104:107]
    ds_read_b128 a[172:175], v23 offset:27136
    v_mfma_f32_16x16x32_bf16 v[108:111], a[140:143], a[100:103], v[108:111]
    s_waitcnt lgkmcnt(7)
    v_mfma_f32_16x16x32_bf16 v[112:115], a[144:147], a[96:99], v[112:115]
    ds_read_b128 a[128:131], v22 offset:28672
    v_mfma_f32_16x16x32_bf16 v[116:119], a[144:147], a[100:103], v[116:119]
    buffer_load_dwordx4 v[236:239], v6, s[16:19], s63 offen offset:1024
    s_waitcnt lgkmcnt(7)
    v_mfma_f32_16x16x32_bf16 v[120:123], a[148:151], a[96:99], v[120:123]
    ds_read_b128 a[132:135], v22 offset:29184
    v_mfma_f32_16x16x32_bf16 v[124:127], a[148:151], a[100:103], v[124:127]
    s_waitcnt vmcnt(31)
    s_waitcnt lgkmcnt(7)
    v_mfma_f32_16x16x32_bf16 v[80:83], a[152:155], a[104:107], v[80:83]
    ds_read_b128 a[136:139], v22 offset:61440
    v_mfma_f32_16x16x32_bf16 v[84:87], a[152:155], a[108:111], v[84:87]
    s_waitcnt lgkmcnt(7)
    v_mfma_f32_16x16x32_bf16 v[88:91], a[156:159], a[104:107], v[88:91]
    ds_read_b128 a[140:143], v22 offset:61952
    v_mfma_f32_16x16x32_bf16 v[92:95], a[156:159], a[108:111], v[92:95]
    s_add_u32 s63, s62, 98304
    buffer_load_dwordx4 v[240:243], v6, s[16:19], s63 offen
    s_waitcnt lgkmcnt(7)
    v_mfma_f32_16x16x32_bf16 v[96:99], a[160:163], a[104:107], v[96:99]
    ds_read_b128 a[144:147], v23 offset:28672
    v_mfma_f32_16x16x32_bf16 v[100:103], a[160:163], a[108:111], v[100:103]
    s_waitcnt lgkmcnt(7)
    v_mfma_f32_16x16x32_bf16 v[104:107], a[164:167], a[104:107], v[104:107]
    ds_read_b128 a[148:151], v23 offset:29184
    v_mfma_f32_16x16x32_bf16 v[108:111], a[164:167], a[108:111], v[108:111]
    s_waitcnt lgkmcnt(7)
    v_mfma_f32_16x16x32_bf16 v[112:115], a[168:171], a[104:107], v[112:115]
    ds_read_b128 a[152:155], v22 offset:30720
    v_mfma_f32_16x16x32_bf16 v[116:119], a[168:171], a[108:111], v[116:119]
    buffer_load_dwordx4 v[244:247], v6, s[16:19], s63 offen offset:1024
    s_waitcnt lgkmcnt(7)
    v_mfma_f32_16x16x32_bf16 v[120:123], a[172:175], a[104:107], v[120:123]
    ds_read_b128 a[156:159], v22 offset:31232
    v_mfma_f32_16x16x32_bf16 v[124:127], a[172:175], a[108:111], v[124:127]
    s_waitcnt vmcnt(29)
    s_waitcnt lgkmcnt(7)
    v_mfma_f32_16x16x32_bf16 v[80:83], a[128:131], a[112:115], v[80:83]
    ds_read_b128 a[160:163], v22 offset:63488
    v_mfma_f32_16x16x32_bf16 v[84:87], a[128:131], a[116:119], v[84:87]
    s_waitcnt lgkmcnt(7)
    v_mfma_f32_16x16x32_bf16 v[88:91], a[132:135], a[112:115], v[88:91]
    ds_read_b128 a[164:167], v22 offset:64000
    v_mfma_f32_16x16x32_bf16 v[92:95], a[132:135], a[116:119], v[92:95]
    s_add_u32 s63, s62, 106496
    buffer_load_dwordx4 v[248:251], v6, s[16:19], s63 offen
    s_waitcnt lgkmcnt(7)
    v_mfma_f32_16x16x32_bf16 v[96:99], a[136:139], a[112:115], v[96:99]
    ds_read_b128 a[168:171], v23 offset:30720
    v_mfma_f32_16x16x32_bf16 v[100:103], a[136:139], a[116:119], v[100:103]
    s_waitcnt lgkmcnt(7)
    v_mfma_f32_16x16x32_bf16 v[104:107], a[140:143], a[112:115], v[104:107]
    ds_read_b128 a[172:175], v23 offset:31232
    v_mfma_f32_16x16x32_bf16 v[108:111], a[140:143], a[116:119], v[108:111]
    s_waitcnt lgkmcnt(7)
    v_mfma_f32_16x16x32_bf16 v[112:115], a[144:147], a[112:115], v[112:115]
    v_mfma_f32_16x16x32_bf16 v[116:119], a[144:147], a[116:119], v[116:119]
    buffer_load_dwordx4 v[252:255], v6, s[16:19], s63 offen offset:1024
    s_waitcnt lgkmcnt(6)
    v_mfma_f32_16x16x32_bf16 v[120:123], a[148:151], a[112:115], v[120:123]
    v_mfma_f32_16x16x32_bf16 v[124:127], a[148:151], a[116:119], v[124:127]
    s_waitcnt vmcnt(26)
    s_waitcnt lgkmcnt(5)
    v_mfma_f32_16x16x32_bf16 v[80:83], a[152:155], a[120:123], v[80:83]
    v_mfma_f32_16x16x32_bf16 v[84:87], a[152:155], a[124:127], v[84:87]
    s_waitcnt lgkmcnt(4)
    v_mfma_f32_16x16x32_bf16 v[88:91], a[156:159], a[120:123], v[88:91]
    v_mfma_f32_16x16x32_bf16 v[92:95], a[156:159], a[124:127], v[92:95]
    s_waitcnt lgkmcnt(3)
    v_mfma_f32_16x16x32_bf16 v[96:99], a[160:163], a[120:123], v[96:99]
    v_mfma_f32_16x16x32_bf16 v[100:103], a[160:163], a[124:127], v[100:103]
    s_waitcnt lgkmcnt(2)
    v_mfma_f32_16x16x32_bf16 v[104:107], a[164:167], a[120:123], v[104:107]
    v_mfma_f32_16x16x32_bf16 v[108:111], a[164:167], a[124:127], v[108:111]
    s_waitcnt lgkmcnt(1)
    v_mfma_f32_16x16x32_bf16 v[112:115], a[168:171], a[120:123], v[112:115]
    v_mfma_f32_16x16x32_bf16 v[116:119], a[168:171], a[124:127], v[116:119]
    s_waitcnt lgkmcnt(0)
    v_mfma_f32_16x16x32_bf16 v[120:123], a[172:175], a[120:123], v[120:123]
    v_mfma_f32_16x16x32_bf16 v[124:127], a[172:175], a[124:127], v[124:127]
    s_mov_b64 exec, 1
    v_mov_b32 v22, 0
    buffer_atomic_add v22, off, s[16:19], s68 sc0 sc1
    s_mov_b64 exec, -1
    s_nop 7
    v_pk_mul_f32 v[8:9], v[80:81], v[80:81]
    v_pk_mul_f32 v[10:11], v[82:83], v[82:83]
    v_pk_mul_f32 v[12:13], v[84:85], v[84:85]
    v_pk_mul_f32 v[14:15], v[86:87], v[86:87]
    v_pk_fma_f32 v[8:9], v[8:9], v[16:17], v[18:19]
    v_pk_fma_f32 v[10:11], v[10:11], v[16:17], v[18:19]
    v_pk_fma_f32 v[12:13], v[12:13], v[16:17], v[18:19]
    v_pk_fma_f32 v[14:15], v[14:15], v[16:17], v[18:19]
    v_pk_mul_f32 v[8:9], v[8:9], v[80:81]
    v_pk_mul_f32 v[10:11], v[10:11], v[82:83]
    v_pk_mul_f32 v[12:13], v[12:13], v[84:85]
    v_pk_mul_f32 v[14:15], v[14:15], v[86:87]
    v_exp_f32 v8, v8
    v_exp_f32 v9, v9
    v_exp_f32 v10, v10
    v_exp_f32 v11, v11
    v_exp_f32 v12, v12
    v_exp_f32 v13, v13
    v_exp_f32 v14, v14
    v_exp_f32 v15, v15
    v_pk_mul_f32 v[80:81], v[80:81], v[88:89]
    v_pk_mul_f32 v[82:83], v[82:83], v[90:91]
    v_pk_mul_f32 v[84:85], v[84:85], v[92:93]
    v_pk_mul_f32 v[86:87], v[86:87], v[94:95]
    v_pk_add_f32 v[8:9], v[8:9], v[20:21]
    v_pk_add_f32 v[10:11], v[10:11], v[20:21]
    v_pk_add_f32 v[12:13], v[12:13], v[20:21]
    v_pk_add_f32 v[14:15], v[14:15], v[20:21]
    v_rcp_f32 v8, v8
    v_rcp_f32 v9, v9
    v_rcp_f32 v10, v10
    v_rcp_f32 v11, v11
    v_rcp_f32 v12, v12
    v_rcp_f32 v13, v13
    v_rcp_f32 v14, v14
    v_rcp_f32 v15, v15
    s_nop 0
    v_pk_mul_f32 v[80:81], v[80:81], v[8:9]
    v_pk_mul_f32 v[82:83], v[82:83], v[10:11]
    v_pk_mul_f32 v[84:85], v[84:85], v[12:13]
    v_pk_mul_f32 v[86:87], v[86:87], v[14:15]
    v_cvt_pk_bf16_f32 v88, v80, v81
    v_cvt_pk_bf16_f32 v89, v82, v83
    v_cvt_pk_bf16_f32 v90, v84, v85
    v_cvt_pk_bf16_f32 v91, v86, v87
    s_nop 1
    v_permlane16_swap_b32 v88, v90
    v_permlane16_swap_b32 v89, v91
    s_add_u32 s50, s49, 352256
    buffer_store_dwordx4 v[88:91], v6, s[12:15], s50 offen offset:0 sc1
    v_pk_mul_f32 v[8:9], v[96:97], v[96:97]
    v_pk_mul_f32 v[10:11], v[98:99], v[98:99]
    v_pk_mul_f32 v[12:13], v[100:101], v[100:101]
    v_pk_mul_f32 v[14:15], v[102:103], v[102:103]
    v_pk_fma_f32 v[8:9], v[8:9], v[16:17], v[18:19]
    v_pk_fma_f32 v[10:11], v[10:11], v[16:17], v[18:19]
    v_pk_fma_f32 v[12:13], v[12:13], v[16:17], v[18:19]
    v_pk_fma_f32 v[14:15], v[14:15], v[16:17], v[18:19]
    v_pk_mul_f32 v[8:9], v[8:9], v[96:97]
    v_pk_mul_f32 v[10:11], v[10:11], v[98:99]
    v_pk_mul_f32 v[12:13], v[12:13], v[100:101]
    v_pk_mul_f32 v[14:15], v[14:15], v[102:103]
    v_exp_f32 v8, v8
    v_exp_f32 v9, v9
    v_exp_f32 v10, v10
    v_exp_f32 v11, v11
    v_exp_f32 v12, v12
    v_exp_f32 v13, v13
    v_exp_f32 v14, v14
    v_exp_f32 v15, v15
    v_pk_mul_f32 v[96:97], v[96:97], v[104:105]
    v_pk_mul_f32 v[98:99], v[98:99], v[106:107]
    v_pk_mul_f32 v[100:101], v[100:101], v[108:109]
    v_pk_mul_f32 v[102:103], v[102:103], v[110:111]
    v_pk_add_f32 v[8:9], v[8:9], v[20:21]
    v_pk_add_f32 v[10:11], v[10:11], v[20:21]
    v_pk_add_f32 v[12:13], v[12:13], v[20:21]
    v_pk_add_f32 v[14:15], v[14:15], v[20:21]
    v_rcp_f32 v8, v8
    v_rcp_f32 v9, v9
    v_rcp_f32 v10, v10
    v_rcp_f32 v11, v11
    v_rcp_f32 v12, v12
    v_rcp_f32 v13, v13
    v_rcp_f32 v14, v14
    v_rcp_f32 v15, v15
    s_nop 0
    v_pk_mul_f32 v[96:97], v[96:97], v[8:9]
    v_pk_mul_f32 v[98:99], v[98:99], v[10:11]
    v_pk_mul_f32 v[100:101], v[100:101], v[12:13]
    v_pk_mul_f32 v[102:103], v[102:103], v[14:15]
    v_cvt_pk_bf16_f32 v104, v96, v97
    v_cvt_pk_bf16_f32 v105, v98, v99
    v_cvt_pk_bf16_f32 v106, v100, v101
    v_cvt_pk_bf16_f32 v107, v102, v103
    s_nop 1
    v_permlane16_swap_b32 v104, v106
    v_permlane16_swap_b32 v105, v107
    s_add_u32 s50, s49, 352256
    buffer_store_dwordx4 v[104:107], v6, s[12:15], s50 offen offset:1024 sc1
    v_pk_mul_f32 v[8:9], v[112:113], v[112:113]
    v_pk_mul_f32 v[10:11], v[114:115], v[114:115]
    v_pk_mul_f32 v[12:13], v[116:117], v[116:117]
    v_pk_mul_f32 v[14:15], v[118:119], v[118:119]
    v_pk_fma_f32 v[8:9], v[8:9], v[16:17], v[18:19]
    v_pk_fma_f32 v[10:11], v[10:11], v[16:17], v[18:19]
    v_pk_fma_f32 v[12:13], v[12:13], v[16:17], v[18:19]
    v_pk_fma_f32 v[14:15], v[14:15], v[16:17], v[18:19]
    v_pk_mul_f32 v[8:9], v[8:9], v[112:113]
    v_pk_mul_f32 v[10:11], v[10:11], v[114:115]
    v_pk_mul_f32 v[12:13], v[12:13], v[116:117]
    v_pk_mul_f32 v[14:15], v[14:15], v[118:119]
    v_exp_f32 v8, v8
    v_exp_f32 v9, v9
    v_exp_f32 v10, v10
    v_exp_f32 v11, v11
    v_exp_f32 v12, v12
    v_exp_f32 v13, v13
    v_exp_f32 v14, v14
    v_exp_f32 v15, v15
    v_pk_mul_f32 v[112:113], v[112:113], v[120:121]
    v_pk_mul_f32 v[114:115], v[114:115], v[122:123]
    v_pk_mul_f32 v[116:117], v[116:117], v[124:125]
    v_pk_mul_f32 v[118:119], v[118:119], v[126:127]
    v_pk_add_f32 v[8:9], v[8:9], v[20:21]
    v_pk_add_f32 v[10:11], v[10:11], v[20:21]
    v_pk_add_f32 v[12:13], v[12:13], v[20:21]
    v_pk_add_f32 v[14:15], v[14:15], v[20:21]
    v_rcp_f32 v8, v8
    v_rcp_f32 v9, v9
    v_rcp_f32 v10, v10
    v_rcp_f32 v11, v11
    v_rcp_f32 v12, v12
    v_rcp_f32 v13, v13
    v_rcp_f32 v14, v14
    v_rcp_f32 v15, v15
    s_nop 0
    v_pk_mul_f32 v[112:113], v[112:113], v[8:9]
    v_pk_mul_f32 v[114:115], v[114:115], v[10:11]
    v_pk_mul_f32 v[116:117], v[116:117], v[12:13]
    v_pk_mul_f32 v[118:119], v[118:119], v[14:15]
    v_cvt_pk_bf16_f32 v120, v112, v113
    v_cvt_pk_bf16_f32 v121, v114, v115
    v_cvt_pk_bf16_f32 v122, v116, v117
    v_cvt_pk_bf16_f32 v123, v118, v119
    s_nop 1
    v_permlane16_swap_b32 v120, v122
    v_permlane16_swap_b32 v121, v123
    s_add_u32 s50, s49, 352256
    s_cmp_eq_u32 s5, 28
    s_cselect_b32 s50, 2130706432, s50
    buffer_store_dwordx4 v[120:123], v6, s[12:15], s50 offen offset:2048 sc1
    s_waitcnt vmcnt(3)
    v_readfirstlane_b32 s58, v22
    s_cmp_ge_u32 s58, 29
    s_cbranch_scc0 gu_late
    s_add_u32 s64, s61, 0
    buffer_load_dwordx4 a[0:3], v6, s[12:15], s64 offen
    s_add_u32 s64, s61, 4096
    buffer_load_dwordx4 a[4:7], v6, s[12:15], s64 offen
    s_add_u32 s64, s61, 8192
    buffer_load_dwordx4 a[8:11], v6, s[12:15], s64 offen
    s_add_u32 s64, s61, 12288
    buffer_load_dwordx4 a[12:15], v6, s[12:15], s64 offen
    s_add_u32 s64, s61, 16384
    buffer_load_dwordx4 a[16:19], v6, s[12:15], s64 offen
    s_add_u32 s64, s61, 20480
    buffer_load_dwordx4 a[20:23], v6, s[12:15], s64 offen
    s_add_u32 s64, s61, 24576
    buffer_load_dwordx4 a[24:27], v6, s[12:15], s64 offen
    s_add_u32 s64, s61, 28672
    buffer_load_dwordx4 a[28:31], v6, s[12:15], s64 offen
    s_add_u32 s64, s61, 32768
    buffer_load_dwordx4 a[32:35], v6, s[12:15], s64 offen
    v_lshrrev_b32 v24, 3, v0
    v_and_b32 v25, 7, v0
    s_lshl_b32 s63, s67, 5
    v_add_u32 v27, s63, v24
    v_lshlrev_b32 v27, 10, v27
    v_lshl_add_u32 v27, v25, 4, v27
    v_add_u32 v27, s60, v27
    v_mul_u32_u24 v24, 272, v24
    v_lshl_add_u32 v24, v25, 5, v24
    v_add_u32 v24, 0, v24
    v_and_b32 v25, 31, v1
    v_mul_u32_u24 v25, 272, v25
    v_lshrrev_b32 v26, 5, v1
    v_lshl_add_u32 v25, v26, 4, v25
    s_mul_i32 s63, s6, 8704
    s_add_u32 s63, s63, 0
    v_add_u32 v25, s63, v25
    s_waitcnt vmcnt(9)
    s_add_u32 s50, s49, 352256
    buffer_load_dword v5, v3, s[12:15], s50 offen
    s_add_u32 s51, s54, 1024
    v_mov_b32 v4, 1
    s_mov_b64 exec, 1
    buffer_atomic_add v4, off, s[16:19], s51 sc1
    s_mov_b64 exec, -1
    s_branch gu_done
gu_idle:
    v_lshlrev_b32 v6, 4, v1
    s_and_b32 s60, s5, 7
    s_mul_i32 s62, s60, 176128
    s_lshl_b32 s60, s60, 7
    s_lshl_b32 s63, s6, 11
    s_add_u32 s62, s62, s63
    s_add_u32 s62, s62, 33554432
    s_lshl_b32 s67, s4, 3
    s_lshr_b32 s63, s5, 3
    s_add_u32 s67, s67, s63
    s_mul_i32 s61, s67, 88064
    s_add_u32 s61, s61, 7340032
    s_lshl_b32 s63, s6, 10
    s_add_u32 s61, s61, s63
    s_lshl_b32 s68, s67, 8
    s_add_u32 s68, s68, s7
    s_add_u32 s68, s68, 8192
    s_add_u32 s63, s62, 0
    buffer_load_dwordx4 v[144:147], v6, s[16:19], s63 offen
    buffer_load_dwordx4 v[148:151], v6, s[16:19], s63 offen offset:1024
    s_add_u32 s63, s62, 8192
    buffer_load_dwordx4 v[152:155], v6, s[16:19], s63 offen
    buffer_load_dwordx4 v[156:159], v6, s[16:19], s63 offen offset:1024
    s_add_u32 s63, s62, 16384
    buffer_load_dwordx4 v[160:163], v6, s[16:19], s63 offen
    buffer_load_dwordx4 v[164:167], v6, s[16:19], s63 offen offset:1024
    s_add_u32 s63, s62, 24576
    buffer_load_dwordx4 v[168:171], v6, s[16:19], s63 offen
    buffer_load_dwordx4 v[172:175], v6, s[16:19], s63 offen offset:1024
    s_add_u32 s63, s62, 32768
    buffer_load_dwordx4 v[176:179], v6, s[16:19], s63 offen
    buffer_load_dwordx4 v[180:183], v6, s[16:19], s63 offen offset:1024
    s_add_u32 s63, s62, 40960
    buffer_load_dwordx4 v[184:187], v6, s[16:19], s63 offen
    buffer_load_dwordx4 v[188:191], v6, s[16:19], s63 offen offset:1024
    s_add_u32 s63, s62, 49152
    buffer_load_dwordx4 v[192:195], v6, s[16:19], s63 offen
    buffer_load_dwordx4 v[196:199], v6, s[16:19], s63 offen offset:1024
    s_add_u32 s63, s62, 57344
    buffer_load_dwordx4 v[200:203], v6, s[16:19], s63 offen
    buffer_load_dwordx4 v[204:207], v6, s[16:19], s63 offen offset:1024
    s_add_u32 s63, s62, 65536
    buffer_load_dwordx4 v[208:211], v6, s[16:19], s63 offen
    buffer_load_dwordx4 v[212:215], v6, s[16:19], s63 offen offset:1024
    s_add_u32 s63, s62, 73728
    buffer_load_dwordx4 v[216:219], v6, s[16:19], s63 offen
    buffer_load_dwordx4 v[220:223], v6, s[16:19], s63 offen offset:1024
    s_add_u32 s63, s62, 81920
    buffer_load_dwordx4 v[224:227], v6, s[16:19], s63 offen
    buffer_load_dwordx4 v[228:231], v6, s[16:19], s63 offen offset:1024
    s_add_u32 s63, s62, 90112
    buffer_load_dwordx4 v[232:235], v6, s[16:19], s63 offen
    buffer_load_dwordx4 v[236:239], v6, s[16:19], s63 offen offset:1024
    s_add_u32 s63, s62, 98304
    buffer_load_dwordx4 v[240:243], v6, s[16:19], s63 offen
    buffer_load_dwordx4 v[244:247], v6, s[16:19], s63 offen offset:1024
    s_add_u32 s63, s62, 106496
    buffer_load_dwordx4 v[248:251], v6, s[16:19], s63 offen
    buffer_load_dwordx4 v[252:255], v6, s[16:19], s63 offen offset:1024
    s_add_u32 s63, s62, 114688
    buffer_load_dwordx4 a[176:179], v6, s[16:19], s63 offen
    buffer_load_dwordx4 a[180:183], v6, s[16:19], s63 offen offset:1024
    s_add_u32 s63, s62, 122880
    buffer_load_dwordx4 a[184:187], v6, s[16:19], s63 offen
    buffer_load_dwordx4 a[188:191], v6, s[16:19], s63 offen offset:1024
    s_add_u32 s63, s62, 131072
    buffer_load_dwordx4 a[192:195], v6, s[16:19], s63 offen
    buffer_load_dwordx4 a[196:199], v6, s[16:19], s63 offen offset:1024
    s_add_u32 s63, s62, 139264
    buffer_load_dwordx4 a[200:203], v6, s[16:19], s63 offen
    buffer_load_dwordx4 a[204:207], v6, s[16:19], s63 offen offset:1024
    s_add_u32 s63, s62, 147456
    buffer_load_dwordx4 a[208:211], v6, s[16:19], s63 offen
    buffer_load_dwordx4 a[212:215], v6, s[16:19], s63 offen offset:1024
    s_add_u32 s63, s62, 155648
    buffer_load_dwordx4 a[216:219], v6, s[16:19], s63 offen
    buffer_load_dwordx4 a[220:223], v6, s[16:19], s63 offen offset:1024
    s_add_u32 s63, s62, 163840
    buffer_load_dwordx4 a[224:227], v6, s[16:19], s63 offen
    buffer_load_dwordx4 a[228:231], v6, s[16:19], s63 offen offset:1024
    s_add_u32 s63, s62, 172032
    buffer_load_dwordx4 a[232:235], v6, s[16:19], s63 offen
    buffer_load_dwordx4 a[236:239], v6, s[16:19], s63 offen offset:1024
    v_lshlrev_b32 v25, 7, v1
    s_sub_u32 s58, s5, 29
    s_lshl_b32 s58, s58, 2
    s_add_u32 s58, s58, s6
    s_lshl_b32 s58, s58, 13
    s_add_u32 s59, s58, 0
    buffer_load_dword v26, v25, s[24:27], s59 offen
    s_add_u32 s59, s58, 98304
    buffer_load_dword v26, v25, s[24:27], s59 offen
    s_add_u32 s59, s58, 196608
    buffer_load_dword v26, v25, s[24:27], s59 offen
    s_add_u32 s59, s58, 294912
    buffer_load_dword v26, v25, s[24:27], s59 offen
    s_add_u32 s59, s58, 393216
    buffer_load_dword v26, v25, s[24:27], s59 offen
    s_add_u32 s59, s58, 491520
    buffer_load_dword v26, v25, s[24:27], s59 offen
    s_cmp_lg_u32 s6, 0
    s_cbranch_scc1 w0_32
    v_lshlrev_b32 v22, 8, v1
    s_mov_b32 s66, 200000
    s_mov_b64 exec, 1
poll_33:
    v_mov_b32 v23, 0
    buffer_atomic_add v23, v22, s[16:19], s68 offen sc0 sc1
    s_sub_u32 s66, s66, 1
    s_cmp_eq_u32 s66, 0
    s_cbranch_scc1 pollout_34
    s_waitcnt vmcnt(0)
    v_cmp_gt_u32 vcc, 29, v23
    s_cbranch_vccz pollout_34
    s_sleep 16
    s_branch poll_33
pollout_34:
    s_mov_b64 exec, -1
w0_32:
    s_waitcnt vmcnt(0)
    s_barrier
    s_branch gu_late2
gu_late:
    s_waitcnt vmcnt(0)
    s_add_u32 s50, s49, 352256
    buffer_load_dword v5, v3, s[12:15], s50 offen
    s_add_u32 s51, s54, 1024
    v_mov_b32 v4, 1
    s_mov_b64 exec, 1
    buffer_atomic_add v4, off, s[16:19], s51 sc1
    s_mov_b64 exec, -1
    v_lshlrev_b32 v22, 8, v1
    s_mov_b32 s66, 200000
    s_mov_b64 exec, 1
poll_35:
    v_mov_b32 v23, 0
    buffer_atomic_add v23, v22, s[16:19], s68 offen sc0 sc1
    s_sub_u32 s66, s66, 1
    s_cmp_eq_u32 s66, 0
    s_cbranch_scc1 pollout_36
    s_waitcnt vmcnt(0)
    v_cmp_gt_u32 vcc, 29, v23
    s_cbranch_vccz pollout_36
    s_sleep 2
    s_branch poll_35
pollout_36:
    s_mov_b64 exec, -1
gu_late2:
    s_add_u32 s64, s61, 0
    buffer_load_dwordx4 a[0:3], v6, s[12:15], s64 offen
    s_add_u32 s64, s61, 4096
    buffer_load_dwordx4 a[4:7], v6, s[12:15], s64 offen
    s_add_u32 s64, s61, 8192
    buffer_load_dwordx4 a[8:11], v6, s[12:15], s64 offen
    s_add_u32 s64, s61, 12288
    buffer_load_dwordx4 a[12:15], v6, s[12:15], s64 offen
    s_add_u32 s64, s61, 16384
    buffer_load_dwordx4 a[16:19], v6, s[12:15], s64 offen
    s_add_u32 s64, s61, 20480
    buffer_load_dwordx4 a[20:23], v6, s[12:15], s64 offen
    s_add_u32 s64, s61, 24576
    buffer_load_dwordx4 a[24:27], v6, s[12:15], s64 offen
    s_add_u32 s64, s61, 28672
    buffer_load_dwordx4 a[28:31], v6, s[12:15], s64 offen
    s_add_u32 s64, s61, 32768
    buffer_load_dwordx4 a[32:35], v6, s[12:15], s64 offen
    v_lshrrev_b32 v24, 3, v0
    v_and_b32 v25, 7, v0
    s_lshl_b32 s63, s67, 5
    v_add_u32 v27, s63, v24
    v_lshlrev_b32 v27, 10, v27
    v_lshl_add_u32 v27, v25, 4, v27
    v_add_u32 v27, s60, v27
    v_mul_u32_u24 v24, 272, v24
    v_lshl_add_u32 v24, v25, 5, v24
    v_add_u32 v24, 0, v24
    v_and_b32 v25, 31, v1
    v_mul_u32_u24 v25, 272, v25
    v_lshrrev_b32 v26, 5, v1
    v_lshl_add_u32 v25, v26, 4, v25
    s_mul_i32 s63, s6, 8704
    s_add_u32 s63, s63, 0
    v_add_u32 v25, s63, v25
gu_done:
    s_waitcnt vmcnt(8)
    v_mfma_f32_32x32x16_bf16 v[32:47], v[144:147], a[0:3], 0
    s_add_u32 s64, s61, 36864
    buffer_load_dwordx4 a[36:39], v6, s[12:15], s64 offen
    v_mfma_f32_32x32x16_bf16 v[48:63], v[148:151], a[0:3], 0
    s_add_u32 s64, s61, 40960
    buffer_load_dwordx4 a[40:43], v6, s[12:15], s64 offen
    s_waitcnt vmcnt(9)
    v_mfma_f32_32x32x16_bf16 v[32:47], v[152:155], a[4:7], v[32:47]
    s_add_u32 s64, s61, 45056
    buffer_load_dwordx4 a[44:47], v6, s[12:15], s64 offen
    v_mfma_f32_32x32x16_bf16 v[48:63], v[156:159], a[4:7], v[48:63]
    s_add_u32 s64, s61, 49152
    buffer_load_dwordx4 a[48:51], v6, s[12:15], s64 offen
    s_waitcnt vmcnt(10)
    v_mfma_f32_32x32x16_bf16 v[32:47], v[160:163], a[8:11], v[32:47]
    s_add_u32 s64, s61, 53248
    buffer_load_dwordx4 a[52:55], v6, s[12:15], s64 offen
    v_mfma_f32_32x32x16_bf16 v[48:63], v[164:167], a[8:11], v[48:63]
    s_add_u32 s64, s61, 57344
    buffer_load_dwordx4 a[56:59], v6, s[12:15], s64 offen
    s_waitcnt vmcnt(11)
    v_mfma_f32_32x32x16_bf16 v[32:47], v[168:171], a[12:15], v[32:47]
    s_add_u32 s64, s61, 61440
    buffer_load_dwordx4 a[60:63], v6, s[12:15], s64 offen
    v_mfma_f32_32x32x16_bf16 v[48:63], v[172:175], a[12:15], v[48:63]
    s_add_u32 s64, s61, 65536
    buffer_load_dwordx4 a[64:67], v6, s[12:15], s64 offen
    s_waitcnt vmcnt(12)
    v_mfma_f32_32x32x16_bf16 v[32:47], v[176:179], a[16:19], v[32:47]
    s_add_u32 s64, s61, 69632
    buffer_load_dwordx4 a[68:71], v6, s[12:15], s64 offen
    v_mfma_f32_32x32x16_bf16 v[48:63], v[180:183], a[16:19], v[48:63]
    s_add_u32 s64, s61, 73728
    buffer_load_dwordx4 a[72:75], v6, s[12:15], s64 offen
    s_waitcnt vmcnt(13)
    v_mfma_f32_32x32x16_bf16 v[32:47], v[184:187], a[20:23], v[32:47]
    s_add_u32 s64, s61, 77824
    buffer_load_dwordx4 a[76:79], v6, s[12:15], s64 offen
    v_mfma_f32_32x32x16_bf16 v[48:63], v[188:191], a[20:23], v[48:63]
    s_add_u32 s64, s61, 81920
    buffer_load_dwordx4 a[80:83], v6, s[12:15], s64 offen
    s_waitcnt vmcnt(14)
    v_mfma_f32_32x32x16_bf16 v[32:47], v[192:195], a[24:27], v[32:47]
    s_add_u32 s64, s61, 86016
    buffer_load_dwordx4 a[84:87], v6, s[12:15], s64 offen
    v_mfma_f32_32x32x16_bf16 v[48:63], v[196:199], a[24:27], v[48:63]
    s_mov_b32 s64, 3145728
    buffer_load_dwordx4 v[28:31], v27, s[12:15], s64 offen
    s_waitcnt vmcnt(15)
    v_mfma_f32_32x32x16_bf16 v[32:47], v[200:203], a[28:31], v[32:47]
    s_mov_b32 s64, 3276800
    buffer_load_dwordx4 v[128:131], v27, s[12:15], s64 offen
    v_mfma_f32_32x32x16_bf16 v[48:63], v[204:207], a[28:31], v[48:63]
    s_waitcnt vmcnt(15)
    v_mfma_f32_32x32x16_bf16 v[32:47], v[208:211], a[32:35], v[32:47]
    v_mfma_f32_32x32x16_bf16 v[48:63], v[212:215], a[32:35], v[48:63]
    s_lshr_b32 s52, s5, 3
    s_lshl_b32 s48, s4, 2
    s_add_u32 s48, s48, s52
    s_and_b32 s49, s5, 7
    s_add_u32 s50, s48, s49
    s_and_b32 s50, s50, 3
    v_lshrrev_b32 v125, 4, v1
    v_lshrrev_b32 v123, 5, v1
    v_lshlrev_b32 v123, 3, v123
    v_bfe_u32 v124, v1, 3, 2
    v_add_u32 v123, v123, v124
    v_lshlrev_b32 v126, 10, v123
    v_lshrrev_b32 v123, 1, v1
    v_xor_b32 v123, v123, v125
    v_and_b32 v123, 3, v123
    v_lshl_add_u32 v126, v123, 5, v126
    v_and_b32 v125, 1, v1
    v_lshl_add_u32 v126, v125, 4, v126
    s_lshl_b32 s52, s49, 7
    s_lshl_b32 s53, s6, 15
    s_add_u32 s52, s52, s53
    v_add_u32 v126, s52, v126
    s_lshl_b32 s58, s6, 12
    v_lshlrev_b32 v124, 3, v124
    v_lshrrev_b32 v123, 5, v1
    v_lshl_add_u32 v124, v123, 2, v124
    v_bfe_u32 v123, v1, 1, 2
    v_add_u32 v124, v124, v123
    v_lshlrev_b32 v127, 5, v124
    v_lshl_add_u32 v127, v125, 4, v127
    s_lshl_b32 s52, s6, 10
    v_add_u32 v127, s52, v127
    s_add_u32 s57, s52, 135168
    s_waitcnt vmcnt(14)
    v_mfma_f32_32x32x16_bf16 v[32:47], v[216:219], a[36:39], v[32:47]
    v_mfma_f32_32x32x16_bf16 v[48:63], v[220:223], a[36:39], v[48:63]
    s_waitcnt vmcnt(13)
    v_mfma_f32_32x32x16_bf16 v[32:47], v[224:227], a[40:43], v[32:47]
    v_mfma_f32_32x32x16_bf16 v[48:63], v[228:231], a[40:43], v[48:63]
    s_waitcnt vmcnt(12)
    v_mfma_f32_32x32x16_bf16 v[32:47], v[232:235], a[44:47], v[32:47]
    v_mfma_f32_32x32x16_bf16 v[48:63], v[236:239], a[44:47], v[48:63]
    s_waitcnt vmcnt(11)
    v_mfma_f32_32x32x16_bf16 v[32:47], v[240:243], a[48:51], v[32:47]
    v_mfma_f32_32x32x16_bf16 v[48:63], v[244:247], a[48:51], v[48:63]
    s_waitcnt vmcnt(10)
    v_mfma_f32_32x32x16_bf16 v[32:47], v[248:251], a[52:55], v[32:47]
    v_mfma_f32_32x32x16_bf16 v[48:63], v[252:255], a[52:55], v[48:63]
    s_add_u32 s68, s68, 1024
    s_cmp_lg_u32 s6, 0
    s_cbranch_scc1 dn_nc_38
    s_mov_b64 exec, 1
    v_mov_b32 v22, 0
    buffer_atomic_add v22, off, s[16:19], s68 sc0 sc1
    s_mov_b64 exec, -1
dn_nc_38:
    s_waitcnt vmcnt(9)
    v_mfma_f32_32x32x16_bf16 v[32:47], a[176:179], a[56:59], v[32:47]
    v_mfma_f32_32x32x16_bf16 v[48:63], a[180:183], a[56:59], v[48:63]
    s_waitcnt vmcnt(8)
    v_mfma_f32_32x32x16_bf16 v[32:47], a[184:187], a[60:63], v[32:47]
    v_mfma_f32_32x32x16_bf16 v[48:63], a[188:191], a[60:63], v[48:63]
    s_waitcnt vmcnt(7)
    v_mfma_f32_32x32x16_bf16 v[32:47], a[192:195], a[64:67], v[32:47]
    v_mfma_f32_32x32x16_bf16 v[48:63], a[196:199], a[64:67], v[48:63]
    s_waitcnt vmcnt(6)
    v_mfma_f32_32x32x16_bf16 v[32:47], a[200:203], a[68:71], v[32:47]
    v_mfma_f32_32x32x16_bf16 v[48:63], a[204:207], a[68:71], v[48:63]
    s_waitcnt vmcnt(5)
    v_mfma_f32_32x32x16_bf16 v[32:47], a[208:211], a[72:75], v[32:47]
    v_mfma_f32_32x32x16_bf16 v[48:63], a[212:215], a[72:75], v[48:63]
    s_waitcnt vmcnt(4)
    s_cmp_lg_u32 s6, 0
    s_cbranch_scc1 dn_np_39
    s_waitcnt vmcnt(0)
    v_readfirstlane_b32 s65, v22
    s_cmp_ge_u32 s65, 29
    s_cbranch_scc1 dn_np_39
    v_lshlrev_b32 v22, 8, v1
    s_mov_b32 s66, 200000
    s_mov_b64 exec, 1
poll_40:
    v_mov_b32 v23, 0
    buffer_atomic_add v23, v22, s[16:19], s68 offen sc0 sc1
    s_sub_u32 s66, s66, 1
    s_cmp_eq_u32 s66, 0
    s_cbranch_scc1 pollout_41
    s_waitcnt vmcnt(0)
    v_cmp_gt_u32 vcc, 29, v23
    s_cbranch_vccz pollout_41
    s_sleep 1
    s_branch poll_40
pollout_41:
    s_mov_b64 exec, -1
dn_np_39:
    s_barrier
    s_add_u32 s64, s61, 352256
    buffer_load_dwordx4 a[88:91], v6, s[12:15], s64 offen
    s_add_u32 s64, s61, 356352
    buffer_load_dwordx4 a[92:95], v6, s[12:15], s64 offen
    s_add_u32 s64, s61, 360448
    buffer_load_dwordx4 a[96:99], v6, s[12:15], s64 offen
    s_add_u32 s64, s61, 364544
    buffer_load_dwordx4 a[100:103], v6, s[12:15], s64 offen
    v_mfma_f32_32x32x16_bf16 v[32:47], a[216:219], a[76:79], v[32:47]
    s_add_u32 s64, s61, 368640
    buffer_load_dwordx4 a[104:107], v6, s[12:15], s64 offen
    v_mfma_f32_32x32x16_bf16 v[48:63], a[220:223], a[76:79], v[48:63]
    s_add_u32 s64, s61, 372736
    buffer_load_dwordx4 a[108:111], v6, s[12:15], s64 offen
    s_waitcnt vmcnt(9)
    v_mfma_f32_32x32x16_bf16 v[32:47], a[224:227], a[80:83], v[32:47]
    s_add_u32 s64, s61, 376832
    buffer_load_dwordx4 a[112:115], v6, s[12:15], s64 offen
    v_mfma_f32_32x32x16_bf16 v[48:63], a[228:231], a[80:83], v[48:63]
    s_add_u32 s64, s61, 380928
    buffer_load_dwordx4 a[116:119], v6, s[12:15], s64 offen
    s_waitcnt vmcnt(10)
    s_cmp_ge_u32 s6, 2
    s_cbranch_scc1 down_skip_37
    v_mfma_f32_32x32x16_bf16 v[32:47], a[232:235], a[84:87], v[32:47]
    v_mfma_f32_32x32x16_bf16 v[48:63], a[236:239], a[84:87], v[48:63]
down_skip_37:
    s_waitcnt vmcnt(7)
    v_mfma_f32_32x32x16_bf16 v[64:79], v[144:147], a[88:91], 0
    s_add_u32 s64, s61, 385024
    buffer_load_dwordx4 a[120:123], v6, s[12:15], s64 offen
    v_mfma_f32_32x32x16_bf16 v[80:95], v[148:151], a[88:91], 0
    s_add_u32 s64, s61, 389120
    buffer_load_dwordx4 a[124:127], v6, s[12:15], s64 offen
    s_waitcnt vmcnt(8)
    v_mfma_f32_32x32x16_bf16 v[64:79], v[152:155], a[92:95], v[64:79]
    s_add_u32 s64, s61, 393216
    buffer_load_dwordx4 a[128:131], v6, s[12:15], s64 offen
    v_mfma_f32_32x32x16_bf16 v[80:95], v[156:159], a[92:95], v[80:95]
    s_add_u32 s64, s61, 397312
    buffer_load_dwordx4 a[132:135], v6, s[12:15], s64 offen
    s_waitcnt vmcnt(9)
    v_mfma_f32_32x32x16_bf16 v[64:79], v[160:163], a[96:99], v[64:79]
    s_add_u32 s64, s61, 401408
    buffer_load_dwordx4 a[136:139], v6, s[12:15], s64 offen
    ds_write_b128 v25, v[32:35] offset:0
    ds_write_b128 v25, v[36:39] offset:32
    v_mfma_f32_32x32x16_bf16 v[80:95], v[164:167], a[96:99], v[80:95]
    s_add_u32 s64, s61, 405504
    buffer_load_dwordx4 a[140:143], v6, s[12:15], s64 offen
    ds_write_b128 v25, v[40:43] offset:64
    ds_write_b128 v25, v[44:47] offset:96
    s_waitcnt vmcnt(10)
    v_mfma_f32_32x32x16_bf16 v[64:79], v[168:171], a[100:103], v[64:79]
    s_add_u32 s64, s61, 409600
    buffer_load_dwordx4 a[144:147], v6, s[12:15], s64 offen
    ds_write_b128 v25, v[48:51] offset:128
    ds_write_b128 v25, v[52:55] offset:160
    v_mfma_f32_32x32x16_bf16 v[80:95], v[172:175], a[100:103], v[80:95]
    s_add_u32 s64, s61, 413696
    buffer_load_dwordx4 a[148:151], v6, s[12:15], s64 offen
    ds_write_b128 v25, v[56:59] offset:192
    ds_write_b128 v25, v[60:63] offset:224
    s_waitcnt vmcnt(11)
    v_mfma_f32_32x32x16_bf16 v[64:79], v[176:179], a[104:107], v[64:79]
    s_add_u32 s64, s61, 417792
    buffer_load_dwordx4 a[152:155], v6, s[12:15], s64 offen
    v_lshlrev_b32 v8, 16, v28
    v_and_b32 v9, 0xffff0000, v28
    v_mfma_f32_32x32x16_bf16 v[80:95], v[180:183], a[104:107], v[80:95]
    s_add_u32 s64, s61, 421888
    buffer_load_dwordx4 a[156:159], v6, s[12:15], s64 offen
    v_lshlrev_b32 v10, 16, v29
    v_and_b32 v11, 0xffff0000, v29
    s_waitcnt vmcnt(12)
    v_mfma_f32_32x32x16_bf16 v[64:79], v[184:187], a[108:111], v[64:79]
    s_add_u32 s64, s61, 425984
    buffer_load_dwordx4 a[160:163], v6, s[12:15], s64 offen
    v_lshlrev_b32 v12, 16, v30
    v_and_b32 v13, 0xffff0000, v30
    v_mfma_f32_32x32x16_bf16 v[80:95], v[188:191], a[108:111], v[80:95]
    s_add_u32 s64, s61, 430080
    buffer_load_dwordx4 a[164:167], v6, s[12:15], s64 offen
    v_lshlrev_b32 v14, 16, v31
    v_and_b32 v15, 0xffff0000, v31
    s_waitcnt vmcnt(13)
    v_mfma_f32_32x32x16_bf16 v[64:79], v[192:195], a[112:115], v[64:79]
    s_add_u32 s64, s61, 434176
    buffer_load_dwordx4 a[168:171], v6, s[12:15], s64 offen
    s_waitcnt lgkmcnt(0)
    s_barrier
    v_mfma_f32_32x32x16_bf16 v[80:95], v[196:199], a[112:115], v[80:95]
    s_add_u32 s64, s61, 438272
    buffer_load_dwordx4 a[172:175], v6, s[12:15], s64 offen
    ds_read_b128 v[32:35], v24 offset:0
    ds_read_b128 v[36:39], v24 offset:16
    s_waitcnt vmcnt(14)
    v_mfma_f32_32x32x16_bf16 v[64:79], v[200:203], a[116:119], v[64:79]
    ds_read_b128 v[40:43], v24 offset:8704
    ds_read_b128 v[44:47], v24 offset:8720
    v_mfma_f32_32x32x16_bf16 v[80:95], v[204:207], a[116:119], v[80:95]
    ds_read_b128 v[48:51], v24 offset:17408
    ds_read_b128 v[52:55], v24 offset:17424
    s_waitcnt vmcnt(13)
    v_mfma_f32_32x32x16_bf16 v[64:79], v[208:211], a[120:123], v[64:79]
    ds_read_b128 v[56:59], v24 offset:26112
    ds_read_b128 v[60:63], v24 offset:26128
    v_mfma_f32_32x32x16_bf16 v[80:95], v[212:215], a[120:123], v[80:95]
    v_lshlrev_b32 v16, 16, v128
    v_and_b32 v17, 0xffff0000, v128
    s_waitcnt vmcnt(12)
    v_mfma_f32_32x32x16_bf16 v[64:79], v[216:219], a[124:127], v[64:79]
    v_lshlrev_b32 v18, 16, v129
    v_and_b32 v19, 0xffff0000, v129
    v_mfma_f32_32x32x16_bf16 v[80:95], v[220:223], a[124:127], v[80:95]
    v_lshlrev_b32 v20, 16, v130
    v_and_b32 v21, 0xffff0000, v130
    s_waitcnt vmcnt(11)
    v_mfma_f32_32x32x16_bf16 v[64:79], v[224:227], a[128:131], v[64:79]
    v_lshlrev_b32 v22, 16, v131
    v_and_b32 v23, 0xffff0000, v131
    v_mfma_f32_32x32x16_bf16 v[80:95], v[228:231], a[128:131], v[80:95]
    s_waitcnt lgkmcnt(0)
    v_pk_add_f32 v[8:9], v[8:9], v[32:33]
    s_waitcnt vmcnt(10)
    v_mfma_f32_32x32x16_bf16 v[64:79], v[232:235], a[132:135], v[64:79]
    v_pk_add_f32 v[10:11], v[10:11], v[34:35]
    v_pk_add_f32 v[12:13], v[12:13], v[36:37]
    v_mfma_f32_32x32x16_bf16 v[80:95], v[236:239], a[132:135], v[80:95]
    v_pk_add_f32 v[14:15], v[14:15], v[38:39]
    v_pk_add_f32 v[8:9], v[8:9], v[40:41]
    s_waitcnt vmcnt(9)
    v_mfma_f32_32x32x16_bf16 v[64:79], v[240:243], a[136:139], v[64:79]
    v_pk_add_f32 v[10:11], v[10:11], v[42:43]
    v_pk_add_f32 v[12:13], v[12:13], v[44:45]
    v_mfma_f32_32x32x16_bf16 v[80:95], v[244:247], a[136:139], v[80:95]
    v_pk_add_f32 v[14:15], v[14:15], v[46:47]
    v_pk_add_f32 v[48:49], v[48:49], v[56:57]
    s_waitcnt vmcnt(8)
    v_mfma_f32_32x32x16_bf16 v[64:79], v[248:251], a[140:143], v[64:79]
    v_pk_add_f32 v[50:51], v[50:51], v[58:59]
    v_pk_add_f32 v[52:53], v[52:53], v[60:61]
    v_mfma_f32_32x32x16_bf16 v[80:95], v[252:255], a[140:143], v[80:95]
    v_pk_add_f32 v[54:55], v[54:55], v[62:63]
    v_pk_add_f32 v[8:9], v[8:9], v[48:49]
    s_waitcnt vmcnt(7)
    v_mfma_f32_32x32x16_bf16 v[64:79], a[176:179], a[144:147], v[64:79]
    v_pk_add_f32 v[10:11], v[10:11], v[50:51]
    v_pk_add_f32 v[12:13], v[12:13], v[52:53]
    v_mfma_f32_32x32x16_bf16 v[80:95], a[180:183], a[144:147], v[80:95]
    v_pk_add_f32 v[14:15], v[14:15], v[54:55]
    v_cvt_pk_bf16_f32 v96, v8, v9
    s_waitcnt vmcnt(6)
    v_mfma_f32_32x32x16_bf16 v[64:79], a[184:187], a[148:151], v[64:79]
    v_cvt_pk_bf16_f32 v97, v10, v11
    v_cvt_pk_bf16_f32 v98, v12, v13
    v_mfma_f32_32x32x16_bf16 v[80:95], a[188:191], a[148:151], v[80:95]
    v_cvt_pk_bf16_f32 v99, v14, v15
    s_mov_b32 s64, 0
    buffer_store_dwordx4 v[96:99], v27, s[20:23], s64 offen sc1
    s_waitcnt vmcnt(6)
    v_mfma_f32_32x32x16_bf16 v[64:79], a[192:195], a[152:155], v[64:79]
    v_mfma_f32_32x32x16_bf16 v[80:95], a[196:199], a[152:155], v[80:95]
    s_waitcnt vmcnt(5)
    v_mfma_f32_32x32x16_bf16 v[64:79], a[200:203], a[156:159], v[64:79]
    v_mfma_f32_32x32x16_bf16 v[80:95], a[204:207], a[156:159], v[80:95]
    s_waitcnt vmcnt(4)
    v_mfma_f32_32x32x16_bf16 v[64:79], a[208:211], a[160:163], v[64:79]
    v_mfma_f32_32x32x16_bf16 v[80:95], a[212:215], a[160:163], v[80:95]
    s_waitcnt vmcnt(3)
    v_mfma_f32_32x32x16_bf16 v[64:79], a[216:219], a[164:167], v[64:79]
    v_mfma_f32_32x32x16_bf16 v[80:95], a[220:223], a[164:167], v[80:95]
    s_waitcnt vmcnt(2)
    v_mfma_f32_32x32x16_bf16 v[64:79], a[224:227], a[168:171], v[64:79]
    v_mfma_f32_32x32x16_bf16 v[80:95], a[228:231], a[168:171], v[80:95]
    s_waitcnt vmcnt(1)
    s_cmp_ge_u32 s6, 2
    s_cbranch_scc1 down_skip_42
    v_mfma_f32_32x32x16_bf16 v[64:79], a[232:235], a[172:175], v[64:79]
    v_mfma_f32_32x32x16_bf16 v[80:95], a[236:239], a[172:175], v[80:95]
down_skip_42:
    s_nop 7
    s_nop 3
    ds_write_b128 v25, v[64:67] offset:34816
    ds_write_b128 v25, v[68:71] offset:34848
    ds_write_b128 v25, v[72:75] offset:34880
    ds_write_b128 v25, v[76:79] offset:34912
    ds_write_b128 v25, v[80:83] offset:34944
    ds_write_b128 v25, v[84:87] offset:34976
    ds_write_b128 v25, v[88:91] offset:35008
    ds_write_b128 v25, v[92:95] offset:35040
    s_waitcnt lgkmcnt(0)
    s_barrier
    ds_read_b128 v[64:67], v24 offset:34816
    ds_read_b128 v[68:71], v24 offset:34832
    ds_read_b128 v[72:75], v24 offset:43520
    ds_read_b128 v[76:79], v24 offset:43536
    ds_read_b128 v[80:83], v24 offset:52224
    ds_read_b128 v[84:87], v24 offset:52240
    ds_read_b128 v[88:91], v24 offset:60928
    ds_read_b128 v[92:95], v24 offset:60944
    s_waitcnt lgkmcnt(4)
    v_pk_add_f32 v[16:17], v[16:17], v[64:65]
    v_pk_add_f32 v[18:19], v[18:19], v[66:67]
    v_pk_add_f32 v[20:21], v[20:21], v[68:69]
    v_pk_add_f32 v[22:23], v[22:23], v[70:71]
    v_pk_add_f32 v[16:17], v[16:17], v[72:73]
    v_pk_add_f32 v[18:19], v[18:19], v[74:75]
    v_pk_add_f32 v[20:21], v[20:21], v[76:77]
    v_pk_add_f32 v[22:23], v[22:23], v[78:79]
    s_waitcnt lgkmcnt(0)
    v_pk_add_f32 v[80:81], v[80:81], v[88:89]
    v_pk_add_f32 v[82:83], v[82:83], v[90:91]
    v_pk_add_f32 v[84:85], v[84:85], v[92:93]
    v_pk_add_f32 v[86:87], v[86:87], v[94:95]
    v_pk_add_f32 v[16:17], v[16:17], v[80:81]
    v_pk_add_f32 v[18:19], v[18:19], v[82:83]
    v_pk_add_f32 v[20:21], v[20:21], v[84:85]
    v_pk_add_f32 v[22:23], v[22:23], v[86:87]
    v_cvt_pk_bf16_f32 v100, v16, v17
    v_cvt_pk_bf16_f32 v101, v18, v19
    v_cvt_pk_bf16_f32 v102, v20, v21
    v_cvt_pk_bf16_f32 v103, v22, v23
    s_mov_b32 s64, 131072
    buffer_store_dwordx4 v[100:103], v27, s[20:23], s64 offen sc1
    s_cmp_lg_u32 s3, 0
    s_cbranch_scc1 k_done
    v_mov_b32 v108, 0x3f803f80
    v_mov_b32 v104, 0
    v_mov_b32 v105, 0
    v_mov_b32 v106, 0
    v_mov_b32 v107, 0
    v_dot2c_f32_bf16 v104, v96, v108
    v_dot2c_f32_bf16 v105, v96, v96
    v_dot2c_f32_bf16 v106, v100, v108
    v_dot2c_f32_bf16 v107, v100, v100
    v_dot2c_f32_bf16 v104, v97, v108
    v_dot2c_f32_bf16 v105, v97, v97
    v_dot2c_f32_bf16 v106, v101, v108
    v_dot2c_f32_bf16 v107, v101, v101
    v_dot2c_f32_bf16 v104, v98, v108
    v_dot2c_f32_bf16 v105, v98, v98
    v_dot2c_f32_bf16 v106, v102, v108
    v_dot2c_f32_bf16 v107, v102, v102
    v_dot2c_f32_bf16 v104, v99, v108
    v_dot2c_f32_bf16 v105, v99, v99
    v_dot2c_f32_bf16 v106, v103, v108
    v_dot2c_f32_bf16 v107, v103, v103
    s_lshl_b32 s64, s67, 11
    s_lshl_b32 s65, s60, 1
    s_add_u32 s64, s64, s65
    s_add_u32 s64, s64, 16384000
    s_add_u32 s65, s64, 8192
    v_add_f32_dpp v104, v104, v104 quad_perm:[1,0,3,2] row_mask:0xf bank_mask:0xf
    v_add_f32_dpp v105, v105, v105 quad_perm:[1,0,3,2] row_mask:0xf bank_mask:0xf
    v_add_f32_dpp v106, v106, v106 quad_perm:[1,0,3,2] row_mask:0xf bank_mask:0xf
    v_add_f32_dpp v107, v107, v107 quad_perm:[1,0,3,2] row_mask:0xf bank_mask:0xf
    v_add_f32_dpp v104, v104, v104 quad_perm:[2,3,0,1] row_mask:0xf bank_mask:0xf
    v_add_f32_dpp v105, v105, v105 quad_perm:[2,3,0,1] row_mask:0xf bank_mask:0xf
    v_add_f32_dpp v106, v106, v106 quad_perm:[2,3,0,1] row_mask:0xf bank_mask:0xf
    v_add_f32_dpp v107, v107, v107 quad_perm:[2,3,0,1] row_mask:0xf bank_mask:0xf
    v_add_f32_dpp v104, v104, v104 row_half_mirror row_mask:0xf bank_mask:0xf
    v_add_f32_dpp v105, v105, v105 row_half_mirror row_mask:0xf bank_mask:0xf
    v_add_f32_dpp v106, v106, v106 row_half_mirror row_mask:0xf bank_mask:0xf
    v_add_f32_dpp v107, v107, v107 row_half_mirror row_mask:0xf bank_mask:0xf
    s_mov_b32 exec_lo, 0x01010101
    s_mov_b32 exec_hi, 0x01010101
    buffer_store_dwordx2 v[104:105], v0, s[16:19], s64 offen sc1
    buffer_store_dwordx2 v[106:107], v0, s[16:19], s65 offen sc1
    s_mov_b64 exec, -1
    s_add_u32 s52, s50, 0
    s_and_b32 s52, s52, 3
    s_lshl_b32 s53, s52, 17
    s_add_u32 m0, s58, 69632
    s_add_u32 s55, s53, 0
    buffer_load_dwordx4 v126, s[24:27], s55 offen lds
    s_add_u32 m0, s58, 70656
    s_add_u32 s55, s53, 16384
    buffer_load_dwordx4 v126, s[24:27], s55 offen lds
    s_add_u32 m0, s58, 71680
    s_add_u32 s55, s53, 4096
    buffer_load_dwordx4 v126, s[24:27], s55 offen lds
    s_add_u32 m0, s58, 72704
    s_add_u32 s55, s53, 20480
    buffer_load_dwordx4 v126, s[24:27], s55 offen lds
    s_add_u32 m0, s57, 0
    s_lshl_b32 s55, s52, 12
    buffer_load_dwordx4 v127, s[28:31], s55 offen lds
    s_add_u32 s52, s50, 1
    s_and_b32 s52, s52, 3
    s_lshl_b32 s53, s52, 17
    s_add_u32 m0, s58, 86016
    s_add_u32 s55, s53, 0
    buffer_load_dwordx4 v126, s[24:27], s55 offen lds
    s_add_u32 m0, s58, 87040
    s_add_u32 s55, s53, 16384
    buffer_load_dwordx4 v126, s[24:27], s55 offen lds
    s_add_u32 m0, s58, 88064
    s_add_u32 s55, s53, 4096
    buffer_load_dwordx4 v126, s[24:27], s55 offen lds
    s_add_u32 m0, s58, 89088
    s_add_u32 s55, s53, 20480
    buffer_load_dwordx4 v126, s[24:27], s55 offen lds
    s_add_u32 m0, s57, 4096
    s_lshl_b32 s55, s52, 12
    buffer_load_dwordx4 v127, s[28:31], s55 offen lds
    s_add_u32 s52, s50, 2
    s_and_b32 s52, s52, 3
    s_lshl_b32 s53, s52, 17
    s_add_u32 m0, s58, 102400
    s_add_u32 s55, s53, 0
    buffer_load_dwordx4 v126, s[24:27], s55 offen lds
    s_add_u32 m0, s58, 103424
    s_add_u32 s55, s53, 16384
    buffer_load_dwordx4 v126, s[24:27], s55 offen lds
    s_add_u32 m0, s58, 104448
    s_add_u32 s55, s53, 4096
    buffer_load_dwordx4 v126, s[24:27], s55 offen lds
    s_add_u32 m0, s58, 105472
    s_add_u32 s55, s53, 20480
    buffer_load_dwordx4 v126, s[24:27], s55 offen lds
    s_add_u32 m0, s57, 8192
    s_lshl_b32 s55, s52, 12
    buffer_load_dwordx4 v127, s[28:31], s55 offen lds
    s_waitcnt vmcnt(15)
    s_barrier
    s_cmp_lg_u32 s6, 0
    s_cbranch_scc1 w0_43
    s_lshr_b32 s65, s67, 1
    s_lshl_b32 s66, s65, 8
    s_add_u32 s66, s66, s7
    s_add_u32 s66, s66, 90112
    v_lshlrev_b32 v3, 9, v1
    v_mov_b32 v2, 1
    s_mov_b64 exec, 3
    buffer_atomic_add v2, v3, s[16:19], s66 offen sc1
    s_mov_b64 exec, -1
w0_43:
    s_mov_b32 s65, 131072
    buffer_load_dword v123, v27, s[20:23], 0 offen
    buffer_load_dword v123, v27, s[20:23], s65 offen
    s_add_u32 s52, s50, 3
    s_and_b32 s52, s52, 3
    s_lshl_b32 s53, s52, 17
    s_add_u32 m0, s58, 118784
    s_add_u32 s55, s53, 0
    buffer_load_dwordx4 v126, s[24:27], s55 offen lds
    s_add_u32 m0, s58, 119808
    s_add_u32 s55, s53, 16384
    buffer_load_dwordx4 v126, s[24:27], s55 offen lds
    s_add_u32 m0, s58, 120832
    s_add_u32 s55, s53, 4096
    buffer_load_dwordx4 v126, s[24:27], s55 offen lds
    s_add_u32 m0, s58, 121856
    s_add_u32 s55, s53, 20480
    buffer_load_dwordx4 v126, s[24:27], s55 offen lds
    s_add_u32 m0, s57, 12288
    s_lshl_b32 s55, s52, 12
    buffer_load_dwordx4 v127, s[28:31], s55 offen lds
    s_load_dwordx2 s[66:67], s[0:1], 72
    s_mov_b32 s3, 1
    s_add_u32 s7, s7, 65536
    s_mov_b32 s8, s20
    s_mov_b32 s9, s21
    s_add_u32 s12, s12, 16777216
    s_addc_u32 s13, s13, 0
    s_waitcnt lgkmcnt(0)
    s_mov_b32 s20, s66
    s_mov_b32 s21, s67
    s_branch layer_top
k_done:
k_exit:
    s_endpgm
attn_fallback:
    s_mov_b32 s62, 0x0000ffff
    s_mov_b32 s63, 0x0000ffff
    v_and_b32 v2, 15, v1
    v_lshlrev_b32 v4, 4, v2
    v_lshrrev_b32 v2, 5, v1
    v_lshl_add_u32 v4, v2, 8, v4
    v_and_b32 v2, 27, v1
    v_cmp_eq_u32 vcc, 16, v2
    v_mov_b32 v2, 0x3f803f80
    s_nop 1
    v_cndmask_b32 v24, 0, v2, vcc
    v_mov_b32 v25, v24
    v_mov_b32 v26, v24
    v_mov_b32 v27, v24
    v_mov_b32 v28, v24
    v_mov_b32 v29, v24
    v_mov_b32 v30, v24
    v_mov_b32 v31, v24
    v_mov_b32 v2, 0xff7fffff
    s_mov_b32 s58, 2097152
attn_fb_44:
    buffer_load_dwordx4 v[16:19], v108, s[12:15], s58 offen
    s_waitcnt vmcnt(0)
    v_mfma_f32_32x32x16_bf16 v[40:55], v[16:19], v[8:11], 0
    s_nop 15
    v_max3_f32 v2, v2, v40, v41
    v_max3_f32 v2, v2, v42, v43
    v_max3_f32 v2, v2, v44, v45
    v_max3_f32 v2, v2, v46, v47
    v_max3_f32 v2, v2, v48, v49
    v_max3_f32 v2, v2, v50, v51
    v_max3_f32 v2, v2, v52, v53
    v_max3_f32 v2, v2, v54, v55
    s_add_u32 s58, s58, 2048
    s_cmp_lt_u32 s58, 2228224
    s_cbranch_scc1 attn_fb_44
    v_mov_b32 v3, v2
    s_nop 1
    v_permlane32_swap_b32 v2, v3
    s_nop 1
    v_max_f32 v2, v2, v3
    v_sub_f32 v2, 0, v2
    v_mov_b32 v56, v2
    v_mov_b32 v72, 0
    v_mov_b32 v57, v2
    v_mov_b32 v73, 0
    v_mov_b32 v58, v2
    v_mov_b32 v74, 0
    v_mov_b32 v59, v2
    v_mov_b32 v75, 0
    v_mov_b32 v60, v2
    v_mov_b32 v76, 0
    v_mov_b32 v61, v2
    v_mov_b32 v77, 0
    v_mov_b32 v62, v2
    v_mov_b32 v78, 0
    v_mov_b32 v63, v2
    v_mov_b32 v79, 0
    v_mov_b32 v64, v2
    v_mov_b32 v80, 0
    v_mov_b32 v65, v2
    v_mov_b32 v81, 0
    v_mov_b32 v66, v2
    v_mov_b32 v82, 0
    v_mov_b32 v67, v2
    v_mov_b32 v83, 0
    v_mov_b32 v68, v2
    v_mov_b32 v84, 0
    v_mov_b32 v69, v2
    v_mov_b32 v85, 0
    v_mov_b32 v70, v2
    v_mov_b32 v86, 0
    v_mov_b32 v71, v2
    v_mov_b32 v87, 0
    s_mov_b32 s58, 2097152
attn_fb_45:
    buffer_load_dwordx4 v[16:19], v108, s[12:15], s58 offen
    s_mov_b64 exec, s[62:63]
    buffer_load_dwordx4 v[24:27], v4, s[12:15], s58 offen offset:1024
    buffer_load_dwordx4 v[28:31], v4, s[12:15], s58 offen offset:1536
    s_mov_b64 exec, -1
    s_waitcnt vmcnt(0)
    v_mfma_f32_32x32x16_bf16 v[40:55], v[16:19], v[8:11], v[56:71]
    s_nop 15
    v_exp_f32 v40, v40
    v_exp_f32 v41, v41
    v_exp_f32 v42, v42
    v_exp_f32 v43, v43
    v_exp_f32 v44, v44
    v_exp_f32 v45, v45
    v_exp_f32 v46, v46
    v_exp_f32 v47, v47
    v_exp_f32 v48, v48
    v_exp_f32 v49, v49
    v_exp_f32 v50, v50
    v_exp_f32 v51, v51
    v_exp_f32 v52, v52
    v_exp_f32 v53, v53
    v_exp_f32 v54, v54
    v_exp_f32 v55, v55
    s_nop 1
    v_smfmac_f32_32x32x32_bf16 v[72:87], v[24:27], v[40:47], v104
    v_smfmac_f32_32x32x32_bf16 v[72:87], v[28:31], v[48:55], v104
    s_add_u32 s58, s58, 2048
    s_cmp_lt_u32 s58, 2228224
    s_cbranch_scc1 attn_fb_45
    s_nop 15
    v_mov_b32 v2, 0xff7fffff
    s_mov_b32 s58, 2097152
attn_fb_46:
    buffer_load_dwordx4 v[16:19], v108, s[12:15], s58 offen
    s_waitcnt vmcnt(0)
    v_mfma_f32_32x32x16_bf16 v[40:55], v[16:19], v[12:15], 0
    s_nop 15
    v_max3_f32 v2, v2, v40, v41
    v_max3_f32 v2, v2, v42, v43
    v_max3_f32 v2, v2, v44, v45
    v_max3_f32 v2, v2, v46, v47
    v_max3_f32 v2, v2, v48, v49
    v_max3_f32 v2, v2, v50, v51
    v_max3_f32 v2, v2, v52, v53
    v_max3_f32 v2, v2, v54, v55
    s_add_u32 s58, s58, 2048
    s_cmp_lt_u32 s58, 2228224
    s_cbranch_scc1 attn_fb_46
    v_mov_b32 v3, v2
    s_nop 1
    v_permlane32_swap_b32 v2, v3
    s_nop 1
    v_max_f32 v2, v2, v3
    v_sub_f32 v2, 0, v2
    v_mov_b32 v56, v2
    v_mov_b32 v88, 0
    v_mov_b32 v57, v2
    v_mov_b32 v89, 0
    v_mov_b32 v58, v2
    v_mov_b32 v90, 0
    v_mov_b32 v59, v2
    v_mov_b32 v91, 0
    v_mov_b32 v60, v2
    v_mov_b32 v92, 0
    v_mov_b32 v61, v2
    v_mov_b32 v93, 0
    v_mov_b32 v62, v2
    v_mov_b32 v94, 0
    v_mov_b32 v63, v2
    v_mov_b32 v95, 0
    v_mov_b32 v64, v2
    v_mov_b32 v96, 0
    v_mov_b32 v65, v2
    v_mov_b32 v97, 0
    v_mov_b32 v66, v2
    v_mov_b32 v98, 0
    v_mov_b32 v67, v2
    v_mov_b32 v99, 0
    v_mov_b32 v68, v2
    v_mov_b32 v100, 0
    v_mov_b32 v69, v2
    v_mov_b32 v101, 0
    v_mov_b32 v70, v2
    v_mov_b32 v102, 0
    v_mov_b32 v71, v2
    v_mov_b32 v103, 0
    s_mov_b32 s58, 2097152
attn_fb_47:
    buffer_load_dwordx4 v[16:19], v108, s[12:15], s58 offen
    s_mov_b64 exec, s[62:63]
    buffer_load_dwordx4 v[24:27], v4, s[12:15], s58 offen offset:1024
    buffer_load_dwordx4 v[28:31], v4, s[12:15], s58 offen offset:1536
    s_mov_b64 exec, -1
    s_waitcnt vmcnt(0)
    v_mfma_f32_32x32x16_bf16 v[40:55], v[16:19], v[12:15], v[56:71]
    s_nop 15
    v_exp_f32 v40, v40
    v_exp_f32 v41, v41
    v_exp_f32 v42, v42
    v_exp_f32 v43, v43
    v_exp_f32 v44, v44
    v_exp_f32 v45, v45
    v_exp_f32 v46, v46
    v_exp_f32 v47, v47
    v_exp_f32 v48, v48
    v_exp_f32 v49, v49
    v_exp_f32 v50, v50
    v_exp_f32 v51, v51
    v_exp_f32 v52, v52
    v_exp_f32 v53, v53
    v_exp_f32 v54, v54
    v_exp_f32 v55, v55
    s_nop 1
    v_smfmac_f32_32x32x32_bf16 v[88:103], v[24:27], v[40:47], v104
    v_smfmac_f32_32x32x32_bf16 v[88:103], v[28:31], v[48:55], v104
    s_add_u32 s58, s58, 2048
    s_cmp_lt_u32 s58, 2228224
    s_cbranch_scc1 attn_fb_47
    s_nop 15
    s_mov_b32 s61, 1
    s_branch attn_norm
code_end:
.section .rodata,"a"
.p2align 6
.amdhsa_kernel interleave_layers__grouped_kv_mqa__glu_gated_geglu__prompt_kernel
  .amdhsa_next_free_vgpr 512
  .amdhsa_next_free_sgpr 102
  .amdhsa_accum_offset 256
  .amdhsa_group_segment_fixed_size 0
  .amdhsa_kernarg_size 96
  .amdhsa_user_sgpr_count 2
  .amdhsa_user_sgpr_kernarg_segment_ptr 1
  .amdhsa_system_sgpr_workgroup_id_x 1
.end_amdhsa_kernel
```
